```python
import torch

def _softmax(x, axis=-1):
    return torch.softmax(x, dim=axis)
def _gelu(x):
    return torch.nn.functional.gelu(x, approximate="tanh")
def _silu(x):
    return torch.nn.functional.silu(x)
def _sigmoid(x):
    return torch.sigmoid(x)
def _layernorm(x, axis=-1, eps=1e-5):
    m = x.mean(dim=axis, keepdim=True)
    v = x.var(dim=axis, keepdim=True, unbiased=False)
    return (x - m) / torch.sqrt(v + eps)
def _scatter_add(tgt, idx, src, axis=0):
    return tgt.clone().index_add_(axis, idx, src)
def _segment_sum(src, seg, n):
    out = torch.zeros((n,) + src.shape[1:], dtype=src.dtype)
    return out.index_add_(0, seg, src)
def _pad(x, pw):
    flat = tuple(v for pair in reversed(pw) for v in pair)
    return torch.nn.functional.pad(x, flat)

kernel_name = 'parallel_sum__sliding_local_dilated__glu_gated_bilinear__prompt'

def setup_inputs():

    _w = (lambda a: (lambda t: t.to(torch.bfloat16) if t.is_floating_point() else t)(torch.as_tensor(a)))
    def _A_setup():
        B, S, D = 1, 2048, 640
        return {
            "x": _w((lambda *s: torch.randn(*s, dtype=torch.bfloat16) * 0.05)(B, S, D)),
            "wqkv": _w((lambda *s: torch.randn(*s, dtype=torch.bfloat16) * 0.05)(D, 3 * D)),
            "wo": _w((lambda *s: torch.randn(*s, dtype=torch.bfloat16) * 0.05)(D, D)),
        }
    _A_in = _A_setup()

    def _B_setup():
        B, S, D, F = 1, 2048, 640, 1536
        return {
            "x": _w((lambda *s: torch.randn(*s, dtype=torch.bfloat16) * 0.05)(B, S, D)),
            "w_gate": _w((lambda *s: torch.randn(*s, dtype=torch.bfloat16) * 0.8)(D, F) * (D ** -0.5)),
            "w_up": _w((lambda *s: torch.randn(*s, dtype=torch.bfloat16) * 0.8)(D, F) * (D ** -0.5)),
            "w_down": _w((lambda *s: torch.randn(*s, dtype=torch.bfloat16) * 0.8)(F, D) * (F ** -0.5)),
        }
    _B_in = _B_setup()

    return {
        "A_x": _A_in["x"],
        "A_wqkv": _A_in["wqkv"],
        "A_wo": _A_in["wo"],
        "B_x": _B_in["x"],
        "B_w_gate": _B_in["w_gate"],
        "B_w_up": _B_in["w_up"],
        "B_w_down": _B_in["w_down"],
    }

def reference(A_x, A_wqkv, A_wo, B_x, B_w_gate, B_w_up, B_w_down):
    def _A_ref(x, wqkv, wo):
        B, S, D = x.shape
        H = 32; Dh = D // H
        W, dil = 8, 2
        qkv = (lambda x, *d: x.permute(*d))((x @ wqkv).reshape(B, S, 3, H, Dh), 2, 0, 3, 1, 4)
        q, k, v = qkv[0], qkv[1], qkv[2]
        scale = Dh ** -0.5
        pos = torch.arange(S)
        off = torch.arange(W) * dil
        idx = pos[:, None] - off[None, :]
        mask = idx >= 0
        idx_c = torch.where(mask, idx, 0).reshape(-1)
        kg = k[:, :, idx_c, :].reshape(B, H, S, W, Dh)
        vg = v[:, :, idx_c, :].reshape(B, H, S, W, Dh)
        logits = torch.einsum("bhsd,bhswd->bhsw", q, kg) * scale
        logits = torch.where(mask[None, None, :, :], logits, -1e9)
        attn = _softmax(logits, axis=-1)
        o = torch.einsum("bhsw,bhswd->bhsd", attn, vg)
        return (lambda x, *d: x.permute(*d))(o, 0, 2, 1, 3).reshape(B, S, D) @ wo

    def _B_ref(x, w_gate, w_up, w_down):
        g = torch.einsum("bsd,df->bsf", x, w_gate)
        u = torch.einsum("bsd,df->bsf", x, w_up)
        h = g * u
        return torch.einsum("bsf,fd->bsd", h, w_down)

    x = A_x
    xn = _layernorm(x, axis=-1)
    return x + _A_ref(xn, A_wqkv, A_wo) + _B_ref(xn, B_w_gate, B_w_up, B_w_down)
```

```asm
; @launch grid=(256,1,1) block=(512,1,1) lds=163840
.amdgcn_target "amdgcn-amd-amdhsa--gfx950"
.text

.globl parallel_sum__sliding_local_dilated__glu_gated_bilinear__prompt_kernel
.p2align 8
.type parallel_sum__sliding_local_dilated__glu_gated_bilinear__prompt_kernel,@function
parallel_sum__sliding_local_dilated__glu_gated_bilinear__prompt_kernel:

s_load_dwordx16 s[4:19], s[0:1], 0
s_load_dwordx4 s[20:23], s[0:1], 64
v_lshrrev_b32 v1, 6, v0
v_and_b32 v0, 63, v0
s_cmp_ge_u32 s2, 256
s_cbranch_scc1 K_END
v_readfirstlane_b32 s3, v1
s_and_b32 s44, s2, 7
s_lshr_b32 s45, s2, 4
s_and_b32 s49, s3, 3
s_cmp_ge_u32 s3, 4
s_cbranch_scc1 K_L
s_bitcmp1_b32 s2, 3
s_cbranch_scc1 Q_C
s_branch H_C
K_L:
s_bitcmp1_b32 s2, 3
s_cbranch_scc1 Q_L
s_branch H_L
H_C:
s_getpc_b64 s[66:67]
H_PC:
s_sub_u32 s66, s66, H_PC-parallel_sum__sliding_local_dilated__glu_gated_bilinear__prompt_kernel
s_subb_u32 s67, s67, 0
s_lshl2_add_u32 s68, s45, s3
s_mul_i32 s68, s68, 1152
v_min_u32 v8, 8, v0
v_lshlrev_b32 v8, 7, v8
v_add_u32 v8, s68, v8
v_min_u32 v8, CODE_SPAN, v8
global_load_dword v19, v8, s[66:67]
s_memrealtime s[74:75]
v_mul_u32_u24 v4, 43, v0
v_lshrrev_b32 v4, 8, v4
v_mul_u32_u24 v5, 6, v4
v_sub_u32 v5, v0, v5
v_lshrrev_b32 v6, 1, v5
v_and_b32 v5, 1, v5
v_mul_u32_u24 v6, 1280, v6
v_mul_u32_u24 v5, 156, v5
v_and_b32 v7, 4, v4
v_mad_u32_u24 v4, v7, 15, v4
v_mul_u32_u24 v4, 3840, v4
v_add3_u32 v4, v4, v5, v6
v_cmp_gt_u32 vcc, 48, v0
v_mov_b32 v5, 2147483648
s_add_u32 s58, s49, 0
s_lshl_b32 s58, s58, 5
s_add_u32 s58, s58, s45
s_mul_i32 s58, s58, 15360
s_mul_i32 s64, s44, 160
s_add_u32 s58, s58, s64
v_cndmask_b32 v17, v5, v4, vcc
s_mov_b32 s42, 983040
s_mov_b32 s43, 0x20000
s_waitcnt lgkmcnt(0)
s_mov_b64 s[40:41], s[6:7]
buffer_load_dword v16, v17, s[40:43], s58 offen
s_or_b32 s60, s2, s3
s_cmp_lg_u32 s60, 0
s_cbranch_scc1 L1
s_mov_b64 s[36:37], s[20:21]
s_mov_b32 s38, 256
s_mov_b32 s39, 0x20000
v_mov_b32 v4, s74
v_mov_b32 v5, s75
v_lshlrev_b32 v6, 20, v0
buffer_store_dwordx2 v[4:5], v6, s[36:39], 0 offen sc1
L1:
s_lshl3_add_u32 s46, s45, s44
s_lshl1_add_u32 s46, s46, 0
v_lshlrev_b32 v2, 4, v0
v_lshlrev_b32 v3, 2, v0
s_mov_b64 s[32:33], s[22:23]
s_mov_b32 s34, 33554432
s_mov_b32 s35, 0x20000
s_mov_b64 s[24:25], s[4:5]
s_mov_b32 s26, 2621440
s_mov_b32 s27, 0x20000
s_bfe_u32 s47, s2, 0x30004
s_lshr_b32 s77, s2, 3
s_xor_b32 s77, s77, s47
s_and_b32 s77, s77, 1
s_lshr_b32 s48, s2, 7
s_lshl1_add_u32 s48, s48, s77
s_lshr_b32 s77, s44, 1
s_lshl_b32 s77, s77, 3
s_add_u32 s47, s77, s47
s_and_b32 s77, s44, 1
s_lshl_b32 s77, s77, 2
s_add_u32 s48, s77, s48
s_mul_i32 s10, s48, 348160
s_add_u32 s10, s10, 16777216
s_mul_i32 s59, s49, 5120
s_add_u32 s11, s10, s59
s_lshl_b32 s55, s3, 2
s_lshr_b32 s55, 0x76025413, s55
s_and_b32 s55, s55, 7
s_mul_i32 s55, s55, 20480
s_and_b32 s61, s3, 1
s_lshr_b32 s62, s3, 1
v_lshrrev_b32 v20, 4, v0
v_bfe_u32 v21, v0, 2, 2
v_lshl_add_u32 v22, v20, 3, v21
v_mul_u32_u24 v22, 384, v22
v_and_b32 v23, 1, v0
v_lshl_add_u32 v22, v23, 3, v22
v_add_u32 v22, 65536, v22
v_and_b32 v21, 2, v21
v_and_b32 v23, 1, v20
v_lshl_or_b32 v21, v23, 2, v21
v_bfe_u32 v23, v0, 1, 1
s_mul_i32 s63, s62, 12
v_add_u32 v23, s63, v23
s_lshl_b32 s63, s61, 13
v_and_b32 v6, 15, v0
v_lshrrev_b32 v7, 4, v0
v_bfe_u32 v5, v0, 1, 3
v_xor_b32 v5, v5, v7
v_lshlrev_b32 v5, 4, v5
v_lshl_add_u32 v4, v6, 7, v5
v_add_u32 v4, s63, v4
v_xor_b32 v5, 64, v4
v_add_u32 v24, 0, v23
v_xor_b32 v24, v24, v21
v_lshl_add_u32 v6, v24, 4, v22
v_add_u32 v10, 49152, v6
v_add_u32 v24, 2, v23
v_xor_b32 v24, v24, v21
v_lshl_add_u32 v7, v24, 4, v22
v_add_u32 v11, 49152, v7
v_add_u32 v24, 4, v23
v_xor_b32 v24, v24, v21
v_lshl_add_u32 v8, v24, 4, v22
v_add_u32 v12, 49152, v8
v_add_u32 v24, 6, v23
v_xor_b32 v24, v24, v21
v_lshl_add_u32 v9, v24, 4, v22
v_add_u32 v13, 49152, v9
s_mul_i32 s63, s62, 384
s_add_u32 s63, s63, 56320
v_lshl_add_u32 v14, v20, 4, s63
s_lshl_b32 s63, s61, 9
s_add_u32 s63, s63, 58368
v_and_b32 v24, 15, v0
v_lshl_add_u32 v15, v24, 3, s63
v_mov_b32 v1, 60416
v_mov_b32 v18, 0
s_lshl1_add_u32 s63, s45, s61
s_lshl3_add_u32 s54, s63, s44
s_lshl1_add_u32 s54, s54, s62
s_lshl_b32 s54, s54, 7
s_add_u32 s54, s54, 23068672
s_mul_i32 s63, s63, 68
s_mul_i32 s64, s44, 6
s_add_u32 s63, s63, s64
s_mul_i32 s64, s62, 3
s_add_u32 s63, s63, s64
s_lshl_b32 s70, s63, 12
s_add_u32 s71, s70, 4096
s_add_u32 s72, s70, 8192
s_setprio 1
s_waitcnt vmcnt(0) lgkmcnt(0)
s_barrier
ds_read_b128 v[16:19], v4 offset:16384
ds_read_b128 v[20:23], v4 offset:18432
ds_read_b128 v[24:27], v4 offset:20480
ds_read_b128 v[28:31], v4 offset:22528
ds_read_b64_tr_b16 v[48:49], v6 offset:0
ds_read_b64_tr_b16 v[50:51], v6 offset:1536
ds_read_b64_tr_b16 v[52:53], v7 offset:0
ds_read_b64_tr_b16 v[54:55], v7 offset:1536
ds_read_b64_tr_b16 v[56:57], v6 offset:12288
ds_read_b64_tr_b16 v[58:59], v6 offset:13824
.p2align 3
s_waitcnt lgkmcnt(4)
s_nop 0
v_mfma_f32_16x16x32_bf16 v[64:67], v[48:51], v[16:19], 0
ds_read_b64_tr_b16 v[60:61], v7 offset:12288
v_mfma_f32_16x16x32_bf16 v[112:115], v[48:51], v[20:23], 0
ds_read_b64_tr_b16 v[62:63], v7 offset:13824
v_mfma_f32_16x16x32_bf16 v[160:163], v[48:51], v[24:27], 0
v_mfma_f32_16x16x32_bf16 v[208:211], v[48:51], v[28:31], 0
s_waitcnt lgkmcnt(4)
s_nop 0
v_mfma_f32_16x16x32_bf16 v[68:71], v[52:55], v[16:19], 0
ds_read_b64_tr_b16 v[48:49], v8 offset:0
v_mfma_f32_16x16x32_bf16 v[116:119], v[52:55], v[20:23], 0
ds_read_b64_tr_b16 v[50:51], v8 offset:1536
v_mfma_f32_16x16x32_bf16 v[164:167], v[52:55], v[24:27], 0
v_mfma_f32_16x16x32_bf16 v[212:215], v[52:55], v[28:31], 0
s_waitcnt lgkmcnt(4)
s_nop 0
v_mfma_f32_16x16x32_bf16 v[88:91], v[56:59], v[16:19], 0
ds_read_b64_tr_b16 v[52:53], v9 offset:0
v_mfma_f32_16x16x32_bf16 v[136:139], v[56:59], v[20:23], 0
ds_read_b64_tr_b16 v[54:55], v9 offset:1536
v_mfma_f32_16x16x32_bf16 v[184:187], v[56:59], v[24:27], 0
v_mfma_f32_16x16x32_bf16 v[232:235], v[56:59], v[28:31], 0
s_waitcnt lgkmcnt(4)
s_nop 0
v_mfma_f32_16x16x32_bf16 v[92:95], v[60:63], v[16:19], 0
ds_read_b64_tr_b16 v[56:57], v8 offset:12288
v_mfma_f32_16x16x32_bf16 v[140:143], v[60:63], v[20:23], 0
ds_read_b64_tr_b16 v[58:59], v8 offset:13824
v_mfma_f32_16x16x32_bf16 v[188:191], v[60:63], v[24:27], 0
v_mfma_f32_16x16x32_bf16 v[236:239], v[60:63], v[28:31], 0
s_waitcnt lgkmcnt(4)
s_nop 0
v_mfma_f32_16x16x32_bf16 v[72:75], v[48:51], v[16:19], 0
ds_read_b64_tr_b16 v[60:61], v9 offset:12288
v_mfma_f32_16x16x32_bf16 v[120:123], v[48:51], v[20:23], 0
ds_read_b64_tr_b16 v[62:63], v9 offset:13824
v_mfma_f32_16x16x32_bf16 v[168:171], v[48:51], v[24:27], 0
v_mfma_f32_16x16x32_bf16 v[216:219], v[48:51], v[28:31], 0
s_waitcnt lgkmcnt(4)
s_nop 0
v_mfma_f32_16x16x32_bf16 v[76:79], v[52:55], v[16:19], 0
ds_read_b64_tr_b16 v[48:49], v6 offset:128
v_mfma_f32_16x16x32_bf16 v[124:127], v[52:55], v[20:23], 0
ds_read_b64_tr_b16 v[50:51], v6 offset:1664
v_mfma_f32_16x16x32_bf16 v[172:175], v[52:55], v[24:27], 0
v_mfma_f32_16x16x32_bf16 v[220:223], v[52:55], v[28:31], 0
s_waitcnt lgkmcnt(4)
s_nop 0
v_mfma_f32_16x16x32_bf16 v[96:99], v[56:59], v[16:19], 0
ds_read_b64_tr_b16 v[52:53], v7 offset:128
v_mfma_f32_16x16x32_bf16 v[144:147], v[56:59], v[20:23], 0
ds_read_b64_tr_b16 v[54:55], v7 offset:1664
v_mfma_f32_16x16x32_bf16 v[192:195], v[56:59], v[24:27], 0
v_mfma_f32_16x16x32_bf16 v[240:243], v[56:59], v[28:31], 0
s_waitcnt lgkmcnt(4)
s_nop 0
v_mfma_f32_16x16x32_bf16 v[100:103], v[60:63], v[16:19], 0
ds_read_b64_tr_b16 v[56:57], v6 offset:12416
v_mfma_f32_16x16x32_bf16 v[148:151], v[60:63], v[20:23], 0
ds_read_b64_tr_b16 v[58:59], v6 offset:13952
v_mfma_f32_16x16x32_bf16 v[196:199], v[60:63], v[24:27], 0
v_mfma_f32_16x16x32_bf16 v[244:247], v[60:63], v[28:31], 0
s_waitcnt lgkmcnt(4)
s_nop 0
v_mfma_f32_16x16x32_bf16 v[80:83], v[48:51], v[16:19], 0
ds_read_b64_tr_b16 v[60:61], v7 offset:12416
v_mfma_f32_16x16x32_bf16 v[128:131], v[48:51], v[20:23], 0
ds_read_b64_tr_b16 v[62:63], v7 offset:13952
v_mfma_f32_16x16x32_bf16 v[176:179], v[48:51], v[24:27], 0
v_mfma_f32_16x16x32_bf16 v[224:227], v[48:51], v[28:31], 0
s_waitcnt lgkmcnt(4)
s_nop 0
v_mfma_f32_16x16x32_bf16 v[84:87], v[52:55], v[16:19], 0
s_waitcnt lgkmcnt(0)
s_barrier
v_mfma_f32_16x16x32_bf16 v[132:135], v[52:55], v[20:23], 0
ds_read_b128 v[32:35], v5 offset:16384
v_mfma_f32_16x16x32_bf16 v[180:183], v[52:55], v[24:27], 0
ds_read_b128 v[36:39], v5 offset:18432
v_mfma_f32_16x16x32_bf16 v[228:231], v[52:55], v[28:31], 0
ds_read_b64_tr_b16 v[48:49], v6 offset:24576
v_mfma_f32_16x16x32_bf16 v[104:107], v[56:59], v[16:19], 0
ds_read_b64_tr_b16 v[50:51], v6 offset:26112
ds_read_b128 v[40:43], v5 offset:20480
v_mfma_f32_16x16x32_bf16 v[152:155], v[56:59], v[20:23], 0
ds_read_b128 v[44:47], v5 offset:22528
v_mfma_f32_16x16x32_bf16 v[200:203], v[56:59], v[24:27], 0
ds_read_b64_tr_b16 v[52:53], v7 offset:24576
v_mfma_f32_16x16x32_bf16 v[248:251], v[56:59], v[28:31], 0
ds_read_b64_tr_b16 v[54:55], v7 offset:26112
v_mfma_f32_16x16x32_bf16 v[108:111], v[60:63], v[16:19], 0
ds_read_b64_tr_b16 v[56:57], v6 offset:36864
v_mfma_f32_16x16x32_bf16 v[156:159], v[60:63], v[20:23], 0
ds_read_b64_tr_b16 v[58:59], v6 offset:38400
v_mfma_f32_16x16x32_bf16 v[204:207], v[60:63], v[24:27], 0
v_mfma_f32_16x16x32_bf16 v[252:255], v[60:63], v[28:31], 0
s_waitcnt lgkmcnt(4)
s_nop 0
v_mfma_f32_16x16x32_bf16 v[64:67], v[48:51], v[32:35], v[64:67]
ds_read_b64_tr_b16 v[60:61], v7 offset:36864
v_mfma_f32_16x16x32_bf16 v[112:115], v[48:51], v[36:39], v[112:115]
ds_read_b64_tr_b16 v[62:63], v7 offset:38400
v_mfma_f32_16x16x32_bf16 v[160:163], v[48:51], v[40:43], v[160:163]
v_mfma_f32_16x16x32_bf16 v[208:211], v[48:51], v[44:47], v[208:211]
s_waitcnt lgkmcnt(4)
s_nop 0
v_mfma_f32_16x16x32_bf16 v[68:71], v[52:55], v[32:35], v[68:71]
ds_read_b64_tr_b16 v[48:49], v8 offset:24576
v_mfma_f32_16x16x32_bf16 v[116:119], v[52:55], v[36:39], v[116:119]
ds_read_b64_tr_b16 v[50:51], v8 offset:26112
v_mfma_f32_16x16x32_bf16 v[164:167], v[52:55], v[40:43], v[164:167]
v_mfma_f32_16x16x32_bf16 v[212:215], v[52:55], v[44:47], v[212:215]
s_waitcnt lgkmcnt(4)
s_nop 0
v_mfma_f32_16x16x32_bf16 v[88:91], v[56:59], v[32:35], v[88:91]
ds_read_b64_tr_b16 v[52:53], v9 offset:24576
v_mfma_f32_16x16x32_bf16 v[136:139], v[56:59], v[36:39], v[136:139]
ds_read_b64_tr_b16 v[54:55], v9 offset:26112
v_mfma_f32_16x16x32_bf16 v[184:187], v[56:59], v[40:43], v[184:187]
v_mfma_f32_16x16x32_bf16 v[232:235], v[56:59], v[44:47], v[232:235]
s_waitcnt lgkmcnt(4)
s_nop 0
v_mfma_f32_16x16x32_bf16 v[92:95], v[60:63], v[32:35], v[92:95]
ds_read_b64_tr_b16 v[56:57], v8 offset:36864
v_mfma_f32_16x16x32_bf16 v[140:143], v[60:63], v[36:39], v[140:143]
ds_read_b64_tr_b16 v[58:59], v8 offset:38400
v_mfma_f32_16x16x32_bf16 v[188:191], v[60:63], v[40:43], v[188:191]
v_mfma_f32_16x16x32_bf16 v[236:239], v[60:63], v[44:47], v[236:239]
s_waitcnt lgkmcnt(4)
s_nop 0
v_mfma_f32_16x16x32_bf16 v[72:75], v[48:51], v[32:35], v[72:75]
ds_read_b64_tr_b16 v[60:61], v9 offset:36864
v_mfma_f32_16x16x32_bf16 v[120:123], v[48:51], v[36:39], v[120:123]
ds_read_b64_tr_b16 v[62:63], v9 offset:38400
v_mfma_f32_16x16x32_bf16 v[168:171], v[48:51], v[40:43], v[168:171]
v_mfma_f32_16x16x32_bf16 v[216:219], v[48:51], v[44:47], v[216:219]
s_waitcnt lgkmcnt(4)
s_nop 0
v_mfma_f32_16x16x32_bf16 v[76:79], v[52:55], v[32:35], v[76:79]
ds_read_b64_tr_b16 v[48:49], v6 offset:24704
v_mfma_f32_16x16x32_bf16 v[124:127], v[52:55], v[36:39], v[124:127]
ds_read_b64_tr_b16 v[50:51], v6 offset:26240
v_mfma_f32_16x16x32_bf16 v[172:175], v[52:55], v[40:43], v[172:175]
v_mfma_f32_16x16x32_bf16 v[220:223], v[52:55], v[44:47], v[220:223]
s_waitcnt lgkmcnt(4)
s_nop 0
v_mfma_f32_16x16x32_bf16 v[96:99], v[56:59], v[32:35], v[96:99]
ds_read_b64_tr_b16 v[52:53], v7 offset:24704
v_mfma_f32_16x16x32_bf16 v[144:147], v[56:59], v[36:39], v[144:147]
ds_read_b64_tr_b16 v[54:55], v7 offset:26240
v_mfma_f32_16x16x32_bf16 v[192:195], v[56:59], v[40:43], v[192:195]
v_mfma_f32_16x16x32_bf16 v[240:243], v[56:59], v[44:47], v[240:243]
s_waitcnt lgkmcnt(4)
s_nop 0
v_mfma_f32_16x16x32_bf16 v[100:103], v[60:63], v[32:35], v[100:103]
ds_read_b64_tr_b16 v[56:57], v6 offset:36992
v_mfma_f32_16x16x32_bf16 v[148:151], v[60:63], v[36:39], v[148:151]
ds_read_b64_tr_b16 v[58:59], v6 offset:38528
v_mfma_f32_16x16x32_bf16 v[196:199], v[60:63], v[40:43], v[196:199]
v_mfma_f32_16x16x32_bf16 v[244:247], v[60:63], v[44:47], v[244:247]
s_waitcnt lgkmcnt(4)
s_nop 0
v_mfma_f32_16x16x32_bf16 v[80:83], v[48:51], v[32:35], v[80:83]
ds_read_b64_tr_b16 v[60:61], v7 offset:36992
v_mfma_f32_16x16x32_bf16 v[128:131], v[48:51], v[36:39], v[128:131]
ds_read_b64_tr_b16 v[62:63], v7 offset:38528
v_mfma_f32_16x16x32_bf16 v[176:179], v[48:51], v[40:43], v[176:179]
v_mfma_f32_16x16x32_bf16 v[224:227], v[48:51], v[44:47], v[224:227]
s_waitcnt lgkmcnt(4)
s_nop 0
v_mfma_f32_16x16x32_bf16 v[84:87], v[52:55], v[32:35], v[84:87]
s_waitcnt lgkmcnt(0)
s_barrier
v_mfma_f32_16x16x32_bf16 v[132:135], v[52:55], v[36:39], v[132:135]
ds_read_b128 v[16:19], v4 offset:0
v_mfma_f32_16x16x32_bf16 v[180:183], v[52:55], v[40:43], v[180:183]
ds_read_b128 v[20:23], v4 offset:2048
v_mfma_f32_16x16x32_bf16 v[228:231], v[52:55], v[44:47], v[228:231]
ds_read_b64_tr_b16 v[48:49], v10 offset:0
v_mfma_f32_16x16x32_bf16 v[104:107], v[56:59], v[32:35], v[104:107]
ds_read_b64_tr_b16 v[50:51], v10 offset:1536
ds_read_b128 v[24:27], v4 offset:4096
v_mfma_f32_16x16x32_bf16 v[152:155], v[56:59], v[36:39], v[152:155]
ds_read_b128 v[28:31], v4 offset:6144
v_mfma_f32_16x16x32_bf16 v[200:203], v[56:59], v[40:43], v[200:203]
ds_read_b64_tr_b16 v[52:53], v11 offset:0
v_mfma_f32_16x16x32_bf16 v[248:251], v[56:59], v[44:47], v[248:251]
ds_read_b64_tr_b16 v[54:55], v11 offset:1536
v_mfma_f32_16x16x32_bf16 v[108:111], v[60:63], v[32:35], v[108:111]
ds_read_b64_tr_b16 v[56:57], v10 offset:12288
v_mfma_f32_16x16x32_bf16 v[156:159], v[60:63], v[36:39], v[156:159]
ds_read_b64_tr_b16 v[58:59], v10 offset:13824
v_mfma_f32_16x16x32_bf16 v[204:207], v[60:63], v[40:43], v[204:207]
v_mfma_f32_16x16x32_bf16 v[252:255], v[60:63], v[44:47], v[252:255]
s_waitcnt lgkmcnt(4)
s_nop 0
v_mfma_f32_16x16x32_bf16 v[64:67], v[48:51], v[16:19], v[64:67]
ds_read_b64_tr_b16 v[60:61], v11 offset:12288
v_mfma_f32_16x16x32_bf16 v[112:115], v[48:51], v[20:23], v[112:115]
ds_read_b64_tr_b16 v[62:63], v11 offset:13824
v_mfma_f32_16x16x32_bf16 v[160:163], v[48:51], v[24:27], v[160:163]
v_mfma_f32_16x16x32_bf16 v[208:211], v[48:51], v[28:31], v[208:211]
s_waitcnt lgkmcnt(4)
s_nop 0
v_mfma_f32_16x16x32_bf16 v[68:71], v[52:55], v[16:19], v[68:71]
ds_read_b64_tr_b16 v[48:49], v12 offset:0
v_mfma_f32_16x16x32_bf16 v[116:119], v[52:55], v[20:23], v[116:119]
ds_read_b64_tr_b16 v[50:51], v12 offset:1536
v_mfma_f32_16x16x32_bf16 v[164:167], v[52:55], v[24:27], v[164:167]
v_mfma_f32_16x16x32_bf16 v[212:215], v[52:55], v[28:31], v[212:215]
s_waitcnt lgkmcnt(4)
s_nop 0
v_mfma_f32_16x16x32_bf16 v[88:91], v[56:59], v[16:19], v[88:91]
ds_read_b64_tr_b16 v[52:53], v13 offset:0
v_mfma_f32_16x16x32_bf16 v[136:139], v[56:59], v[20:23], v[136:139]
ds_read_b64_tr_b16 v[54:55], v13 offset:1536
v_mfma_f32_16x16x32_bf16 v[184:187], v[56:59], v[24:27], v[184:187]
v_mfma_f32_16x16x32_bf16 v[232:235], v[56:59], v[28:31], v[232:235]
s_waitcnt lgkmcnt(4)
s_nop 0
v_mfma_f32_16x16x32_bf16 v[92:95], v[60:63], v[16:19], v[92:95]
ds_read_b64_tr_b16 v[56:57], v12 offset:12288
v_mfma_f32_16x16x32_bf16 v[140:143], v[60:63], v[20:23], v[140:143]
ds_read_b64_tr_b16 v[58:59], v12 offset:13824
v_mfma_f32_16x16x32_bf16 v[188:191], v[60:63], v[24:27], v[188:191]
v_mfma_f32_16x16x32_bf16 v[236:239], v[60:63], v[28:31], v[236:239]
s_waitcnt lgkmcnt(4)
s_nop 0
v_mfma_f32_16x16x32_bf16 v[72:75], v[48:51], v[16:19], v[72:75]
ds_read_b64_tr_b16 v[60:61], v13 offset:12288
v_mfma_f32_16x16x32_bf16 v[120:123], v[48:51], v[20:23], v[120:123]
ds_read_b64_tr_b16 v[62:63], v13 offset:13824
v_mfma_f32_16x16x32_bf16 v[168:171], v[48:51], v[24:27], v[168:171]
v_mfma_f32_16x16x32_bf16 v[216:219], v[48:51], v[28:31], v[216:219]
s_waitcnt lgkmcnt(4)
s_nop 0
v_mfma_f32_16x16x32_bf16 v[76:79], v[52:55], v[16:19], v[76:79]
ds_read_b64_tr_b16 v[48:49], v10 offset:128
v_mfma_f32_16x16x32_bf16 v[124:127], v[52:55], v[20:23], v[124:127]
ds_read_b64_tr_b16 v[50:51], v10 offset:1664
v_mfma_f32_16x16x32_bf16 v[172:175], v[52:55], v[24:27], v[172:175]
v_mfma_f32_16x16x32_bf16 v[220:223], v[52:55], v[28:31], v[220:223]
s_waitcnt lgkmcnt(4)
s_nop 0
v_mfma_f32_16x16x32_bf16 v[96:99], v[56:59], v[16:19], v[96:99]
ds_read_b64_tr_b16 v[52:53], v11 offset:128
v_mfma_f32_16x16x32_bf16 v[144:147], v[56:59], v[20:23], v[144:147]
ds_read_b64_tr_b16 v[54:55], v11 offset:1664
v_mfma_f32_16x16x32_bf16 v[192:195], v[56:59], v[24:27], v[192:195]
v_mfma_f32_16x16x32_bf16 v[240:243], v[56:59], v[28:31], v[240:243]
s_waitcnt lgkmcnt(4)
s_nop 0
v_mfma_f32_16x16x32_bf16 v[100:103], v[60:63], v[16:19], v[100:103]
ds_read_b64_tr_b16 v[56:57], v10 offset:12416
v_mfma_f32_16x16x32_bf16 v[148:151], v[60:63], v[20:23], v[148:151]
ds_read_b64_tr_b16 v[58:59], v10 offset:13952
v_mfma_f32_16x16x32_bf16 v[196:199], v[60:63], v[24:27], v[196:199]
v_mfma_f32_16x16x32_bf16 v[244:247], v[60:63], v[28:31], v[244:247]
s_waitcnt lgkmcnt(4)
s_nop 0
v_mfma_f32_16x16x32_bf16 v[80:83], v[48:51], v[16:19], v[80:83]
ds_read_b64_tr_b16 v[60:61], v11 offset:12416
v_mfma_f32_16x16x32_bf16 v[128:131], v[48:51], v[20:23], v[128:131]
ds_read_b64_tr_b16 v[62:63], v11 offset:13952
v_mfma_f32_16x16x32_bf16 v[176:179], v[48:51], v[24:27], v[176:179]
v_mfma_f32_16x16x32_bf16 v[224:227], v[48:51], v[28:31], v[224:227]
s_waitcnt lgkmcnt(4)
s_nop 0
v_mfma_f32_16x16x32_bf16 v[84:87], v[52:55], v[16:19], v[84:87]
s_waitcnt lgkmcnt(0)
s_barrier
v_mfma_f32_16x16x32_bf16 v[132:135], v[52:55], v[20:23], v[132:135]
ds_read_b128 v[32:35], v5 offset:0
v_mfma_f32_16x16x32_bf16 v[180:183], v[52:55], v[24:27], v[180:183]
ds_read_b128 v[36:39], v5 offset:2048
v_mfma_f32_16x16x32_bf16 v[228:231], v[52:55], v[28:31], v[228:231]
ds_read_b64_tr_b16 v[48:49], v10 offset:24576
v_mfma_f32_16x16x32_bf16 v[104:107], v[56:59], v[16:19], v[104:107]
ds_read_b64_tr_b16 v[50:51], v10 offset:26112
ds_read_b128 v[40:43], v5 offset:4096
v_mfma_f32_16x16x32_bf16 v[152:155], v[56:59], v[20:23], v[152:155]
ds_read_b128 v[44:47], v5 offset:6144
v_mfma_f32_16x16x32_bf16 v[200:203], v[56:59], v[24:27], v[200:203]
ds_read_b64_tr_b16 v[52:53], v11 offset:24576
v_mfma_f32_16x16x32_bf16 v[248:251], v[56:59], v[28:31], v[248:251]
ds_read_b64_tr_b16 v[54:55], v11 offset:26112
v_mfma_f32_16x16x32_bf16 v[108:111], v[60:63], v[16:19], v[108:111]
ds_read_b64_tr_b16 v[56:57], v10 offset:36864
v_mfma_f32_16x16x32_bf16 v[156:159], v[60:63], v[20:23], v[156:159]
ds_read_b64_tr_b16 v[58:59], v10 offset:38400
v_mfma_f32_16x16x32_bf16 v[204:207], v[60:63], v[24:27], v[204:207]
v_mfma_f32_16x16x32_bf16 v[252:255], v[60:63], v[28:31], v[252:255]
s_waitcnt lgkmcnt(4)
s_nop 0
v_mfma_f32_16x16x32_bf16 v[64:67], v[48:51], v[32:35], v[64:67]
ds_read_b64_tr_b16 v[60:61], v11 offset:36864
v_mfma_f32_16x16x32_bf16 v[112:115], v[48:51], v[36:39], v[112:115]
ds_read_b64_tr_b16 v[62:63], v11 offset:38400
v_mfma_f32_16x16x32_bf16 v[160:163], v[48:51], v[40:43], v[160:163]
v_mfma_f32_16x16x32_bf16 v[208:211], v[48:51], v[44:47], v[208:211]
s_waitcnt lgkmcnt(4)
s_nop 0
v_mfma_f32_16x16x32_bf16 v[68:71], v[52:55], v[32:35], v[68:71]
ds_read_b64_tr_b16 v[48:49], v12 offset:24576
v_mfma_f32_16x16x32_bf16 v[116:119], v[52:55], v[36:39], v[116:119]
ds_read_b64_tr_b16 v[50:51], v12 offset:26112
v_mfma_f32_16x16x32_bf16 v[164:167], v[52:55], v[40:43], v[164:167]
v_mfma_f32_16x16x32_bf16 v[212:215], v[52:55], v[44:47], v[212:215]
s_waitcnt lgkmcnt(4)
s_nop 0
v_mfma_f32_16x16x32_bf16 v[88:91], v[56:59], v[32:35], v[88:91]
ds_read_b64_tr_b16 v[52:53], v13 offset:24576
v_mfma_f32_16x16x32_bf16 v[136:139], v[56:59], v[36:39], v[136:139]
ds_read_b64_tr_b16 v[54:55], v13 offset:26112
v_mfma_f32_16x16x32_bf16 v[184:187], v[56:59], v[40:43], v[184:187]
v_mfma_f32_16x16x32_bf16 v[232:235], v[56:59], v[44:47], v[232:235]
s_waitcnt lgkmcnt(4)
s_nop 0
v_mfma_f32_16x16x32_bf16 v[92:95], v[60:63], v[32:35], v[92:95]
ds_read_b64_tr_b16 v[56:57], v12 offset:36864
v_mfma_f32_16x16x32_bf16 v[140:143], v[60:63], v[36:39], v[140:143]
ds_read_b64_tr_b16 v[58:59], v12 offset:38400
v_mfma_f32_16x16x32_bf16 v[188:191], v[60:63], v[40:43], v[188:191]
v_mfma_f32_16x16x32_bf16 v[236:239], v[60:63], v[44:47], v[236:239]
s_waitcnt lgkmcnt(4)
s_nop 0
v_mfma_f32_16x16x32_bf16 v[72:75], v[48:51], v[32:35], v[72:75]
ds_read_b64_tr_b16 v[60:61], v13 offset:36864
v_mfma_f32_16x16x32_bf16 v[120:123], v[48:51], v[36:39], v[120:123]
ds_read_b64_tr_b16 v[62:63], v13 offset:38400
v_mfma_f32_16x16x32_bf16 v[168:171], v[48:51], v[40:43], v[168:171]
v_mfma_f32_16x16x32_bf16 v[216:219], v[48:51], v[44:47], v[216:219]
s_waitcnt lgkmcnt(4)
s_nop 0
v_mfma_f32_16x16x32_bf16 v[76:79], v[52:55], v[32:35], v[76:79]
ds_read_b64_tr_b16 v[48:49], v10 offset:24704
v_mfma_f32_16x16x32_bf16 v[124:127], v[52:55], v[36:39], v[124:127]
ds_read_b64_tr_b16 v[50:51], v10 offset:26240
v_mfma_f32_16x16x32_bf16 v[172:175], v[52:55], v[40:43], v[172:175]
v_mfma_f32_16x16x32_bf16 v[220:223], v[52:55], v[44:47], v[220:223]
s_waitcnt lgkmcnt(4)
s_nop 0
v_mfma_f32_16x16x32_bf16 v[96:99], v[56:59], v[32:35], v[96:99]
ds_read_b64_tr_b16 v[52:53], v11 offset:24704
v_mfma_f32_16x16x32_bf16 v[144:147], v[56:59], v[36:39], v[144:147]
ds_read_b64_tr_b16 v[54:55], v11 offset:26240
v_mfma_f32_16x16x32_bf16 v[192:195], v[56:59], v[40:43], v[192:195]
v_mfma_f32_16x16x32_bf16 v[240:243], v[56:59], v[44:47], v[240:243]
s_waitcnt lgkmcnt(4)
s_nop 0
v_mfma_f32_16x16x32_bf16 v[100:103], v[60:63], v[32:35], v[100:103]
ds_read_b64_tr_b16 v[56:57], v10 offset:36992
v_mfma_f32_16x16x32_bf16 v[148:151], v[60:63], v[36:39], v[148:151]
ds_read_b64_tr_b16 v[58:59], v10 offset:38528
v_mfma_f32_16x16x32_bf16 v[196:199], v[60:63], v[40:43], v[196:199]
v_mfma_f32_16x16x32_bf16 v[244:247], v[60:63], v[44:47], v[244:247]
s_waitcnt lgkmcnt(4)
s_nop 0
v_mfma_f32_16x16x32_bf16 v[80:83], v[48:51], v[32:35], v[80:83]
ds_read_b64_tr_b16 v[60:61], v11 offset:36992
v_mfma_f32_16x16x32_bf16 v[128:131], v[48:51], v[36:39], v[128:131]
ds_read_b64_tr_b16 v[62:63], v11 offset:38528
v_mfma_f32_16x16x32_bf16 v[176:179], v[48:51], v[40:43], v[176:179]
v_mfma_f32_16x16x32_bf16 v[224:227], v[48:51], v[44:47], v[224:227]
s_waitcnt lgkmcnt(4)
s_nop 0
v_mfma_f32_16x16x32_bf16 v[84:87], v[52:55], v[32:35], v[84:87]
s_waitcnt lgkmcnt(0)
s_barrier
v_mfma_f32_16x16x32_bf16 v[132:135], v[52:55], v[36:39], v[132:135]
ds_read_b128 v[16:19], v4 offset:49152
v_mfma_f32_16x16x32_bf16 v[180:183], v[52:55], v[40:43], v[180:183]
ds_read_b128 v[20:23], v4 offset:51200
v_mfma_f32_16x16x32_bf16 v[228:231], v[52:55], v[44:47], v[228:231]
ds_read_b64_tr_b16 v[48:49], v6 offset:0
v_mfma_f32_16x16x32_bf16 v[104:107], v[56:59], v[32:35], v[104:107]
ds_read_b64_tr_b16 v[50:51], v6 offset:1536
ds_read_b128 v[24:27], v4 offset:53248
v_mfma_f32_16x16x32_bf16 v[152:155], v[56:59], v[36:39], v[152:155]
ds_read_b128 v[28:31], v4 offset:55296
v_mfma_f32_16x16x32_bf16 v[200:203], v[56:59], v[40:43], v[200:203]
ds_read_b64_tr_b16 v[52:53], v7 offset:0
v_mfma_f32_16x16x32_bf16 v[248:251], v[56:59], v[44:47], v[248:251]
ds_read_b64_tr_b16 v[54:55], v7 offset:1536
v_mfma_f32_16x16x32_bf16 v[108:111], v[60:63], v[32:35], v[108:111]
ds_read_b64_tr_b16 v[56:57], v6 offset:12288
v_mfma_f32_16x16x32_bf16 v[156:159], v[60:63], v[36:39], v[156:159]
ds_read_b64_tr_b16 v[58:59], v6 offset:13824
v_mfma_f32_16x16x32_bf16 v[204:207], v[60:63], v[40:43], v[204:207]
v_mfma_f32_16x16x32_bf16 v[252:255], v[60:63], v[44:47], v[252:255]
s_waitcnt lgkmcnt(4)
s_nop 0
v_mfma_f32_16x16x32_bf16 v[64:67], v[48:51], v[16:19], v[64:67]
ds_read_b64_tr_b16 v[60:61], v7 offset:12288
v_mfma_f32_16x16x32_bf16 v[112:115], v[48:51], v[20:23], v[112:115]
ds_read_b64_tr_b16 v[62:63], v7 offset:13824
v_mfma_f32_16x16x32_bf16 v[160:163], v[48:51], v[24:27], v[160:163]
v_mfma_f32_16x16x32_bf16 v[208:211], v[48:51], v[28:31], v[208:211]
s_waitcnt lgkmcnt(4)
s_nop 0
v_mfma_f32_16x16x32_bf16 v[68:71], v[52:55], v[16:19], v[68:71]
ds_read_b64_tr_b16 v[48:49], v8 offset:0
v_mfma_f32_16x16x32_bf16 v[116:119], v[52:55], v[20:23], v[116:119]
ds_read_b64_tr_b16 v[50:51], v8 offset:1536
v_mfma_f32_16x16x32_bf16 v[164:167], v[52:55], v[24:27], v[164:167]
v_mfma_f32_16x16x32_bf16 v[212:215], v[52:55], v[28:31], v[212:215]
s_waitcnt lgkmcnt(4)
s_nop 0
v_mfma_f32_16x16x32_bf16 v[88:91], v[56:59], v[16:19], v[88:91]
ds_read_b64_tr_b16 v[52:53], v9 offset:0
v_mfma_f32_16x16x32_bf16 v[136:139], v[56:59], v[20:23], v[136:139]
ds_read_b64_tr_b16 v[54:55], v9 offset:1536
v_mfma_f32_16x16x32_bf16 v[184:187], v[56:59], v[24:27], v[184:187]
v_mfma_f32_16x16x32_bf16 v[232:235], v[56:59], v[28:31], v[232:235]
s_waitcnt lgkmcnt(4)
s_nop 0
v_mfma_f32_16x16x32_bf16 v[92:95], v[60:63], v[16:19], v[92:95]
ds_read_b64_tr_b16 v[56:57], v8 offset:12288
v_mfma_f32_16x16x32_bf16 v[140:143], v[60:63], v[20:23], v[140:143]
ds_read_b64_tr_b16 v[58:59], v8 offset:13824
v_mfma_f32_16x16x32_bf16 v[188:191], v[60:63], v[24:27], v[188:191]
v_mfma_f32_16x16x32_bf16 v[236:239], v[60:63], v[28:31], v[236:239]
s_waitcnt lgkmcnt(4)
s_nop 0
v_mfma_f32_16x16x32_bf16 v[72:75], v[48:51], v[16:19], v[72:75]
ds_read_b64_tr_b16 v[60:61], v9 offset:12288
v_mfma_f32_16x16x32_bf16 v[120:123], v[48:51], v[20:23], v[120:123]
ds_read_b64_tr_b16 v[62:63], v9 offset:13824
v_mfma_f32_16x16x32_bf16 v[168:171], v[48:51], v[24:27], v[168:171]
v_mfma_f32_16x16x32_bf16 v[216:219], v[48:51], v[28:31], v[216:219]
s_waitcnt lgkmcnt(4)
s_nop 0
v_mfma_f32_16x16x32_bf16 v[76:79], v[52:55], v[16:19], v[76:79]
ds_read_b64_tr_b16 v[48:49], v6 offset:128
v_mfma_f32_16x16x32_bf16 v[124:127], v[52:55], v[20:23], v[124:127]
ds_read_b64_tr_b16 v[50:51], v6 offset:1664
v_mfma_f32_16x16x32_bf16 v[172:175], v[52:55], v[24:27], v[172:175]
v_mfma_f32_16x16x32_bf16 v[220:223], v[52:55], v[28:31], v[220:223]
s_waitcnt lgkmcnt(4)
s_nop 0
v_mfma_f32_16x16x32_bf16 v[96:99], v[56:59], v[16:19], v[96:99]
ds_read_b64_tr_b16 v[52:53], v7 offset:128
v_mfma_f32_16x16x32_bf16 v[144:147], v[56:59], v[20:23], v[144:147]
ds_read_b64_tr_b16 v[54:55], v7 offset:1664
v_mfma_f32_16x16x32_bf16 v[192:195], v[56:59], v[24:27], v[192:195]
v_mfma_f32_16x16x32_bf16 v[240:243], v[56:59], v[28:31], v[240:243]
s_waitcnt lgkmcnt(4)
s_nop 0
v_mfma_f32_16x16x32_bf16 v[100:103], v[60:63], v[16:19], v[100:103]
ds_read_b64_tr_b16 v[56:57], v6 offset:12416
v_mfma_f32_16x16x32_bf16 v[148:151], v[60:63], v[20:23], v[148:151]
ds_read_b64_tr_b16 v[58:59], v6 offset:13952
v_mfma_f32_16x16x32_bf16 v[196:199], v[60:63], v[24:27], v[196:199]
v_mfma_f32_16x16x32_bf16 v[244:247], v[60:63], v[28:31], v[244:247]
s_waitcnt lgkmcnt(4)
s_nop 0
v_mfma_f32_16x16x32_bf16 v[80:83], v[48:51], v[16:19], v[80:83]
ds_read_b64_tr_b16 v[60:61], v7 offset:12416
v_mfma_f32_16x16x32_bf16 v[128:131], v[48:51], v[20:23], v[128:131]
ds_read_b64_tr_b16 v[62:63], v7 offset:13952
v_mfma_f32_16x16x32_bf16 v[176:179], v[48:51], v[24:27], v[176:179]
v_mfma_f32_16x16x32_bf16 v[224:227], v[48:51], v[28:31], v[224:227]
s_waitcnt lgkmcnt(4)
s_nop 0
v_mfma_f32_16x16x32_bf16 v[84:87], v[52:55], v[16:19], v[84:87]
s_waitcnt lgkmcnt(0)
s_barrier
v_mfma_f32_16x16x32_bf16 v[132:135], v[52:55], v[20:23], v[132:135]
ds_read_b128 v[32:35], v5 offset:49152
v_mfma_f32_16x16x32_bf16 v[180:183], v[52:55], v[24:27], v[180:183]
ds_read_b128 v[36:39], v5 offset:51200
v_mfma_f32_16x16x32_bf16 v[228:231], v[52:55], v[28:31], v[228:231]
ds_read_b64_tr_b16 v[48:49], v6 offset:24576
v_mfma_f32_16x16x32_bf16 v[104:107], v[56:59], v[16:19], v[104:107]
ds_read_b64_tr_b16 v[50:51], v6 offset:26112
ds_read_b128 v[40:43], v5 offset:53248
v_mfma_f32_16x16x32_bf16 v[152:155], v[56:59], v[20:23], v[152:155]
ds_read_b128 v[44:47], v5 offset:55296
v_mfma_f32_16x16x32_bf16 v[200:203], v[56:59], v[24:27], v[200:203]
ds_read_b64_tr_b16 v[52:53], v7 offset:24576
v_mfma_f32_16x16x32_bf16 v[248:251], v[56:59], v[28:31], v[248:251]
ds_read_b64_tr_b16 v[54:55], v7 offset:26112
v_mfma_f32_16x16x32_bf16 v[108:111], v[60:63], v[16:19], v[108:111]
ds_read_b64_tr_b16 v[56:57], v6 offset:36864
v_mfma_f32_16x16x32_bf16 v[156:159], v[60:63], v[20:23], v[156:159]
ds_read_b64_tr_b16 v[58:59], v6 offset:38400
v_mfma_f32_16x16x32_bf16 v[204:207], v[60:63], v[24:27], v[204:207]
v_mfma_f32_16x16x32_bf16 v[252:255], v[60:63], v[28:31], v[252:255]
s_waitcnt lgkmcnt(4)
s_nop 0
v_mfma_f32_16x16x32_bf16 v[64:67], v[48:51], v[32:35], v[64:67]
ds_read_b64_tr_b16 v[60:61], v7 offset:36864
v_mfma_f32_16x16x32_bf16 v[112:115], v[48:51], v[36:39], v[112:115]
ds_read_b64_tr_b16 v[62:63], v7 offset:38400
v_mfma_f32_16x16x32_bf16 v[160:163], v[48:51], v[40:43], v[160:163]
v_mfma_f32_16x16x32_bf16 v[208:211], v[48:51], v[44:47], v[208:211]
s_waitcnt lgkmcnt(4)
s_nop 0
v_mfma_f32_16x16x32_bf16 v[68:71], v[52:55], v[32:35], v[68:71]
ds_read_b64_tr_b16 v[48:49], v8 offset:24576
v_mfma_f32_16x16x32_bf16 v[116:119], v[52:55], v[36:39], v[116:119]
ds_read_b64_tr_b16 v[50:51], v8 offset:26112
v_mfma_f32_16x16x32_bf16 v[164:167], v[52:55], v[40:43], v[164:167]
v_mfma_f32_16x16x32_bf16 v[212:215], v[52:55], v[44:47], v[212:215]
s_waitcnt lgkmcnt(4)
s_nop 0
v_mfma_f32_16x16x32_bf16 v[88:91], v[56:59], v[32:35], v[88:91]
ds_read_b64_tr_b16 v[52:53], v9 offset:24576
v_mfma_f32_16x16x32_bf16 v[136:139], v[56:59], v[36:39], v[136:139]
ds_read_b64_tr_b16 v[54:55], v9 offset:26112
v_mfma_f32_16x16x32_bf16 v[184:187], v[56:59], v[40:43], v[184:187]
v_mfma_f32_16x16x32_bf16 v[232:235], v[56:59], v[44:47], v[232:235]
s_waitcnt lgkmcnt(4)
s_nop 0
v_mfma_f32_16x16x32_bf16 v[92:95], v[60:63], v[32:35], v[92:95]
ds_read_b64_tr_b16 v[56:57], v8 offset:36864
v_mfma_f32_16x16x32_bf16 v[140:143], v[60:63], v[36:39], v[140:143]
ds_read_b64_tr_b16 v[58:59], v8 offset:38400
v_mfma_f32_16x16x32_bf16 v[188:191], v[60:63], v[40:43], v[188:191]
v_mfma_f32_16x16x32_bf16 v[236:239], v[60:63], v[44:47], v[236:239]
s_waitcnt lgkmcnt(4)
s_nop 0
v_mfma_f32_16x16x32_bf16 v[72:75], v[48:51], v[32:35], v[72:75]
ds_read_b64_tr_b16 v[60:61], v9 offset:36864
v_mfma_f32_16x16x32_bf16 v[120:123], v[48:51], v[36:39], v[120:123]
ds_read_b64_tr_b16 v[62:63], v9 offset:38400
v_mfma_f32_16x16x32_bf16 v[168:171], v[48:51], v[40:43], v[168:171]
v_mfma_f32_16x16x32_bf16 v[216:219], v[48:51], v[44:47], v[216:219]
s_waitcnt lgkmcnt(4)
s_nop 0
v_mfma_f32_16x16x32_bf16 v[76:79], v[52:55], v[32:35], v[76:79]
ds_read_b64_tr_b16 v[48:49], v6 offset:24704
v_mfma_f32_16x16x32_bf16 v[124:127], v[52:55], v[36:39], v[124:127]
ds_read_b64_tr_b16 v[50:51], v6 offset:26240
v_mfma_f32_16x16x32_bf16 v[172:175], v[52:55], v[40:43], v[172:175]
v_mfma_f32_16x16x32_bf16 v[220:223], v[52:55], v[44:47], v[220:223]
s_waitcnt lgkmcnt(4)
s_nop 0
v_mfma_f32_16x16x32_bf16 v[96:99], v[56:59], v[32:35], v[96:99]
ds_read_b64_tr_b16 v[52:53], v7 offset:24704
v_mfma_f32_16x16x32_bf16 v[144:147], v[56:59], v[36:39], v[144:147]
ds_read_b64_tr_b16 v[54:55], v7 offset:26240
v_mfma_f32_16x16x32_bf16 v[192:195], v[56:59], v[40:43], v[192:195]
v_mfma_f32_16x16x32_bf16 v[240:243], v[56:59], v[44:47], v[240:243]
s_waitcnt lgkmcnt(4)
s_nop 0
v_mfma_f32_16x16x32_bf16 v[100:103], v[60:63], v[32:35], v[100:103]
ds_read_b64_tr_b16 v[56:57], v6 offset:36992
v_mfma_f32_16x16x32_bf16 v[148:151], v[60:63], v[36:39], v[148:151]
ds_read_b64_tr_b16 v[58:59], v6 offset:38528
v_mfma_f32_16x16x32_bf16 v[196:199], v[60:63], v[40:43], v[196:199]
v_mfma_f32_16x16x32_bf16 v[244:247], v[60:63], v[44:47], v[244:247]
s_waitcnt lgkmcnt(4)
s_nop 0
v_mfma_f32_16x16x32_bf16 v[80:83], v[48:51], v[32:35], v[80:83]
ds_read_b64_tr_b16 v[60:61], v7 offset:36992
v_mfma_f32_16x16x32_bf16 v[128:131], v[48:51], v[36:39], v[128:131]
ds_read_b64_tr_b16 v[62:63], v7 offset:38528
v_mfma_f32_16x16x32_bf16 v[176:179], v[48:51], v[40:43], v[176:179]
v_mfma_f32_16x16x32_bf16 v[224:227], v[48:51], v[44:47], v[224:227]
s_waitcnt lgkmcnt(4)
s_nop 0
v_mfma_f32_16x16x32_bf16 v[84:87], v[52:55], v[32:35], v[84:87]
s_waitcnt lgkmcnt(0)
s_barrier
v_mfma_f32_16x16x32_bf16 v[132:135], v[52:55], v[36:39], v[132:135]
ds_read_b128 v[16:19], v4 offset:32768
v_mfma_f32_16x16x32_bf16 v[180:183], v[52:55], v[40:43], v[180:183]
ds_read_b128 v[20:23], v4 offset:34816
v_mfma_f32_16x16x32_bf16 v[228:231], v[52:55], v[44:47], v[228:231]
ds_read_b64_tr_b16 v[48:49], v10 offset:0
v_mfma_f32_16x16x32_bf16 v[104:107], v[56:59], v[32:35], v[104:107]
ds_read_b64_tr_b16 v[50:51], v10 offset:1536
ds_read_b128 v[24:27], v4 offset:36864
v_mfma_f32_16x16x32_bf16 v[152:155], v[56:59], v[36:39], v[152:155]
ds_read_b128 v[28:31], v4 offset:38912
v_mfma_f32_16x16x32_bf16 v[200:203], v[56:59], v[40:43], v[200:203]
ds_read_b64_tr_b16 v[52:53], v11 offset:0
v_mfma_f32_16x16x32_bf16 v[248:251], v[56:59], v[44:47], v[248:251]
ds_read_b64_tr_b16 v[54:55], v11 offset:1536
v_mfma_f32_16x16x32_bf16 v[108:111], v[60:63], v[32:35], v[108:111]
ds_read_b64_tr_b16 v[56:57], v10 offset:12288
v_mfma_f32_16x16x32_bf16 v[156:159], v[60:63], v[36:39], v[156:159]
ds_read_b64_tr_b16 v[58:59], v10 offset:13824
v_mfma_f32_16x16x32_bf16 v[204:207], v[60:63], v[40:43], v[204:207]
v_mfma_f32_16x16x32_bf16 v[252:255], v[60:63], v[44:47], v[252:255]
s_waitcnt lgkmcnt(4)
s_nop 0
v_mfma_f32_16x16x32_bf16 v[64:67], v[48:51], v[16:19], v[64:67]
ds_read_b64_tr_b16 v[60:61], v11 offset:12288
v_mfma_f32_16x16x32_bf16 v[112:115], v[48:51], v[20:23], v[112:115]
ds_read_b64_tr_b16 v[62:63], v11 offset:13824
v_mfma_f32_16x16x32_bf16 v[160:163], v[48:51], v[24:27], v[160:163]
v_mfma_f32_16x16x32_bf16 v[208:211], v[48:51], v[28:31], v[208:211]
s_waitcnt lgkmcnt(4)
s_nop 0
v_mfma_f32_16x16x32_bf16 v[68:71], v[52:55], v[16:19], v[68:71]
ds_read_b64_tr_b16 v[48:49], v12 offset:0
v_mfma_f32_16x16x32_bf16 v[116:119], v[52:55], v[20:23], v[116:119]
ds_read_b64_tr_b16 v[50:51], v12 offset:1536
v_mfma_f32_16x16x32_bf16 v[164:167], v[52:55], v[24:27], v[164:167]
v_mfma_f32_16x16x32_bf16 v[212:215], v[52:55], v[28:31], v[212:215]
s_waitcnt lgkmcnt(4)
s_nop 0
v_mfma_f32_16x16x32_bf16 v[88:91], v[56:59], v[16:19], v[88:91]
ds_read_b64_tr_b16 v[52:53], v13 offset:0
v_mfma_f32_16x16x32_bf16 v[136:139], v[56:59], v[20:23], v[136:139]
ds_read_b64_tr_b16 v[54:55], v13 offset:1536
v_mfma_f32_16x16x32_bf16 v[184:187], v[56:59], v[24:27], v[184:187]
v_mfma_f32_16x16x32_bf16 v[232:235], v[56:59], v[28:31], v[232:235]
s_waitcnt lgkmcnt(4)
s_nop 0
v_mfma_f32_16x16x32_bf16 v[92:95], v[60:63], v[16:19], v[92:95]
ds_read_b64_tr_b16 v[56:57], v12 offset:12288
v_mfma_f32_16x16x32_bf16 v[140:143], v[60:63], v[20:23], v[140:143]
ds_read_b64_tr_b16 v[58:59], v12 offset:13824
v_mfma_f32_16x16x32_bf16 v[188:191], v[60:63], v[24:27], v[188:191]
v_mfma_f32_16x16x32_bf16 v[236:239], v[60:63], v[28:31], v[236:239]
s_waitcnt lgkmcnt(4)
s_nop 0
v_mfma_f32_16x16x32_bf16 v[72:75], v[48:51], v[16:19], v[72:75]
ds_read_b64_tr_b16 v[60:61], v13 offset:12288
v_mfma_f32_16x16x32_bf16 v[120:123], v[48:51], v[20:23], v[120:123]
ds_read_b64_tr_b16 v[62:63], v13 offset:13824
v_mfma_f32_16x16x32_bf16 v[168:171], v[48:51], v[24:27], v[168:171]
v_mfma_f32_16x16x32_bf16 v[216:219], v[48:51], v[28:31], v[216:219]
s_waitcnt lgkmcnt(4)
s_nop 0
v_mfma_f32_16x16x32_bf16 v[76:79], v[52:55], v[16:19], v[76:79]
ds_read_b64_tr_b16 v[48:49], v10 offset:128
v_mfma_f32_16x16x32_bf16 v[124:127], v[52:55], v[20:23], v[124:127]
ds_read_b64_tr_b16 v[50:51], v10 offset:1664
v_mfma_f32_16x16x32_bf16 v[172:175], v[52:55], v[24:27], v[172:175]
v_mfma_f32_16x16x32_bf16 v[220:223], v[52:55], v[28:31], v[220:223]
s_waitcnt lgkmcnt(4)
s_nop 0
v_mfma_f32_16x16x32_bf16 v[96:99], v[56:59], v[16:19], v[96:99]
ds_read_b64_tr_b16 v[52:53], v11 offset:128
v_mfma_f32_16x16x32_bf16 v[144:147], v[56:59], v[20:23], v[144:147]
ds_read_b64_tr_b16 v[54:55], v11 offset:1664
v_mfma_f32_16x16x32_bf16 v[192:195], v[56:59], v[24:27], v[192:195]
v_mfma_f32_16x16x32_bf16 v[240:243], v[56:59], v[28:31], v[240:243]
s_waitcnt lgkmcnt(4)
s_nop 0
v_mfma_f32_16x16x32_bf16 v[100:103], v[60:63], v[16:19], v[100:103]
ds_read_b64_tr_b16 v[56:57], v10 offset:12416
v_mfma_f32_16x16x32_bf16 v[148:151], v[60:63], v[20:23], v[148:151]
ds_read_b64_tr_b16 v[58:59], v10 offset:13952
v_mfma_f32_16x16x32_bf16 v[196:199], v[60:63], v[24:27], v[196:199]
v_mfma_f32_16x16x32_bf16 v[244:247], v[60:63], v[28:31], v[244:247]
s_waitcnt lgkmcnt(4)
s_nop 0
v_mfma_f32_16x16x32_bf16 v[80:83], v[48:51], v[16:19], v[80:83]
ds_read_b64_tr_b16 v[60:61], v11 offset:12416
v_mfma_f32_16x16x32_bf16 v[128:131], v[48:51], v[20:23], v[128:131]
ds_read_b64_tr_b16 v[62:63], v11 offset:13952
v_mfma_f32_16x16x32_bf16 v[176:179], v[48:51], v[24:27], v[176:179]
v_mfma_f32_16x16x32_bf16 v[224:227], v[48:51], v[28:31], v[224:227]
s_waitcnt lgkmcnt(4)
s_nop 0
v_mfma_f32_16x16x32_bf16 v[84:87], v[52:55], v[16:19], v[84:87]
s_waitcnt lgkmcnt(0)
s_barrier
v_mfma_f32_16x16x32_bf16 v[132:135], v[52:55], v[20:23], v[132:135]
ds_read_b128 v[32:35], v5 offset:32768
v_mfma_f32_16x16x32_bf16 v[180:183], v[52:55], v[24:27], v[180:183]
ds_read_b128 v[36:39], v5 offset:34816
v_mfma_f32_16x16x32_bf16 v[228:231], v[52:55], v[28:31], v[228:231]
ds_read_b64_tr_b16 v[48:49], v10 offset:24576
v_mfma_f32_16x16x32_bf16 v[104:107], v[56:59], v[16:19], v[104:107]
ds_read_b64_tr_b16 v[50:51], v10 offset:26112
ds_read_b128 v[40:43], v5 offset:36864
v_mfma_f32_16x16x32_bf16 v[152:155], v[56:59], v[20:23], v[152:155]
ds_read_b128 v[44:47], v5 offset:38912
v_mfma_f32_16x16x32_bf16 v[200:203], v[56:59], v[24:27], v[200:203]
ds_read_b64_tr_b16 v[52:53], v11 offset:24576
v_mfma_f32_16x16x32_bf16 v[248:251], v[56:59], v[28:31], v[248:251]
ds_read_b64_tr_b16 v[54:55], v11 offset:26112
v_mfma_f32_16x16x32_bf16 v[108:111], v[60:63], v[16:19], v[108:111]
ds_read_b64_tr_b16 v[56:57], v10 offset:36864
v_mfma_f32_16x16x32_bf16 v[156:159], v[60:63], v[20:23], v[156:159]
ds_read_b64_tr_b16 v[58:59], v10 offset:38400
v_mfma_f32_16x16x32_bf16 v[204:207], v[60:63], v[24:27], v[204:207]
v_mfma_f32_16x16x32_bf16 v[252:255], v[60:63], v[28:31], v[252:255]
s_waitcnt lgkmcnt(4)
s_nop 0
v_mfma_f32_16x16x32_bf16 v[64:67], v[48:51], v[32:35], v[64:67]
ds_read_b64_tr_b16 v[60:61], v11 offset:36864
v_mfma_f32_16x16x32_bf16 v[112:115], v[48:51], v[36:39], v[112:115]
ds_read_b64_tr_b16 v[62:63], v11 offset:38400
v_mfma_f32_16x16x32_bf16 v[160:163], v[48:51], v[40:43], v[160:163]
v_mfma_f32_16x16x32_bf16 v[208:211], v[48:51], v[44:47], v[208:211]
s_waitcnt lgkmcnt(4)
s_nop 0
v_mfma_f32_16x16x32_bf16 v[68:71], v[52:55], v[32:35], v[68:71]
ds_read_b64_tr_b16 v[48:49], v12 offset:24576
v_mfma_f32_16x16x32_bf16 v[116:119], v[52:55], v[36:39], v[116:119]
ds_read_b64_tr_b16 v[50:51], v12 offset:26112
v_mfma_f32_16x16x32_bf16 v[164:167], v[52:55], v[40:43], v[164:167]
v_mfma_f32_16x16x32_bf16 v[212:215], v[52:55], v[44:47], v[212:215]
s_waitcnt lgkmcnt(4)
s_nop 0
v_mfma_f32_16x16x32_bf16 v[88:91], v[56:59], v[32:35], v[88:91]
ds_read_b64_tr_b16 v[52:53], v13 offset:24576
v_mfma_f32_16x16x32_bf16 v[136:139], v[56:59], v[36:39], v[136:139]
ds_read_b64_tr_b16 v[54:55], v13 offset:26112
v_mfma_f32_16x16x32_bf16 v[184:187], v[56:59], v[40:43], v[184:187]
v_mfma_f32_16x16x32_bf16 v[232:235], v[56:59], v[44:47], v[232:235]
s_waitcnt lgkmcnt(4)
s_nop 0
v_mfma_f32_16x16x32_bf16 v[92:95], v[60:63], v[32:35], v[92:95]
ds_read_b64_tr_b16 v[56:57], v12 offset:36864
v_mfma_f32_16x16x32_bf16 v[140:143], v[60:63], v[36:39], v[140:143]
ds_read_b64_tr_b16 v[58:59], v12 offset:38400
v_mfma_f32_16x16x32_bf16 v[188:191], v[60:63], v[40:43], v[188:191]
v_mfma_f32_16x16x32_bf16 v[236:239], v[60:63], v[44:47], v[236:239]
s_waitcnt lgkmcnt(4)
s_nop 0
v_mfma_f32_16x16x32_bf16 v[72:75], v[48:51], v[32:35], v[72:75]
ds_read_b64_tr_b16 v[60:61], v13 offset:36864
v_mfma_f32_16x16x32_bf16 v[120:123], v[48:51], v[36:39], v[120:123]
ds_read_b64_tr_b16 v[62:63], v13 offset:38400
v_mfma_f32_16x16x32_bf16 v[168:171], v[48:51], v[40:43], v[168:171]
v_mfma_f32_16x16x32_bf16 v[216:219], v[48:51], v[44:47], v[216:219]
s_waitcnt lgkmcnt(4)
s_nop 0
v_mfma_f32_16x16x32_bf16 v[76:79], v[52:55], v[32:35], v[76:79]
ds_read_b64_tr_b16 v[48:49], v10 offset:24704
v_mfma_f32_16x16x32_bf16 v[124:127], v[52:55], v[36:39], v[124:127]
ds_read_b64_tr_b16 v[50:51], v10 offset:26240
v_mfma_f32_16x16x32_bf16 v[172:175], v[52:55], v[40:43], v[172:175]
v_mfma_f32_16x16x32_bf16 v[220:223], v[52:55], v[44:47], v[220:223]
s_waitcnt lgkmcnt(4)
s_nop 0
v_mfma_f32_16x16x32_bf16 v[96:99], v[56:59], v[32:35], v[96:99]
ds_read_b64_tr_b16 v[52:53], v11 offset:24704
v_mfma_f32_16x16x32_bf16 v[144:147], v[56:59], v[36:39], v[144:147]
ds_read_b64_tr_b16 v[54:55], v11 offset:26240
v_mfma_f32_16x16x32_bf16 v[192:195], v[56:59], v[40:43], v[192:195]
v_mfma_f32_16x16x32_bf16 v[240:243], v[56:59], v[44:47], v[240:243]
s_waitcnt lgkmcnt(4)
s_nop 0
v_mfma_f32_16x16x32_bf16 v[100:103], v[60:63], v[32:35], v[100:103]
ds_read_b64_tr_b16 v[56:57], v10 offset:36992
v_mfma_f32_16x16x32_bf16 v[148:151], v[60:63], v[36:39], v[148:151]
ds_read_b64_tr_b16 v[58:59], v10 offset:38528
v_mfma_f32_16x16x32_bf16 v[196:199], v[60:63], v[40:43], v[196:199]
v_mfma_f32_16x16x32_bf16 v[244:247], v[60:63], v[44:47], v[244:247]
s_waitcnt lgkmcnt(4)
s_nop 0
v_mfma_f32_16x16x32_bf16 v[80:83], v[48:51], v[32:35], v[80:83]
ds_read_b64_tr_b16 v[60:61], v11 offset:36992
v_mfma_f32_16x16x32_bf16 v[128:131], v[48:51], v[36:39], v[128:131]
ds_read_b64_tr_b16 v[62:63], v11 offset:38528
v_mfma_f32_16x16x32_bf16 v[176:179], v[48:51], v[40:43], v[176:179]
v_mfma_f32_16x16x32_bf16 v[224:227], v[48:51], v[44:47], v[224:227]
s_waitcnt lgkmcnt(4)
s_nop 0
v_mfma_f32_16x16x32_bf16 v[84:87], v[52:55], v[32:35], v[84:87]
s_waitcnt lgkmcnt(0)
s_barrier
v_mfma_f32_16x16x32_bf16 v[132:135], v[52:55], v[36:39], v[132:135]
ds_read_b128 v[16:19], v4 offset:16384
v_mfma_f32_16x16x32_bf16 v[180:183], v[52:55], v[40:43], v[180:183]
ds_read_b128 v[20:23], v4 offset:18432
v_mfma_f32_16x16x32_bf16 v[228:231], v[52:55], v[44:47], v[228:231]
ds_read_b64_tr_b16 v[48:49], v6 offset:0
v_mfma_f32_16x16x32_bf16 v[104:107], v[56:59], v[32:35], v[104:107]
ds_read_b64_tr_b16 v[50:51], v6 offset:1536
ds_read_b128 v[24:27], v4 offset:20480
v_mfma_f32_16x16x32_bf16 v[152:155], v[56:59], v[36:39], v[152:155]
ds_read_b128 v[28:31], v4 offset:22528
v_mfma_f32_16x16x32_bf16 v[200:203], v[56:59], v[40:43], v[200:203]
ds_read_b64_tr_b16 v[52:53], v7 offset:0
v_mfma_f32_16x16x32_bf16 v[248:251], v[56:59], v[44:47], v[248:251]
ds_read_b64_tr_b16 v[54:55], v7 offset:1536
v_mfma_f32_16x16x32_bf16 v[108:111], v[60:63], v[32:35], v[108:111]
ds_read_b64_tr_b16 v[56:57], v6 offset:12288
v_mfma_f32_16x16x32_bf16 v[156:159], v[60:63], v[36:39], v[156:159]
ds_read_b64_tr_b16 v[58:59], v6 offset:13824
v_mfma_f32_16x16x32_bf16 v[204:207], v[60:63], v[40:43], v[204:207]
v_mfma_f32_16x16x32_bf16 v[252:255], v[60:63], v[44:47], v[252:255]
s_waitcnt lgkmcnt(4)
s_nop 0
v_mfma_f32_16x16x32_bf16 v[64:67], v[48:51], v[16:19], v[64:67]
ds_read_b64_tr_b16 v[60:61], v7 offset:12288
v_mfma_f32_16x16x32_bf16 v[112:115], v[48:51], v[20:23], v[112:115]
ds_read_b64_tr_b16 v[62:63], v7 offset:13824
v_mfma_f32_16x16x32_bf16 v[160:163], v[48:51], v[24:27], v[160:163]
v_mfma_f32_16x16x32_bf16 v[208:211], v[48:51], v[28:31], v[208:211]
s_waitcnt lgkmcnt(4)
s_nop 0
v_mfma_f32_16x16x32_bf16 v[68:71], v[52:55], v[16:19], v[68:71]
ds_read_b64_tr_b16 v[48:49], v8 offset:0
v_mfma_f32_16x16x32_bf16 v[116:119], v[52:55], v[20:23], v[116:119]
ds_read_b64_tr_b16 v[50:51], v8 offset:1536
v_mfma_f32_16x16x32_bf16 v[164:167], v[52:55], v[24:27], v[164:167]
v_mfma_f32_16x16x32_bf16 v[212:215], v[52:55], v[28:31], v[212:215]
s_waitcnt lgkmcnt(4)
s_nop 0
v_mfma_f32_16x16x32_bf16 v[88:91], v[56:59], v[16:19], v[88:91]
ds_read_b64_tr_b16 v[52:53], v9 offset:0
v_mfma_f32_16x16x32_bf16 v[136:139], v[56:59], v[20:23], v[136:139]
ds_read_b64_tr_b16 v[54:55], v9 offset:1536
v_mfma_f32_16x16x32_bf16 v[184:187], v[56:59], v[24:27], v[184:187]
v_mfma_f32_16x16x32_bf16 v[232:235], v[56:59], v[28:31], v[232:235]
s_waitcnt lgkmcnt(4)
s_nop 0
v_mfma_f32_16x16x32_bf16 v[92:95], v[60:63], v[16:19], v[92:95]
ds_read_b64_tr_b16 v[56:57], v8 offset:12288
v_mfma_f32_16x16x32_bf16 v[140:143], v[60:63], v[20:23], v[140:143]
ds_read_b64_tr_b16 v[58:59], v8 offset:13824
v_mfma_f32_16x16x32_bf16 v[188:191], v[60:63], v[24:27], v[188:191]
v_mfma_f32_16x16x32_bf16 v[236:239], v[60:63], v[28:31], v[236:239]
s_waitcnt lgkmcnt(4)
s_nop 0
v_mfma_f32_16x16x32_bf16 v[72:75], v[48:51], v[16:19], v[72:75]
ds_read_b64_tr_b16 v[60:61], v9 offset:12288
v_mfma_f32_16x16x32_bf16 v[120:123], v[48:51], v[20:23], v[120:123]
ds_read_b64_tr_b16 v[62:63], v9 offset:13824
v_mfma_f32_16x16x32_bf16 v[168:171], v[48:51], v[24:27], v[168:171]
v_mfma_f32_16x16x32_bf16 v[216:219], v[48:51], v[28:31], v[216:219]
s_waitcnt lgkmcnt(4)
s_nop 0
v_mfma_f32_16x16x32_bf16 v[76:79], v[52:55], v[16:19], v[76:79]
ds_read_b64_tr_b16 v[48:49], v6 offset:128
v_mfma_f32_16x16x32_bf16 v[124:127], v[52:55], v[20:23], v[124:127]
ds_read_b64_tr_b16 v[50:51], v6 offset:1664
v_mfma_f32_16x16x32_bf16 v[172:175], v[52:55], v[24:27], v[172:175]
v_mfma_f32_16x16x32_bf16 v[220:223], v[52:55], v[28:31], v[220:223]
s_waitcnt lgkmcnt(4)
s_nop 0
v_mfma_f32_16x16x32_bf16 v[96:99], v[56:59], v[16:19], v[96:99]
ds_read_b64_tr_b16 v[52:53], v7 offset:128
v_mfma_f32_16x16x32_bf16 v[144:147], v[56:59], v[20:23], v[144:147]
ds_read_b64_tr_b16 v[54:55], v7 offset:1664
v_mfma_f32_16x16x32_bf16 v[192:195], v[56:59], v[24:27], v[192:195]
v_mfma_f32_16x16x32_bf16 v[240:243], v[56:59], v[28:31], v[240:243]
s_waitcnt lgkmcnt(4)
s_nop 0
v_mfma_f32_16x16x32_bf16 v[100:103], v[60:63], v[16:19], v[100:103]
ds_read_b64_tr_b16 v[56:57], v6 offset:12416
v_mfma_f32_16x16x32_bf16 v[148:151], v[60:63], v[20:23], v[148:151]
ds_read_b64_tr_b16 v[58:59], v6 offset:13952
v_mfma_f32_16x16x32_bf16 v[196:199], v[60:63], v[24:27], v[196:199]
v_mfma_f32_16x16x32_bf16 v[244:247], v[60:63], v[28:31], v[244:247]
s_waitcnt lgkmcnt(4)
s_nop 0
v_mfma_f32_16x16x32_bf16 v[80:83], v[48:51], v[16:19], v[80:83]
ds_read_b64_tr_b16 v[60:61], v7 offset:12416
v_mfma_f32_16x16x32_bf16 v[128:131], v[48:51], v[20:23], v[128:131]
ds_read_b64_tr_b16 v[62:63], v7 offset:13952
v_mfma_f32_16x16x32_bf16 v[176:179], v[48:51], v[24:27], v[176:179]
v_mfma_f32_16x16x32_bf16 v[224:227], v[48:51], v[28:31], v[224:227]
s_waitcnt lgkmcnt(4)
s_nop 0
v_mfma_f32_16x16x32_bf16 v[84:87], v[52:55], v[16:19], v[84:87]
s_waitcnt lgkmcnt(0)
s_barrier
v_mfma_f32_16x16x32_bf16 v[132:135], v[52:55], v[20:23], v[132:135]
ds_read_b128 v[32:35], v5 offset:16384
v_mfma_f32_16x16x32_bf16 v[180:183], v[52:55], v[24:27], v[180:183]
ds_read_b128 v[36:39], v5 offset:18432
v_mfma_f32_16x16x32_bf16 v[228:231], v[52:55], v[28:31], v[228:231]
ds_read_b64_tr_b16 v[48:49], v6 offset:24576
v_mfma_f32_16x16x32_bf16 v[104:107], v[56:59], v[16:19], v[104:107]
ds_read_b64_tr_b16 v[50:51], v6 offset:26112
ds_read_b128 v[40:43], v5 offset:20480
v_mfma_f32_16x16x32_bf16 v[152:155], v[56:59], v[20:23], v[152:155]
ds_read_b128 v[44:47], v5 offset:22528
v_mfma_f32_16x16x32_bf16 v[200:203], v[56:59], v[24:27], v[200:203]
ds_read_b64_tr_b16 v[52:53], v7 offset:24576
v_mfma_f32_16x16x32_bf16 v[248:251], v[56:59], v[28:31], v[248:251]
ds_read_b64_tr_b16 v[54:55], v7 offset:26112
v_mfma_f32_16x16x32_bf16 v[108:111], v[60:63], v[16:19], v[108:111]
ds_read_b64_tr_b16 v[56:57], v6 offset:36864
v_mfma_f32_16x16x32_bf16 v[156:159], v[60:63], v[20:23], v[156:159]
ds_read_b64_tr_b16 v[58:59], v6 offset:38400
v_mfma_f32_16x16x32_bf16 v[204:207], v[60:63], v[24:27], v[204:207]
v_mfma_f32_16x16x32_bf16 v[252:255], v[60:63], v[28:31], v[252:255]
s_waitcnt lgkmcnt(4)
s_nop 0
v_mfma_f32_16x16x32_bf16 v[64:67], v[48:51], v[32:35], v[64:67]
ds_read_b64_tr_b16 v[60:61], v7 offset:36864
v_mfma_f32_16x16x32_bf16 v[112:115], v[48:51], v[36:39], v[112:115]
ds_read_b64_tr_b16 v[62:63], v7 offset:38400
v_mfma_f32_16x16x32_bf16 v[160:163], v[48:51], v[40:43], v[160:163]
v_mfma_f32_16x16x32_bf16 v[208:211], v[48:51], v[44:47], v[208:211]
s_waitcnt lgkmcnt(4)
s_nop 0
v_mfma_f32_16x16x32_bf16 v[68:71], v[52:55], v[32:35], v[68:71]
ds_read_b64_tr_b16 v[48:49], v8 offset:24576
v_mfma_f32_16x16x32_bf16 v[116:119], v[52:55], v[36:39], v[116:119]
ds_read_b64_tr_b16 v[50:51], v8 offset:26112
v_mfma_f32_16x16x32_bf16 v[164:167], v[52:55], v[40:43], v[164:167]
v_mfma_f32_16x16x32_bf16 v[212:215], v[52:55], v[44:47], v[212:215]
s_waitcnt lgkmcnt(4)
s_nop 0
v_mfma_f32_16x16x32_bf16 v[88:91], v[56:59], v[32:35], v[88:91]
ds_read_b64_tr_b16 v[52:53], v9 offset:24576
v_mfma_f32_16x16x32_bf16 v[136:139], v[56:59], v[36:39], v[136:139]
ds_read_b64_tr_b16 v[54:55], v9 offset:26112
v_mfma_f32_16x16x32_bf16 v[184:187], v[56:59], v[40:43], v[184:187]
v_mfma_f32_16x16x32_bf16 v[232:235], v[56:59], v[44:47], v[232:235]
s_waitcnt lgkmcnt(4)
s_nop 0
v_mfma_f32_16x16x32_bf16 v[92:95], v[60:63], v[32:35], v[92:95]
ds_read_b64_tr_b16 v[56:57], v8 offset:36864
v_mfma_f32_16x16x32_bf16 v[140:143], v[60:63], v[36:39], v[140:143]
ds_read_b64_tr_b16 v[58:59], v8 offset:38400
v_mfma_f32_16x16x32_bf16 v[188:191], v[60:63], v[40:43], v[188:191]
v_mfma_f32_16x16x32_bf16 v[236:239], v[60:63], v[44:47], v[236:239]
s_waitcnt lgkmcnt(4)
s_nop 0
v_mfma_f32_16x16x32_bf16 v[72:75], v[48:51], v[32:35], v[72:75]
ds_read_b64_tr_b16 v[60:61], v9 offset:36864
v_mfma_f32_16x16x32_bf16 v[120:123], v[48:51], v[36:39], v[120:123]
ds_read_b64_tr_b16 v[62:63], v9 offset:38400
v_mfma_f32_16x16x32_bf16 v[168:171], v[48:51], v[40:43], v[168:171]
v_mfma_f32_16x16x32_bf16 v[216:219], v[48:51], v[44:47], v[216:219]
s_waitcnt lgkmcnt(4)
s_nop 0
v_mfma_f32_16x16x32_bf16 v[76:79], v[52:55], v[32:35], v[76:79]
ds_read_b64_tr_b16 v[48:49], v6 offset:24704
v_mfma_f32_16x16x32_bf16 v[124:127], v[52:55], v[36:39], v[124:127]
ds_read_b64_tr_b16 v[50:51], v6 offset:26240
v_mfma_f32_16x16x32_bf16 v[172:175], v[52:55], v[40:43], v[172:175]
v_mfma_f32_16x16x32_bf16 v[220:223], v[52:55], v[44:47], v[220:223]
s_waitcnt lgkmcnt(4)
s_nop 0
v_mfma_f32_16x16x32_bf16 v[96:99], v[56:59], v[32:35], v[96:99]
ds_read_b64_tr_b16 v[52:53], v7 offset:24704
v_mfma_f32_16x16x32_bf16 v[144:147], v[56:59], v[36:39], v[144:147]
ds_read_b64_tr_b16 v[54:55], v7 offset:26240
v_mfma_f32_16x16x32_bf16 v[192:195], v[56:59], v[40:43], v[192:195]
v_mfma_f32_16x16x32_bf16 v[240:243], v[56:59], v[44:47], v[240:243]
s_waitcnt lgkmcnt(4)
s_nop 0
v_mfma_f32_16x16x32_bf16 v[100:103], v[60:63], v[32:35], v[100:103]
ds_read_b64_tr_b16 v[56:57], v6 offset:36992
v_mfma_f32_16x16x32_bf16 v[148:151], v[60:63], v[36:39], v[148:151]
ds_read_b64_tr_b16 v[58:59], v6 offset:38528
v_mfma_f32_16x16x32_bf16 v[196:199], v[60:63], v[40:43], v[196:199]
v_mfma_f32_16x16x32_bf16 v[244:247], v[60:63], v[44:47], v[244:247]
s_waitcnt lgkmcnt(4)
s_nop 0
v_mfma_f32_16x16x32_bf16 v[80:83], v[48:51], v[32:35], v[80:83]
ds_read_b64_tr_b16 v[60:61], v7 offset:36992
v_mfma_f32_16x16x32_bf16 v[128:131], v[48:51], v[36:39], v[128:131]
ds_read_b64_tr_b16 v[62:63], v7 offset:38528
v_mfma_f32_16x16x32_bf16 v[176:179], v[48:51], v[40:43], v[176:179]
v_mfma_f32_16x16x32_bf16 v[224:227], v[48:51], v[44:47], v[224:227]
s_waitcnt lgkmcnt(4)
s_nop 0
v_mfma_f32_16x16x32_bf16 v[84:87], v[52:55], v[32:35], v[84:87]
s_waitcnt lgkmcnt(0)
s_barrier
v_mfma_f32_16x16x32_bf16 v[132:135], v[52:55], v[36:39], v[132:135]
ds_read_b128 v[16:19], v4 offset:0
v_mfma_f32_16x16x32_bf16 v[180:183], v[52:55], v[40:43], v[180:183]
ds_read_b128 v[20:23], v4 offset:2048
v_mfma_f32_16x16x32_bf16 v[228:231], v[52:55], v[44:47], v[228:231]
ds_read_b64_tr_b16 v[48:49], v10 offset:0
v_mfma_f32_16x16x32_bf16 v[104:107], v[56:59], v[32:35], v[104:107]
ds_read_b64_tr_b16 v[50:51], v10 offset:1536
ds_read_b128 v[24:27], v4 offset:4096
v_mfma_f32_16x16x32_bf16 v[152:155], v[56:59], v[36:39], v[152:155]
ds_read_b128 v[28:31], v4 offset:6144
v_mfma_f32_16x16x32_bf16 v[200:203], v[56:59], v[40:43], v[200:203]
ds_read_b64_tr_b16 v[52:53], v11 offset:0
v_mfma_f32_16x16x32_bf16 v[248:251], v[56:59], v[44:47], v[248:251]
ds_read_b64_tr_b16 v[54:55], v11 offset:1536
v_mfma_f32_16x16x32_bf16 v[108:111], v[60:63], v[32:35], v[108:111]
ds_read_b64_tr_b16 v[56:57], v10 offset:12288
v_mfma_f32_16x16x32_bf16 v[156:159], v[60:63], v[36:39], v[156:159]
ds_read_b64_tr_b16 v[58:59], v10 offset:13824
v_mfma_f32_16x16x32_bf16 v[204:207], v[60:63], v[40:43], v[204:207]
v_mfma_f32_16x16x32_bf16 v[252:255], v[60:63], v[44:47], v[252:255]
s_waitcnt lgkmcnt(4)
s_nop 0
v_mfma_f32_16x16x32_bf16 v[64:67], v[48:51], v[16:19], v[64:67]
ds_read_b64_tr_b16 v[60:61], v11 offset:12288
v_mfma_f32_16x16x32_bf16 v[112:115], v[48:51], v[20:23], v[112:115]
ds_read_b64_tr_b16 v[62:63], v11 offset:13824
v_mfma_f32_16x16x32_bf16 v[160:163], v[48:51], v[24:27], v[160:163]
v_mfma_f32_16x16x32_bf16 v[208:211], v[48:51], v[28:31], v[208:211]
s_waitcnt lgkmcnt(4)
s_nop 0
v_mfma_f32_16x16x32_bf16 v[68:71], v[52:55], v[16:19], v[68:71]
ds_read_b64_tr_b16 v[48:49], v12 offset:0
v_mfma_f32_16x16x32_bf16 v[116:119], v[52:55], v[20:23], v[116:119]
ds_read_b64_tr_b16 v[50:51], v12 offset:1536
v_mfma_f32_16x16x32_bf16 v[164:167], v[52:55], v[24:27], v[164:167]
v_mfma_f32_16x16x32_bf16 v[212:215], v[52:55], v[28:31], v[212:215]
s_waitcnt lgkmcnt(4)
s_nop 0
v_mfma_f32_16x16x32_bf16 v[88:91], v[56:59], v[16:19], v[88:91]
ds_read_b64_tr_b16 v[52:53], v13 offset:0
v_mfma_f32_16x16x32_bf16 v[136:139], v[56:59], v[20:23], v[136:139]
ds_read_b64_tr_b16 v[54:55], v13 offset:1536
v_mfma_f32_16x16x32_bf16 v[184:187], v[56:59], v[24:27], v[184:187]
v_mfma_f32_16x16x32_bf16 v[232:235], v[56:59], v[28:31], v[232:235]
s_waitcnt lgkmcnt(4)
s_nop 0
v_mfma_f32_16x16x32_bf16 v[92:95], v[60:63], v[16:19], v[92:95]
ds_read_b64_tr_b16 v[56:57], v12 offset:12288
v_mfma_f32_16x16x32_bf16 v[140:143], v[60:63], v[20:23], v[140:143]
ds_read_b64_tr_b16 v[58:59], v12 offset:13824
v_mfma_f32_16x16x32_bf16 v[188:191], v[60:63], v[24:27], v[188:191]
v_mfma_f32_16x16x32_bf16 v[236:239], v[60:63], v[28:31], v[236:239]
s_waitcnt lgkmcnt(4)
s_nop 0
v_mfma_f32_16x16x32_bf16 v[72:75], v[48:51], v[16:19], v[72:75]
ds_read_b64_tr_b16 v[60:61], v13 offset:12288
v_mfma_f32_16x16x32_bf16 v[120:123], v[48:51], v[20:23], v[120:123]
ds_read_b64_tr_b16 v[62:63], v13 offset:13824
v_mfma_f32_16x16x32_bf16 v[168:171], v[48:51], v[24:27], v[168:171]
v_mfma_f32_16x16x32_bf16 v[216:219], v[48:51], v[28:31], v[216:219]
s_waitcnt lgkmcnt(4)
s_nop 0
v_mfma_f32_16x16x32_bf16 v[76:79], v[52:55], v[16:19], v[76:79]
ds_read_b64_tr_b16 v[48:49], v10 offset:128
v_mfma_f32_16x16x32_bf16 v[124:127], v[52:55], v[20:23], v[124:127]
ds_read_b64_tr_b16 v[50:51], v10 offset:1664
v_mfma_f32_16x16x32_bf16 v[172:175], v[52:55], v[24:27], v[172:175]
v_mfma_f32_16x16x32_bf16 v[220:223], v[52:55], v[28:31], v[220:223]
s_waitcnt lgkmcnt(4)
s_nop 0
v_mfma_f32_16x16x32_bf16 v[96:99], v[56:59], v[16:19], v[96:99]
ds_read_b64_tr_b16 v[52:53], v11 offset:128
v_mfma_f32_16x16x32_bf16 v[144:147], v[56:59], v[20:23], v[144:147]
ds_read_b64_tr_b16 v[54:55], v11 offset:1664
v_mfma_f32_16x16x32_bf16 v[192:195], v[56:59], v[24:27], v[192:195]
v_mfma_f32_16x16x32_bf16 v[240:243], v[56:59], v[28:31], v[240:243]
s_waitcnt lgkmcnt(4)
s_nop 0
v_mfma_f32_16x16x32_bf16 v[100:103], v[60:63], v[16:19], v[100:103]
ds_read_b64_tr_b16 v[56:57], v10 offset:12416
v_mfma_f32_16x16x32_bf16 v[148:151], v[60:63], v[20:23], v[148:151]
ds_read_b64_tr_b16 v[58:59], v10 offset:13952
v_mfma_f32_16x16x32_bf16 v[196:199], v[60:63], v[24:27], v[196:199]
v_mfma_f32_16x16x32_bf16 v[244:247], v[60:63], v[28:31], v[244:247]
s_waitcnt lgkmcnt(4)
s_nop 0
v_mfma_f32_16x16x32_bf16 v[80:83], v[48:51], v[16:19], v[80:83]
ds_read_b64_tr_b16 v[60:61], v11 offset:12416
v_mfma_f32_16x16x32_bf16 v[128:131], v[48:51], v[20:23], v[128:131]
ds_read_b64_tr_b16 v[62:63], v11 offset:13952
v_mfma_f32_16x16x32_bf16 v[176:179], v[48:51], v[24:27], v[176:179]
v_mfma_f32_16x16x32_bf16 v[224:227], v[48:51], v[28:31], v[224:227]
s_waitcnt lgkmcnt(4)
s_nop 0
v_mfma_f32_16x16x32_bf16 v[84:87], v[52:55], v[16:19], v[84:87]
s_waitcnt lgkmcnt(0)
s_barrier
v_mfma_f32_16x16x32_bf16 v[132:135], v[52:55], v[20:23], v[132:135]
ds_read_b128 v[32:35], v5 offset:0
v_mfma_f32_16x16x32_bf16 v[180:183], v[52:55], v[24:27], v[180:183]
ds_read_b128 v[36:39], v5 offset:2048
v_mfma_f32_16x16x32_bf16 v[228:231], v[52:55], v[28:31], v[228:231]
ds_read_b64_tr_b16 v[48:49], v10 offset:24576
v_mfma_f32_16x16x32_bf16 v[104:107], v[56:59], v[16:19], v[104:107]
ds_read_b64_tr_b16 v[50:51], v10 offset:26112
ds_read_b128 v[40:43], v5 offset:4096
v_mfma_f32_16x16x32_bf16 v[152:155], v[56:59], v[20:23], v[152:155]
ds_read_b128 v[44:47], v5 offset:6144
v_mfma_f32_16x16x32_bf16 v[200:203], v[56:59], v[24:27], v[200:203]
ds_read_b64_tr_b16 v[52:53], v11 offset:24576
v_mfma_f32_16x16x32_bf16 v[248:251], v[56:59], v[28:31], v[248:251]
ds_read_b64_tr_b16 v[54:55], v11 offset:26112
v_mfma_f32_16x16x32_bf16 v[108:111], v[60:63], v[16:19], v[108:111]
ds_read_b64_tr_b16 v[56:57], v10 offset:36864
v_mfma_f32_16x16x32_bf16 v[156:159], v[60:63], v[20:23], v[156:159]
ds_read_b64_tr_b16 v[58:59], v10 offset:38400
v_mfma_f32_16x16x32_bf16 v[204:207], v[60:63], v[24:27], v[204:207]
v_mfma_f32_16x16x32_bf16 v[252:255], v[60:63], v[28:31], v[252:255]
s_waitcnt lgkmcnt(4)
s_nop 0
v_mfma_f32_16x16x32_bf16 v[64:67], v[48:51], v[32:35], v[64:67]
ds_read_b64_tr_b16 v[60:61], v11 offset:36864
v_mfma_f32_16x16x32_bf16 v[112:115], v[48:51], v[36:39], v[112:115]
ds_read_b64_tr_b16 v[62:63], v11 offset:38400
v_mfma_f32_16x16x32_bf16 v[160:163], v[48:51], v[40:43], v[160:163]
v_mfma_f32_16x16x32_bf16 v[208:211], v[48:51], v[44:47], v[208:211]
s_waitcnt lgkmcnt(4)
s_nop 0
v_mfma_f32_16x16x32_bf16 v[68:71], v[52:55], v[32:35], v[68:71]
ds_read_b64_tr_b16 v[48:49], v12 offset:24576
v_mfma_f32_16x16x32_bf16 v[116:119], v[52:55], v[36:39], v[116:119]
ds_read_b64_tr_b16 v[50:51], v12 offset:26112
v_mfma_f32_16x16x32_bf16 v[164:167], v[52:55], v[40:43], v[164:167]
v_mfma_f32_16x16x32_bf16 v[212:215], v[52:55], v[44:47], v[212:215]
s_waitcnt lgkmcnt(4)
s_nop 0
v_mfma_f32_16x16x32_bf16 v[88:91], v[56:59], v[32:35], v[88:91]
ds_read_b64_tr_b16 v[52:53], v13 offset:24576
v_mfma_f32_16x16x32_bf16 v[136:139], v[56:59], v[36:39], v[136:139]
ds_read_b64_tr_b16 v[54:55], v13 offset:26112
v_mfma_f32_16x16x32_bf16 v[184:187], v[56:59], v[40:43], v[184:187]
v_mfma_f32_16x16x32_bf16 v[232:235], v[56:59], v[44:47], v[232:235]
s_waitcnt lgkmcnt(4)
s_nop 0
v_mfma_f32_16x16x32_bf16 v[92:95], v[60:63], v[32:35], v[92:95]
ds_read_b64_tr_b16 v[56:57], v12 offset:36864
v_mfma_f32_16x16x32_bf16 v[140:143], v[60:63], v[36:39], v[140:143]
ds_read_b64_tr_b16 v[58:59], v12 offset:38400
v_mfma_f32_16x16x32_bf16 v[188:191], v[60:63], v[40:43], v[188:191]
v_mfma_f32_16x16x32_bf16 v[236:239], v[60:63], v[44:47], v[236:239]
s_waitcnt lgkmcnt(4)
s_nop 0
v_mfma_f32_16x16x32_bf16 v[72:75], v[48:51], v[32:35], v[72:75]
ds_read_b64_tr_b16 v[60:61], v13 offset:36864
v_mfma_f32_16x16x32_bf16 v[120:123], v[48:51], v[36:39], v[120:123]
ds_read_b64_tr_b16 v[62:63], v13 offset:38400
v_mfma_f32_16x16x32_bf16 v[168:171], v[48:51], v[40:43], v[168:171]
v_mfma_f32_16x16x32_bf16 v[216:219], v[48:51], v[44:47], v[216:219]
s_waitcnt lgkmcnt(4)
s_nop 0
v_mfma_f32_16x16x32_bf16 v[76:79], v[52:55], v[32:35], v[76:79]
ds_read_b64_tr_b16 v[48:49], v10 offset:24704
v_mfma_f32_16x16x32_bf16 v[124:127], v[52:55], v[36:39], v[124:127]
ds_read_b64_tr_b16 v[50:51], v10 offset:26240
v_mfma_f32_16x16x32_bf16 v[172:175], v[52:55], v[40:43], v[172:175]
v_mfma_f32_16x16x32_bf16 v[220:223], v[52:55], v[44:47], v[220:223]
s_waitcnt lgkmcnt(4)
s_nop 0
v_mfma_f32_16x16x32_bf16 v[96:99], v[56:59], v[32:35], v[96:99]
ds_read_b64_tr_b16 v[52:53], v11 offset:24704
v_mfma_f32_16x16x32_bf16 v[144:147], v[56:59], v[36:39], v[144:147]
ds_read_b64_tr_b16 v[54:55], v11 offset:26240
v_mfma_f32_16x16x32_bf16 v[192:195], v[56:59], v[40:43], v[192:195]
v_mfma_f32_16x16x32_bf16 v[240:243], v[56:59], v[44:47], v[240:243]
s_waitcnt lgkmcnt(4)
s_nop 0
v_mfma_f32_16x16x32_bf16 v[100:103], v[60:63], v[32:35], v[100:103]
ds_read_b64_tr_b16 v[56:57], v10 offset:36992
v_mfma_f32_16x16x32_bf16 v[148:151], v[60:63], v[36:39], v[148:151]
ds_read_b64_tr_b16 v[58:59], v10 offset:38528
v_mfma_f32_16x16x32_bf16 v[196:199], v[60:63], v[40:43], v[196:199]
v_mfma_f32_16x16x32_bf16 v[244:247], v[60:63], v[44:47], v[244:247]
s_waitcnt lgkmcnt(4)
s_nop 0
v_mfma_f32_16x16x32_bf16 v[80:83], v[48:51], v[32:35], v[80:83]
ds_read_b64_tr_b16 v[60:61], v11 offset:36992
v_mfma_f32_16x16x32_bf16 v[128:131], v[48:51], v[36:39], v[128:131]
ds_read_b64_tr_b16 v[62:63], v11 offset:38528
v_mfma_f32_16x16x32_bf16 v[176:179], v[48:51], v[40:43], v[176:179]
v_mfma_f32_16x16x32_bf16 v[224:227], v[48:51], v[44:47], v[224:227]
s_waitcnt lgkmcnt(4)
s_nop 0
v_mfma_f32_16x16x32_bf16 v[84:87], v[52:55], v[32:35], v[84:87]
s_waitcnt lgkmcnt(0)
s_barrier
v_mfma_f32_16x16x32_bf16 v[132:135], v[52:55], v[36:39], v[132:135]
ds_read_b128 v[16:19], v4 offset:49152
v_mfma_f32_16x16x32_bf16 v[180:183], v[52:55], v[40:43], v[180:183]
ds_read_b128 v[20:23], v4 offset:51200
v_mfma_f32_16x16x32_bf16 v[228:231], v[52:55], v[44:47], v[228:231]
ds_read_b64_tr_b16 v[48:49], v6 offset:0
v_mfma_f32_16x16x32_bf16 v[104:107], v[56:59], v[32:35], v[104:107]
ds_read_b64_tr_b16 v[50:51], v6 offset:1536
ds_read_b128 v[24:27], v4 offset:53248
v_mfma_f32_16x16x32_bf16 v[152:155], v[56:59], v[36:39], v[152:155]
ds_read_b128 v[28:31], v4 offset:55296
v_mfma_f32_16x16x32_bf16 v[200:203], v[56:59], v[40:43], v[200:203]
ds_read_b64_tr_b16 v[52:53], v7 offset:0
v_mfma_f32_16x16x32_bf16 v[248:251], v[56:59], v[44:47], v[248:251]
ds_read_b64_tr_b16 v[54:55], v7 offset:1536
v_mfma_f32_16x16x32_bf16 v[108:111], v[60:63], v[32:35], v[108:111]
ds_read_b64_tr_b16 v[56:57], v6 offset:12288
v_mfma_f32_16x16x32_bf16 v[156:159], v[60:63], v[36:39], v[156:159]
ds_read_b64_tr_b16 v[58:59], v6 offset:13824
v_mfma_f32_16x16x32_bf16 v[204:207], v[60:63], v[40:43], v[204:207]
v_mfma_f32_16x16x32_bf16 v[252:255], v[60:63], v[44:47], v[252:255]
s_waitcnt lgkmcnt(4)
s_nop 0
v_mfma_f32_16x16x32_bf16 v[64:67], v[48:51], v[16:19], v[64:67]
ds_read_b64_tr_b16 v[60:61], v7 offset:12288
v_mfma_f32_16x16x32_bf16 v[112:115], v[48:51], v[20:23], v[112:115]
ds_read_b64_tr_b16 v[62:63], v7 offset:13824
v_mfma_f32_16x16x32_bf16 v[160:163], v[48:51], v[24:27], v[160:163]
v_mfma_f32_16x16x32_bf16 v[208:211], v[48:51], v[28:31], v[208:211]
s_waitcnt lgkmcnt(4)
s_nop 0
v_mfma_f32_16x16x32_bf16 v[68:71], v[52:55], v[16:19], v[68:71]
ds_read_b64_tr_b16 v[48:49], v8 offset:0
v_mfma_f32_16x16x32_bf16 v[116:119], v[52:55], v[20:23], v[116:119]
ds_read_b64_tr_b16 v[50:51], v8 offset:1536
v_mfma_f32_16x16x32_bf16 v[164:167], v[52:55], v[24:27], v[164:167]
v_mfma_f32_16x16x32_bf16 v[212:215], v[52:55], v[28:31], v[212:215]
s_waitcnt lgkmcnt(4)
s_nop 0
v_mfma_f32_16x16x32_bf16 v[88:91], v[56:59], v[16:19], v[88:91]
ds_read_b64_tr_b16 v[52:53], v9 offset:0
v_mfma_f32_16x16x32_bf16 v[136:139], v[56:59], v[20:23], v[136:139]
ds_read_b64_tr_b16 v[54:55], v9 offset:1536
v_mfma_f32_16x16x32_bf16 v[184:187], v[56:59], v[24:27], v[184:187]
v_mfma_f32_16x16x32_bf16 v[232:235], v[56:59], v[28:31], v[232:235]
s_waitcnt lgkmcnt(4)
s_nop 0
v_mfma_f32_16x16x32_bf16 v[92:95], v[60:63], v[16:19], v[92:95]
ds_read_b64_tr_b16 v[56:57], v8 offset:12288
v_mfma_f32_16x16x32_bf16 v[140:143], v[60:63], v[20:23], v[140:143]
ds_read_b64_tr_b16 v[58:59], v8 offset:13824
v_mfma_f32_16x16x32_bf16 v[188:191], v[60:63], v[24:27], v[188:191]
v_mfma_f32_16x16x32_bf16 v[236:239], v[60:63], v[28:31], v[236:239]
s_waitcnt lgkmcnt(4)
s_nop 0
v_mfma_f32_16x16x32_bf16 v[72:75], v[48:51], v[16:19], v[72:75]
ds_read_b64_tr_b16 v[60:61], v9 offset:12288
v_mfma_f32_16x16x32_bf16 v[120:123], v[48:51], v[20:23], v[120:123]
ds_read_b64_tr_b16 v[62:63], v9 offset:13824
v_mfma_f32_16x16x32_bf16 v[168:171], v[48:51], v[24:27], v[168:171]
v_mfma_f32_16x16x32_bf16 v[216:219], v[48:51], v[28:31], v[216:219]
s_waitcnt lgkmcnt(4)
s_nop 0
v_mfma_f32_16x16x32_bf16 v[76:79], v[52:55], v[16:19], v[76:79]
ds_read_b64_tr_b16 v[48:49], v6 offset:128
v_mfma_f32_16x16x32_bf16 v[124:127], v[52:55], v[20:23], v[124:127]
ds_read_b64_tr_b16 v[50:51], v6 offset:1664
v_mfma_f32_16x16x32_bf16 v[172:175], v[52:55], v[24:27], v[172:175]
v_mfma_f32_16x16x32_bf16 v[220:223], v[52:55], v[28:31], v[220:223]
s_waitcnt lgkmcnt(4)
s_nop 0
v_mfma_f32_16x16x32_bf16 v[96:99], v[56:59], v[16:19], v[96:99]
ds_read_b64_tr_b16 v[52:53], v7 offset:128
v_mfma_f32_16x16x32_bf16 v[144:147], v[56:59], v[20:23], v[144:147]
ds_read_b64_tr_b16 v[54:55], v7 offset:1664
v_mfma_f32_16x16x32_bf16 v[192:195], v[56:59], v[24:27], v[192:195]
v_mfma_f32_16x16x32_bf16 v[240:243], v[56:59], v[28:31], v[240:243]
s_waitcnt lgkmcnt(4)
s_nop 0
v_mfma_f32_16x16x32_bf16 v[100:103], v[60:63], v[16:19], v[100:103]
ds_read_b64_tr_b16 v[56:57], v6 offset:12416
v_mfma_f32_16x16x32_bf16 v[148:151], v[60:63], v[20:23], v[148:151]
ds_read_b64_tr_b16 v[58:59], v6 offset:13952
v_mfma_f32_16x16x32_bf16 v[196:199], v[60:63], v[24:27], v[196:199]
v_mfma_f32_16x16x32_bf16 v[244:247], v[60:63], v[28:31], v[244:247]
s_waitcnt lgkmcnt(4)
s_nop 0
v_mfma_f32_16x16x32_bf16 v[80:83], v[48:51], v[16:19], v[80:83]
ds_read_b64_tr_b16 v[60:61], v7 offset:12416
v_mfma_f32_16x16x32_bf16 v[128:131], v[48:51], v[20:23], v[128:131]
ds_read_b64_tr_b16 v[62:63], v7 offset:13952
v_mfma_f32_16x16x32_bf16 v[176:179], v[48:51], v[24:27], v[176:179]
v_mfma_f32_16x16x32_bf16 v[224:227], v[48:51], v[28:31], v[224:227]
s_waitcnt lgkmcnt(4)
s_nop 0
v_mfma_f32_16x16x32_bf16 v[84:87], v[52:55], v[16:19], v[84:87]
s_waitcnt lgkmcnt(0)
s_barrier
v_mfma_f32_16x16x32_bf16 v[132:135], v[52:55], v[20:23], v[132:135]
ds_read_b128 v[32:35], v5 offset:49152
v_mfma_f32_16x16x32_bf16 v[180:183], v[52:55], v[24:27], v[180:183]
ds_read_b128 v[36:39], v5 offset:51200
v_mfma_f32_16x16x32_bf16 v[228:231], v[52:55], v[28:31], v[228:231]
ds_read_b64_tr_b16 v[48:49], v6 offset:24576
v_mfma_f32_16x16x32_bf16 v[104:107], v[56:59], v[16:19], v[104:107]
ds_read_b64_tr_b16 v[50:51], v6 offset:26112
ds_read_b128 v[40:43], v5 offset:53248
v_mfma_f32_16x16x32_bf16 v[152:155], v[56:59], v[20:23], v[152:155]
ds_read_b128 v[44:47], v5 offset:55296
v_mfma_f32_16x16x32_bf16 v[200:203], v[56:59], v[24:27], v[200:203]
ds_read_b64_tr_b16 v[52:53], v7 offset:24576
v_mfma_f32_16x16x32_bf16 v[248:251], v[56:59], v[28:31], v[248:251]
ds_read_b64_tr_b16 v[54:55], v7 offset:26112
v_mfma_f32_16x16x32_bf16 v[108:111], v[60:63], v[16:19], v[108:111]
ds_read_b64_tr_b16 v[56:57], v6 offset:36864
v_mfma_f32_16x16x32_bf16 v[156:159], v[60:63], v[20:23], v[156:159]
ds_read_b64_tr_b16 v[58:59], v6 offset:38400
v_mfma_f32_16x16x32_bf16 v[204:207], v[60:63], v[24:27], v[204:207]
v_mfma_f32_16x16x32_bf16 v[252:255], v[60:63], v[28:31], v[252:255]
s_waitcnt lgkmcnt(4)
s_nop 0
v_mfma_f32_16x16x32_bf16 v[64:67], v[48:51], v[32:35], v[64:67]
ds_read_b64_tr_b16 v[60:61], v7 offset:36864
v_mfma_f32_16x16x32_bf16 v[112:115], v[48:51], v[36:39], v[112:115]
ds_read_b64_tr_b16 v[62:63], v7 offset:38400
v_mfma_f32_16x16x32_bf16 v[160:163], v[48:51], v[40:43], v[160:163]
v_mfma_f32_16x16x32_bf16 v[208:211], v[48:51], v[44:47], v[208:211]
s_waitcnt lgkmcnt(4)
s_nop 0
v_mfma_f32_16x16x32_bf16 v[68:71], v[52:55], v[32:35], v[68:71]
ds_read_b64_tr_b16 v[48:49], v8 offset:24576
v_mfma_f32_16x16x32_bf16 v[116:119], v[52:55], v[36:39], v[116:119]
ds_read_b64_tr_b16 v[50:51], v8 offset:26112
v_mfma_f32_16x16x32_bf16 v[164:167], v[52:55], v[40:43], v[164:167]
v_mfma_f32_16x16x32_bf16 v[212:215], v[52:55], v[44:47], v[212:215]
s_waitcnt lgkmcnt(4)
s_nop 0
v_mfma_f32_16x16x32_bf16 v[88:91], v[56:59], v[32:35], v[88:91]
ds_read_b64_tr_b16 v[52:53], v9 offset:24576
v_mfma_f32_16x16x32_bf16 v[136:139], v[56:59], v[36:39], v[136:139]
ds_read_b64_tr_b16 v[54:55], v9 offset:26112
v_mfma_f32_16x16x32_bf16 v[184:187], v[56:59], v[40:43], v[184:187]
v_mfma_f32_16x16x32_bf16 v[232:235], v[56:59], v[44:47], v[232:235]
s_waitcnt lgkmcnt(4)
s_nop 0
v_mfma_f32_16x16x32_bf16 v[92:95], v[60:63], v[32:35], v[92:95]
ds_read_b64_tr_b16 v[56:57], v8 offset:36864
v_mfma_f32_16x16x32_bf16 v[140:143], v[60:63], v[36:39], v[140:143]
ds_read_b64_tr_b16 v[58:59], v8 offset:38400
v_mfma_f32_16x16x32_bf16 v[188:191], v[60:63], v[40:43], v[188:191]
v_mfma_f32_16x16x32_bf16 v[236:239], v[60:63], v[44:47], v[236:239]
s_waitcnt lgkmcnt(4)
s_nop 0
v_mfma_f32_16x16x32_bf16 v[72:75], v[48:51], v[32:35], v[72:75]
ds_read_b64_tr_b16 v[60:61], v9 offset:36864
v_mfma_f32_16x16x32_bf16 v[120:123], v[48:51], v[36:39], v[120:123]
ds_read_b64_tr_b16 v[62:63], v9 offset:38400
v_mfma_f32_16x16x32_bf16 v[168:171], v[48:51], v[40:43], v[168:171]
v_mfma_f32_16x16x32_bf16 v[216:219], v[48:51], v[44:47], v[216:219]
s_waitcnt lgkmcnt(4)
s_nop 0
v_mfma_f32_16x16x32_bf16 v[76:79], v[52:55], v[32:35], v[76:79]
ds_read_b64_tr_b16 v[48:49], v6 offset:24704
v_mfma_f32_16x16x32_bf16 v[124:127], v[52:55], v[36:39], v[124:127]
ds_read_b64_tr_b16 v[50:51], v6 offset:26240
v_mfma_f32_16x16x32_bf16 v[172:175], v[52:55], v[40:43], v[172:175]
v_mfma_f32_16x16x32_bf16 v[220:223], v[52:55], v[44:47], v[220:223]
s_waitcnt lgkmcnt(4)
s_nop 0
v_mfma_f32_16x16x32_bf16 v[96:99], v[56:59], v[32:35], v[96:99]
ds_read_b64_tr_b16 v[52:53], v7 offset:24704
v_mfma_f32_16x16x32_bf16 v[144:147], v[56:59], v[36:39], v[144:147]
ds_read_b64_tr_b16 v[54:55], v7 offset:26240
v_mfma_f32_16x16x32_bf16 v[192:195], v[56:59], v[40:43], v[192:195]
v_mfma_f32_16x16x32_bf16 v[240:243], v[56:59], v[44:47], v[240:243]
s_waitcnt lgkmcnt(4)
s_nop 0
v_mfma_f32_16x16x32_bf16 v[100:103], v[60:63], v[32:35], v[100:103]
ds_read_b64_tr_b16 v[56:57], v6 offset:36992
v_mfma_f32_16x16x32_bf16 v[148:151], v[60:63], v[36:39], v[148:151]
ds_read_b64_tr_b16 v[58:59], v6 offset:38528
v_mfma_f32_16x16x32_bf16 v[196:199], v[60:63], v[40:43], v[196:199]
v_mfma_f32_16x16x32_bf16 v[244:247], v[60:63], v[44:47], v[244:247]
s_waitcnt lgkmcnt(4)
s_nop 0
v_mfma_f32_16x16x32_bf16 v[80:83], v[48:51], v[32:35], v[80:83]
ds_read_b64_tr_b16 v[60:61], v7 offset:36992
v_mfma_f32_16x16x32_bf16 v[128:131], v[48:51], v[36:39], v[128:131]
ds_read_b64_tr_b16 v[62:63], v7 offset:38528
v_mfma_f32_16x16x32_bf16 v[176:179], v[48:51], v[40:43], v[176:179]
v_mfma_f32_16x16x32_bf16 v[224:227], v[48:51], v[44:47], v[224:227]
s_waitcnt lgkmcnt(4)
s_nop 0
v_mfma_f32_16x16x32_bf16 v[84:87], v[52:55], v[32:35], v[84:87]
s_waitcnt lgkmcnt(0)
s_barrier
v_mfma_f32_16x16x32_bf16 v[132:135], v[52:55], v[36:39], v[132:135]
ds_read_b128 v[16:19], v4 offset:32768
v_mfma_f32_16x16x32_bf16 v[180:183], v[52:55], v[40:43], v[180:183]
ds_read_b128 v[20:23], v4 offset:34816
v_mfma_f32_16x16x32_bf16 v[228:231], v[52:55], v[44:47], v[228:231]
ds_read_b64_tr_b16 v[48:49], v10 offset:0
v_mfma_f32_16x16x32_bf16 v[104:107], v[56:59], v[32:35], v[104:107]
ds_read_b64_tr_b16 v[50:51], v10 offset:1536
ds_read_b128 v[24:27], v4 offset:36864
v_mfma_f32_16x16x32_bf16 v[152:155], v[56:59], v[36:39], v[152:155]
ds_read_b128 v[28:31], v4 offset:38912
v_mfma_f32_16x16x32_bf16 v[200:203], v[56:59], v[40:43], v[200:203]
ds_read_b64_tr_b16 v[52:53], v11 offset:0
v_mfma_f32_16x16x32_bf16 v[248:251], v[56:59], v[44:47], v[248:251]
ds_read_b64_tr_b16 v[54:55], v11 offset:1536
v_mfma_f32_16x16x32_bf16 v[108:111], v[60:63], v[32:35], v[108:111]
ds_read_b64_tr_b16 v[56:57], v10 offset:12288
v_mfma_f32_16x16x32_bf16 v[156:159], v[60:63], v[36:39], v[156:159]
ds_read_b64_tr_b16 v[58:59], v10 offset:13824
v_mfma_f32_16x16x32_bf16 v[204:207], v[60:63], v[40:43], v[204:207]
v_mfma_f32_16x16x32_bf16 v[252:255], v[60:63], v[44:47], v[252:255]
s_waitcnt lgkmcnt(4)
s_nop 0
v_mfma_f32_16x16x32_bf16 v[64:67], v[48:51], v[16:19], v[64:67]
ds_read_b64_tr_b16 v[60:61], v11 offset:12288
v_mfma_f32_16x16x32_bf16 v[112:115], v[48:51], v[20:23], v[112:115]
ds_read_b64_tr_b16 v[62:63], v11 offset:13824
v_mfma_f32_16x16x32_bf16 v[160:163], v[48:51], v[24:27], v[160:163]
v_mfma_f32_16x16x32_bf16 v[208:211], v[48:51], v[28:31], v[208:211]
s_waitcnt lgkmcnt(4)
s_nop 0
v_mfma_f32_16x16x32_bf16 v[68:71], v[52:55], v[16:19], v[68:71]
ds_read_b64_tr_b16 v[48:49], v12 offset:0
v_mfma_f32_16x16x32_bf16 v[116:119], v[52:55], v[20:23], v[116:119]
ds_read_b64_tr_b16 v[50:51], v12 offset:1536
v_mfma_f32_16x16x32_bf16 v[164:167], v[52:55], v[24:27], v[164:167]
v_mfma_f32_16x16x32_bf16 v[212:215], v[52:55], v[28:31], v[212:215]
s_waitcnt lgkmcnt(4)
s_nop 0
v_mfma_f32_16x16x32_bf16 v[88:91], v[56:59], v[16:19], v[88:91]
ds_read_b64_tr_b16 v[52:53], v13 offset:0
v_mfma_f32_16x16x32_bf16 v[136:139], v[56:59], v[20:23], v[136:139]
ds_read_b64_tr_b16 v[54:55], v13 offset:1536
v_mfma_f32_16x16x32_bf16 v[184:187], v[56:59], v[24:27], v[184:187]
v_mfma_f32_16x16x32_bf16 v[232:235], v[56:59], v[28:31], v[232:235]
s_waitcnt lgkmcnt(4)
s_nop 0
v_mfma_f32_16x16x32_bf16 v[92:95], v[60:63], v[16:19], v[92:95]
ds_read_b64_tr_b16 v[56:57], v12 offset:12288
v_mfma_f32_16x16x32_bf16 v[140:143], v[60:63], v[20:23], v[140:143]
ds_read_b64_tr_b16 v[58:59], v12 offset:13824
v_mfma_f32_16x16x32_bf16 v[188:191], v[60:63], v[24:27], v[188:191]
v_mfma_f32_16x16x32_bf16 v[236:239], v[60:63], v[28:31], v[236:239]
s_waitcnt lgkmcnt(4)
s_nop 0
v_mfma_f32_16x16x32_bf16 v[72:75], v[48:51], v[16:19], v[72:75]
ds_read_b64_tr_b16 v[60:61], v13 offset:12288
v_mfma_f32_16x16x32_bf16 v[120:123], v[48:51], v[20:23], v[120:123]
ds_read_b64_tr_b16 v[62:63], v13 offset:13824
v_mfma_f32_16x16x32_bf16 v[168:171], v[48:51], v[24:27], v[168:171]
v_mfma_f32_16x16x32_bf16 v[216:219], v[48:51], v[28:31], v[216:219]
s_waitcnt lgkmcnt(4)
s_nop 0
v_mfma_f32_16x16x32_bf16 v[76:79], v[52:55], v[16:19], v[76:79]
ds_read_b64_tr_b16 v[48:49], v10 offset:128
v_mfma_f32_16x16x32_bf16 v[124:127], v[52:55], v[20:23], v[124:127]
ds_read_b64_tr_b16 v[50:51], v10 offset:1664
v_mfma_f32_16x16x32_bf16 v[172:175], v[52:55], v[24:27], v[172:175]
v_mfma_f32_16x16x32_bf16 v[220:223], v[52:55], v[28:31], v[220:223]
s_waitcnt lgkmcnt(4)
s_nop 0
v_mfma_f32_16x16x32_bf16 v[96:99], v[56:59], v[16:19], v[96:99]
ds_read_b64_tr_b16 v[52:53], v11 offset:128
v_mfma_f32_16x16x32_bf16 v[144:147], v[56:59], v[20:23], v[144:147]
ds_read_b64_tr_b16 v[54:55], v11 offset:1664
v_mfma_f32_16x16x32_bf16 v[192:195], v[56:59], v[24:27], v[192:195]
v_mfma_f32_16x16x32_bf16 v[240:243], v[56:59], v[28:31], v[240:243]
s_waitcnt lgkmcnt(4)
s_nop 0
v_mfma_f32_16x16x32_bf16 v[100:103], v[60:63], v[16:19], v[100:103]
ds_read_b64_tr_b16 v[56:57], v10 offset:12416
v_mfma_f32_16x16x32_bf16 v[148:151], v[60:63], v[20:23], v[148:151]
ds_read_b64_tr_b16 v[58:59], v10 offset:13952
v_mfma_f32_16x16x32_bf16 v[196:199], v[60:63], v[24:27], v[196:199]
v_mfma_f32_16x16x32_bf16 v[244:247], v[60:63], v[28:31], v[244:247]
s_waitcnt lgkmcnt(4)
s_nop 0
v_mfma_f32_16x16x32_bf16 v[80:83], v[48:51], v[16:19], v[80:83]
ds_read_b64_tr_b16 v[60:61], v11 offset:12416
v_mfma_f32_16x16x32_bf16 v[128:131], v[48:51], v[20:23], v[128:131]
ds_read_b64_tr_b16 v[62:63], v11 offset:13952
v_mfma_f32_16x16x32_bf16 v[176:179], v[48:51], v[24:27], v[176:179]
v_mfma_f32_16x16x32_bf16 v[224:227], v[48:51], v[28:31], v[224:227]
s_waitcnt lgkmcnt(4)
s_nop 0
v_mfma_f32_16x16x32_bf16 v[84:87], v[52:55], v[16:19], v[84:87]
s_waitcnt lgkmcnt(0)
s_barrier
v_mfma_f32_16x16x32_bf16 v[132:135], v[52:55], v[20:23], v[132:135]
ds_read_b128 v[32:35], v5 offset:32768
v_mfma_f32_16x16x32_bf16 v[180:183], v[52:55], v[24:27], v[180:183]
ds_read_b128 v[36:39], v5 offset:34816
v_mfma_f32_16x16x32_bf16 v[228:231], v[52:55], v[28:31], v[228:231]
ds_read_b64_tr_b16 v[48:49], v10 offset:24576
v_mfma_f32_16x16x32_bf16 v[104:107], v[56:59], v[16:19], v[104:107]
ds_read_b64_tr_b16 v[50:51], v10 offset:26112
ds_read_b128 v[40:43], v5 offset:36864
v_mfma_f32_16x16x32_bf16 v[152:155], v[56:59], v[20:23], v[152:155]
ds_read_b128 v[44:47], v5 offset:38912
v_mfma_f32_16x16x32_bf16 v[200:203], v[56:59], v[24:27], v[200:203]
ds_read_b64_tr_b16 v[52:53], v11 offset:24576
v_mfma_f32_16x16x32_bf16 v[248:251], v[56:59], v[28:31], v[248:251]
ds_read_b64_tr_b16 v[54:55], v11 offset:26112
v_mfma_f32_16x16x32_bf16 v[108:111], v[60:63], v[16:19], v[108:111]
ds_read_b64_tr_b16 v[56:57], v10 offset:36864
v_mfma_f32_16x16x32_bf16 v[156:159], v[60:63], v[20:23], v[156:159]
ds_read_b64_tr_b16 v[58:59], v10 offset:38400
v_mfma_f32_16x16x32_bf16 v[204:207], v[60:63], v[24:27], v[204:207]
v_mfma_f32_16x16x32_bf16 v[252:255], v[60:63], v[28:31], v[252:255]
s_waitcnt lgkmcnt(4)
s_nop 0
v_mfma_f32_16x16x32_bf16 v[64:67], v[48:51], v[32:35], v[64:67]
ds_read_b64_tr_b16 v[60:61], v11 offset:36864
v_mfma_f32_16x16x32_bf16 v[112:115], v[48:51], v[36:39], v[112:115]
ds_read_b64_tr_b16 v[62:63], v11 offset:38400
v_mfma_f32_16x16x32_bf16 v[160:163], v[48:51], v[40:43], v[160:163]
v_mfma_f32_16x16x32_bf16 v[208:211], v[48:51], v[44:47], v[208:211]
s_waitcnt lgkmcnt(4)
s_nop 0
v_mfma_f32_16x16x32_bf16 v[68:71], v[52:55], v[32:35], v[68:71]
ds_read_b64_tr_b16 v[48:49], v12 offset:24576
v_mfma_f32_16x16x32_bf16 v[116:119], v[52:55], v[36:39], v[116:119]
ds_read_b64_tr_b16 v[50:51], v12 offset:26112
v_mfma_f32_16x16x32_bf16 v[164:167], v[52:55], v[40:43], v[164:167]
v_mfma_f32_16x16x32_bf16 v[212:215], v[52:55], v[44:47], v[212:215]
s_waitcnt lgkmcnt(4)
s_nop 0
v_mfma_f32_16x16x32_bf16 v[88:91], v[56:59], v[32:35], v[88:91]
ds_read_b64_tr_b16 v[52:53], v13 offset:24576
v_mfma_f32_16x16x32_bf16 v[136:139], v[56:59], v[36:39], v[136:139]
ds_read_b64_tr_b16 v[54:55], v13 offset:26112
v_mfma_f32_16x16x32_bf16 v[184:187], v[56:59], v[40:43], v[184:187]
v_mfma_f32_16x16x32_bf16 v[232:235], v[56:59], v[44:47], v[232:235]
s_waitcnt lgkmcnt(4)
s_nop 0
v_mfma_f32_16x16x32_bf16 v[92:95], v[60:63], v[32:35], v[92:95]
ds_read_b64_tr_b16 v[56:57], v12 offset:36864
v_mfma_f32_16x16x32_bf16 v[140:143], v[60:63], v[36:39], v[140:143]
ds_read_b64_tr_b16 v[58:59], v12 offset:38400
v_mfma_f32_16x16x32_bf16 v[188:191], v[60:63], v[40:43], v[188:191]
v_mfma_f32_16x16x32_bf16 v[236:239], v[60:63], v[44:47], v[236:239]
s_waitcnt lgkmcnt(4)
s_nop 0
v_mfma_f32_16x16x32_bf16 v[72:75], v[48:51], v[32:35], v[72:75]
ds_read_b64_tr_b16 v[60:61], v13 offset:36864
v_mfma_f32_16x16x32_bf16 v[120:123], v[48:51], v[36:39], v[120:123]
ds_read_b64_tr_b16 v[62:63], v13 offset:38400
v_mfma_f32_16x16x32_bf16 v[168:171], v[48:51], v[40:43], v[168:171]
v_mfma_f32_16x16x32_bf16 v[216:219], v[48:51], v[44:47], v[216:219]
s_waitcnt lgkmcnt(4)
s_nop 0
v_mfma_f32_16x16x32_bf16 v[76:79], v[52:55], v[32:35], v[76:79]
ds_read_b64_tr_b16 v[48:49], v10 offset:24704
v_mfma_f32_16x16x32_bf16 v[124:127], v[52:55], v[36:39], v[124:127]
ds_read_b64_tr_b16 v[50:51], v10 offset:26240
v_mfma_f32_16x16x32_bf16 v[172:175], v[52:55], v[40:43], v[172:175]
v_mfma_f32_16x16x32_bf16 v[220:223], v[52:55], v[44:47], v[220:223]
s_waitcnt lgkmcnt(4)
s_nop 0
v_mfma_f32_16x16x32_bf16 v[96:99], v[56:59], v[32:35], v[96:99]
ds_read_b64_tr_b16 v[52:53], v11 offset:24704
v_mfma_f32_16x16x32_bf16 v[144:147], v[56:59], v[36:39], v[144:147]
ds_read_b64_tr_b16 v[54:55], v11 offset:26240
v_mfma_f32_16x16x32_bf16 v[192:195], v[56:59], v[40:43], v[192:195]
v_mfma_f32_16x16x32_bf16 v[240:243], v[56:59], v[44:47], v[240:243]
s_waitcnt lgkmcnt(4)
s_nop 0
v_mfma_f32_16x16x32_bf16 v[100:103], v[60:63], v[32:35], v[100:103]
ds_read_b64_tr_b16 v[56:57], v10 offset:36992
v_mfma_f32_16x16x32_bf16 v[148:151], v[60:63], v[36:39], v[148:151]
ds_read_b64_tr_b16 v[58:59], v10 offset:38528
v_mfma_f32_16x16x32_bf16 v[196:199], v[60:63], v[40:43], v[196:199]
v_mfma_f32_16x16x32_bf16 v[244:247], v[60:63], v[44:47], v[244:247]
s_waitcnt lgkmcnt(4)
s_nop 0
v_mfma_f32_16x16x32_bf16 v[80:83], v[48:51], v[32:35], v[80:83]
ds_read_b64_tr_b16 v[60:61], v11 offset:36992
v_mfma_f32_16x16x32_bf16 v[128:131], v[48:51], v[36:39], v[128:131]
ds_read_b64_tr_b16 v[62:63], v11 offset:38528
v_mfma_f32_16x16x32_bf16 v[176:179], v[48:51], v[40:43], v[176:179]
v_mfma_f32_16x16x32_bf16 v[224:227], v[48:51], v[44:47], v[224:227]
s_waitcnt lgkmcnt(4)
s_nop 0
v_mfma_f32_16x16x32_bf16 v[84:87], v[52:55], v[32:35], v[84:87]
s_waitcnt lgkmcnt(0)
s_barrier
v_mfma_f32_16x16x32_bf16 v[132:135], v[52:55], v[36:39], v[132:135]
ds_read_b128 v[16:19], v4 offset:16384
v_mfma_f32_16x16x32_bf16 v[180:183], v[52:55], v[40:43], v[180:183]
ds_read_b128 v[20:23], v4 offset:18432
v_mfma_f32_16x16x32_bf16 v[228:231], v[52:55], v[44:47], v[228:231]
ds_read_b64_tr_b16 v[48:49], v6 offset:0
v_mfma_f32_16x16x32_bf16 v[104:107], v[56:59], v[32:35], v[104:107]
ds_read_b64_tr_b16 v[50:51], v6 offset:1536
ds_read_b128 v[24:27], v4 offset:20480
v_mfma_f32_16x16x32_bf16 v[152:155], v[56:59], v[36:39], v[152:155]
ds_read_b128 v[28:31], v4 offset:22528
v_mfma_f32_16x16x32_bf16 v[200:203], v[56:59], v[40:43], v[200:203]
ds_read_b64_tr_b16 v[52:53], v7 offset:0
v_mfma_f32_16x16x32_bf16 v[248:251], v[56:59], v[44:47], v[248:251]
ds_read_b64_tr_b16 v[54:55], v7 offset:1536
v_mfma_f32_16x16x32_bf16 v[108:111], v[60:63], v[32:35], v[108:111]
ds_read_b64_tr_b16 v[56:57], v6 offset:12288
v_mfma_f32_16x16x32_bf16 v[156:159], v[60:63], v[36:39], v[156:159]
ds_read_b64_tr_b16 v[58:59], v6 offset:13824
v_mfma_f32_16x16x32_bf16 v[204:207], v[60:63], v[40:43], v[204:207]
v_mfma_f32_16x16x32_bf16 v[252:255], v[60:63], v[44:47], v[252:255]
s_waitcnt lgkmcnt(4)
s_nop 0
v_mfma_f32_16x16x32_bf16 v[64:67], v[48:51], v[16:19], v[64:67]
ds_read_b64_tr_b16 v[60:61], v7 offset:12288
v_mfma_f32_16x16x32_bf16 v[112:115], v[48:51], v[20:23], v[112:115]
ds_read_b64_tr_b16 v[62:63], v7 offset:13824
v_mfma_f32_16x16x32_bf16 v[160:163], v[48:51], v[24:27], v[160:163]
v_mfma_f32_16x16x32_bf16 v[208:211], v[48:51], v[28:31], v[208:211]
s_waitcnt lgkmcnt(4)
s_nop 0
v_mfma_f32_16x16x32_bf16 v[68:71], v[52:55], v[16:19], v[68:71]
ds_read_b64_tr_b16 v[48:49], v8 offset:0
v_mfma_f32_16x16x32_bf16 v[116:119], v[52:55], v[20:23], v[116:119]
ds_read_b64_tr_b16 v[50:51], v8 offset:1536
v_mfma_f32_16x16x32_bf16 v[164:167], v[52:55], v[24:27], v[164:167]
v_mfma_f32_16x16x32_bf16 v[212:215], v[52:55], v[28:31], v[212:215]
s_waitcnt lgkmcnt(4)
s_nop 0
v_mfma_f32_16x16x32_bf16 v[88:91], v[56:59], v[16:19], v[88:91]
ds_read_b64_tr_b16 v[52:53], v9 offset:0
v_mfma_f32_16x16x32_bf16 v[136:139], v[56:59], v[20:23], v[136:139]
ds_read_b64_tr_b16 v[54:55], v9 offset:1536
v_mfma_f32_16x16x32_bf16 v[184:187], v[56:59], v[24:27], v[184:187]
v_mfma_f32_16x16x32_bf16 v[232:235], v[56:59], v[28:31], v[232:235]
s_waitcnt lgkmcnt(4)
s_nop 0
v_mfma_f32_16x16x32_bf16 v[92:95], v[60:63], v[16:19], v[92:95]
ds_read_b64_tr_b16 v[56:57], v8 offset:12288
v_mfma_f32_16x16x32_bf16 v[140:143], v[60:63], v[20:23], v[140:143]
ds_read_b64_tr_b16 v[58:59], v8 offset:13824
v_mfma_f32_16x16x32_bf16 v[188:191], v[60:63], v[24:27], v[188:191]
v_mfma_f32_16x16x32_bf16 v[236:239], v[60:63], v[28:31], v[236:239]
s_waitcnt lgkmcnt(4)
s_nop 0
v_mfma_f32_16x16x32_bf16 v[72:75], v[48:51], v[16:19], v[72:75]
ds_read_b64_tr_b16 v[60:61], v9 offset:12288
v_mfma_f32_16x16x32_bf16 v[120:123], v[48:51], v[20:23], v[120:123]
ds_read_b64_tr_b16 v[62:63], v9 offset:13824
v_mfma_f32_16x16x32_bf16 v[168:171], v[48:51], v[24:27], v[168:171]
v_mfma_f32_16x16x32_bf16 v[216:219], v[48:51], v[28:31], v[216:219]
s_waitcnt lgkmcnt(4)
s_nop 0
v_mfma_f32_16x16x32_bf16 v[76:79], v[52:55], v[16:19], v[76:79]
ds_read_b64_tr_b16 v[48:49], v6 offset:128
v_mfma_f32_16x16x32_bf16 v[124:127], v[52:55], v[20:23], v[124:127]
ds_read_b64_tr_b16 v[50:51], v6 offset:1664
v_mfma_f32_16x16x32_bf16 v[172:175], v[52:55], v[24:27], v[172:175]
v_mfma_f32_16x16x32_bf16 v[220:223], v[52:55], v[28:31], v[220:223]
s_waitcnt lgkmcnt(4)
s_nop 0
v_mfma_f32_16x16x32_bf16 v[96:99], v[56:59], v[16:19], v[96:99]
ds_read_b64_tr_b16 v[52:53], v7 offset:128
v_mfma_f32_16x16x32_bf16 v[144:147], v[56:59], v[20:23], v[144:147]
ds_read_b64_tr_b16 v[54:55], v7 offset:1664
v_mfma_f32_16x16x32_bf16 v[192:195], v[56:59], v[24:27], v[192:195]
v_mfma_f32_16x16x32_bf16 v[240:243], v[56:59], v[28:31], v[240:243]
s_waitcnt lgkmcnt(4)
s_nop 0
v_mfma_f32_16x16x32_bf16 v[100:103], v[60:63], v[16:19], v[100:103]
ds_read_b64_tr_b16 v[56:57], v6 offset:12416
v_mfma_f32_16x16x32_bf16 v[148:151], v[60:63], v[20:23], v[148:151]
ds_read_b64_tr_b16 v[58:59], v6 offset:13952
v_mfma_f32_16x16x32_bf16 v[196:199], v[60:63], v[24:27], v[196:199]
v_mfma_f32_16x16x32_bf16 v[244:247], v[60:63], v[28:31], v[244:247]
s_waitcnt lgkmcnt(4)
s_nop 0
v_mfma_f32_16x16x32_bf16 v[80:83], v[48:51], v[16:19], v[80:83]
ds_read_b64_tr_b16 v[60:61], v7 offset:12416
v_mfma_f32_16x16x32_bf16 v[128:131], v[48:51], v[20:23], v[128:131]
ds_read_b64_tr_b16 v[62:63], v7 offset:13952
v_mfma_f32_16x16x32_bf16 v[176:179], v[48:51], v[24:27], v[176:179]
v_mfma_f32_16x16x32_bf16 v[224:227], v[48:51], v[28:31], v[224:227]
s_waitcnt lgkmcnt(4)
s_nop 0
v_mfma_f32_16x16x32_bf16 v[84:87], v[52:55], v[16:19], v[84:87]
s_waitcnt lgkmcnt(0)
s_barrier
v_mfma_f32_16x16x32_bf16 v[132:135], v[52:55], v[20:23], v[132:135]
ds_read_b128 v[32:35], v5 offset:16384
v_mfma_f32_16x16x32_bf16 v[180:183], v[52:55], v[24:27], v[180:183]
ds_read_b128 v[36:39], v5 offset:18432
v_mfma_f32_16x16x32_bf16 v[228:231], v[52:55], v[28:31], v[228:231]
ds_read_b64_tr_b16 v[48:49], v6 offset:24576
v_mfma_f32_16x16x32_bf16 v[104:107], v[56:59], v[16:19], v[104:107]
ds_read_b64_tr_b16 v[50:51], v6 offset:26112
ds_read_b128 v[40:43], v5 offset:20480
v_mfma_f32_16x16x32_bf16 v[152:155], v[56:59], v[20:23], v[152:155]
ds_read_b128 v[44:47], v5 offset:22528
v_mfma_f32_16x16x32_bf16 v[200:203], v[56:59], v[24:27], v[200:203]
ds_read_b64_tr_b16 v[52:53], v7 offset:24576
v_mfma_f32_16x16x32_bf16 v[248:251], v[56:59], v[28:31], v[248:251]
ds_read_b64_tr_b16 v[54:55], v7 offset:26112
v_mfma_f32_16x16x32_bf16 v[108:111], v[60:63], v[16:19], v[108:111]
ds_read_b64_tr_b16 v[56:57], v6 offset:36864
v_mfma_f32_16x16x32_bf16 v[156:159], v[60:63], v[20:23], v[156:159]
ds_read_b64_tr_b16 v[58:59], v6 offset:38400
v_mfma_f32_16x16x32_bf16 v[204:207], v[60:63], v[24:27], v[204:207]
v_mfma_f32_16x16x32_bf16 v[252:255], v[60:63], v[28:31], v[252:255]
s_waitcnt lgkmcnt(4)
s_nop 0
v_mfma_f32_16x16x32_bf16 v[64:67], v[48:51], v[32:35], v[64:67]
ds_read_b64_tr_b16 v[60:61], v7 offset:36864
v_mfma_f32_16x16x32_bf16 v[112:115], v[48:51], v[36:39], v[112:115]
ds_read_b64_tr_b16 v[62:63], v7 offset:38400
v_mfma_f32_16x16x32_bf16 v[160:163], v[48:51], v[40:43], v[160:163]
v_mfma_f32_16x16x32_bf16 v[208:211], v[48:51], v[44:47], v[208:211]
s_waitcnt lgkmcnt(4)
s_nop 0
v_mfma_f32_16x16x32_bf16 v[68:71], v[52:55], v[32:35], v[68:71]
ds_read_b64_tr_b16 v[48:49], v8 offset:24576
v_mfma_f32_16x16x32_bf16 v[116:119], v[52:55], v[36:39], v[116:119]
ds_read_b64_tr_b16 v[50:51], v8 offset:26112
v_mfma_f32_16x16x32_bf16 v[164:167], v[52:55], v[40:43], v[164:167]
v_mfma_f32_16x16x32_bf16 v[212:215], v[52:55], v[44:47], v[212:215]
s_waitcnt lgkmcnt(4)
s_nop 0
v_mfma_f32_16x16x32_bf16 v[88:91], v[56:59], v[32:35], v[88:91]
ds_read_b64_tr_b16 v[52:53], v9 offset:24576
v_mfma_f32_16x16x32_bf16 v[136:139], v[56:59], v[36:39], v[136:139]
ds_read_b64_tr_b16 v[54:55], v9 offset:26112
v_mfma_f32_16x16x32_bf16 v[184:187], v[56:59], v[40:43], v[184:187]
v_mfma_f32_16x16x32_bf16 v[232:235], v[56:59], v[44:47], v[232:235]
s_waitcnt lgkmcnt(4)
s_nop 0
v_mfma_f32_16x16x32_bf16 v[92:95], v[60:63], v[32:35], v[92:95]
ds_read_b64_tr_b16 v[56:57], v8 offset:36864
v_mfma_f32_16x16x32_bf16 v[140:143], v[60:63], v[36:39], v[140:143]
ds_read_b64_tr_b16 v[58:59], v8 offset:38400
v_mfma_f32_16x16x32_bf16 v[188:191], v[60:63], v[40:43], v[188:191]
v_mfma_f32_16x16x32_bf16 v[236:239], v[60:63], v[44:47], v[236:239]
s_waitcnt lgkmcnt(4)
s_nop 0
v_mfma_f32_16x16x32_bf16 v[72:75], v[48:51], v[32:35], v[72:75]
ds_read_b64_tr_b16 v[60:61], v9 offset:36864
v_mfma_f32_16x16x32_bf16 v[120:123], v[48:51], v[36:39], v[120:123]
ds_read_b64_tr_b16 v[62:63], v9 offset:38400
v_mfma_f32_16x16x32_bf16 v[168:171], v[48:51], v[40:43], v[168:171]
v_mfma_f32_16x16x32_bf16 v[216:219], v[48:51], v[44:47], v[216:219]
s_waitcnt lgkmcnt(4)
s_nop 0
v_mfma_f32_16x16x32_bf16 v[76:79], v[52:55], v[32:35], v[76:79]
ds_read_b64_tr_b16 v[48:49], v6 offset:24704
v_mfma_f32_16x16x32_bf16 v[124:127], v[52:55], v[36:39], v[124:127]
ds_read_b64_tr_b16 v[50:51], v6 offset:26240
v_mfma_f32_16x16x32_bf16 v[172:175], v[52:55], v[40:43], v[172:175]
v_mfma_f32_16x16x32_bf16 v[220:223], v[52:55], v[44:47], v[220:223]
s_waitcnt lgkmcnt(4)
s_nop 0
v_mfma_f32_16x16x32_bf16 v[96:99], v[56:59], v[32:35], v[96:99]
ds_read_b64_tr_b16 v[52:53], v7 offset:24704
v_mfma_f32_16x16x32_bf16 v[144:147], v[56:59], v[36:39], v[144:147]
ds_read_b64_tr_b16 v[54:55], v7 offset:26240
v_mfma_f32_16x16x32_bf16 v[192:195], v[56:59], v[40:43], v[192:195]
v_mfma_f32_16x16x32_bf16 v[240:243], v[56:59], v[44:47], v[240:243]
s_waitcnt lgkmcnt(4)
s_nop 0
v_mfma_f32_16x16x32_bf16 v[100:103], v[60:63], v[32:35], v[100:103]
ds_read_b64_tr_b16 v[56:57], v6 offset:36992
v_mfma_f32_16x16x32_bf16 v[148:151], v[60:63], v[36:39], v[148:151]
ds_read_b64_tr_b16 v[58:59], v6 offset:38528
v_mfma_f32_16x16x32_bf16 v[196:199], v[60:63], v[40:43], v[196:199]
v_mfma_f32_16x16x32_bf16 v[244:247], v[60:63], v[44:47], v[244:247]
s_waitcnt lgkmcnt(4)
s_nop 0
v_mfma_f32_16x16x32_bf16 v[80:83], v[48:51], v[32:35], v[80:83]
ds_read_b64_tr_b16 v[60:61], v7 offset:36992
v_mfma_f32_16x16x32_bf16 v[128:131], v[48:51], v[36:39], v[128:131]
ds_read_b64_tr_b16 v[62:63], v7 offset:38528
v_mfma_f32_16x16x32_bf16 v[176:179], v[48:51], v[40:43], v[176:179]
v_mfma_f32_16x16x32_bf16 v[224:227], v[48:51], v[44:47], v[224:227]
s_waitcnt lgkmcnt(4)
s_nop 0
v_mfma_f32_16x16x32_bf16 v[84:87], v[52:55], v[32:35], v[84:87]
s_waitcnt lgkmcnt(0)
s_barrier
v_mfma_f32_16x16x32_bf16 v[132:135], v[52:55], v[36:39], v[132:135]
ds_read_b128 v[16:19], v4 offset:0
v_mfma_f32_16x16x32_bf16 v[180:183], v[52:55], v[40:43], v[180:183]
ds_read_b128 v[20:23], v4 offset:2048
v_mfma_f32_16x16x32_bf16 v[228:231], v[52:55], v[44:47], v[228:231]
ds_read_b64_tr_b16 v[48:49], v10 offset:0
v_mfma_f32_16x16x32_bf16 v[104:107], v[56:59], v[32:35], v[104:107]
ds_read_b64_tr_b16 v[50:51], v10 offset:1536
ds_read_b128 v[24:27], v4 offset:4096
v_mfma_f32_16x16x32_bf16 v[152:155], v[56:59], v[36:39], v[152:155]
ds_read_b128 v[28:31], v4 offset:6144
v_mfma_f32_16x16x32_bf16 v[200:203], v[56:59], v[40:43], v[200:203]
ds_read_b64_tr_b16 v[52:53], v11 offset:0
v_mfma_f32_16x16x32_bf16 v[248:251], v[56:59], v[44:47], v[248:251]
ds_read_b64_tr_b16 v[54:55], v11 offset:1536
v_mfma_f32_16x16x32_bf16 v[108:111], v[60:63], v[32:35], v[108:111]
ds_read_b64_tr_b16 v[56:57], v10 offset:12288
v_mfma_f32_16x16x32_bf16 v[156:159], v[60:63], v[36:39], v[156:159]
ds_read_b64_tr_b16 v[58:59], v10 offset:13824
v_mfma_f32_16x16x32_bf16 v[204:207], v[60:63], v[40:43], v[204:207]
v_mfma_f32_16x16x32_bf16 v[252:255], v[60:63], v[44:47], v[252:255]
s_waitcnt lgkmcnt(4)
s_nop 0
v_mfma_f32_16x16x32_bf16 v[64:67], v[48:51], v[16:19], v[64:67]
ds_read_b64_tr_b16 v[60:61], v11 offset:12288
v_mfma_f32_16x16x32_bf16 v[112:115], v[48:51], v[20:23], v[112:115]
ds_read_b64_tr_b16 v[62:63], v11 offset:13824
v_mfma_f32_16x16x32_bf16 v[160:163], v[48:51], v[24:27], v[160:163]
v_mfma_f32_16x16x32_bf16 v[208:211], v[48:51], v[28:31], v[208:211]
s_waitcnt lgkmcnt(4)
s_nop 0
v_mfma_f32_16x16x32_bf16 v[68:71], v[52:55], v[16:19], v[68:71]
ds_read_b64_tr_b16 v[48:49], v12 offset:0
v_mfma_f32_16x16x32_bf16 v[116:119], v[52:55], v[20:23], v[116:119]
ds_read_b64_tr_b16 v[50:51], v12 offset:1536
v_mfma_f32_16x16x32_bf16 v[164:167], v[52:55], v[24:27], v[164:167]
v_mfma_f32_16x16x32_bf16 v[212:215], v[52:55], v[28:31], v[212:215]
s_waitcnt lgkmcnt(4)
s_nop 0
v_mfma_f32_16x16x32_bf16 v[88:91], v[56:59], v[16:19], v[88:91]
ds_read_b64_tr_b16 v[52:53], v13 offset:0
v_mfma_f32_16x16x32_bf16 v[136:139], v[56:59], v[20:23], v[136:139]
ds_read_b64_tr_b16 v[54:55], v13 offset:1536
v_mfma_f32_16x16x32_bf16 v[184:187], v[56:59], v[24:27], v[184:187]
v_mfma_f32_16x16x32_bf16 v[232:235], v[56:59], v[28:31], v[232:235]
s_waitcnt lgkmcnt(4)
s_nop 0
v_mfma_f32_16x16x32_bf16 v[92:95], v[60:63], v[16:19], v[92:95]
ds_read_b64_tr_b16 v[56:57], v12 offset:12288
v_mfma_f32_16x16x32_bf16 v[140:143], v[60:63], v[20:23], v[140:143]
ds_read_b64_tr_b16 v[58:59], v12 offset:13824
v_mfma_f32_16x16x32_bf16 v[188:191], v[60:63], v[24:27], v[188:191]
v_mfma_f32_16x16x32_bf16 v[236:239], v[60:63], v[28:31], v[236:239]
s_waitcnt lgkmcnt(4)
s_nop 0
v_mfma_f32_16x16x32_bf16 v[72:75], v[48:51], v[16:19], v[72:75]
ds_read_b64_tr_b16 v[60:61], v13 offset:12288
v_mfma_f32_16x16x32_bf16 v[120:123], v[48:51], v[20:23], v[120:123]
ds_read_b64_tr_b16 v[62:63], v13 offset:13824
v_mfma_f32_16x16x32_bf16 v[168:171], v[48:51], v[24:27], v[168:171]
v_mfma_f32_16x16x32_bf16 v[216:219], v[48:51], v[28:31], v[216:219]
s_waitcnt lgkmcnt(4)
s_nop 0
v_mfma_f32_16x16x32_bf16 v[76:79], v[52:55], v[16:19], v[76:79]
ds_read_b64_tr_b16 v[48:49], v10 offset:128
v_mfma_f32_16x16x32_bf16 v[124:127], v[52:55], v[20:23], v[124:127]
ds_read_b64_tr_b16 v[50:51], v10 offset:1664
v_mfma_f32_16x16x32_bf16 v[172:175], v[52:55], v[24:27], v[172:175]
v_mfma_f32_16x16x32_bf16 v[220:223], v[52:55], v[28:31], v[220:223]
s_waitcnt lgkmcnt(4)
s_nop 0
v_mfma_f32_16x16x32_bf16 v[96:99], v[56:59], v[16:19], v[96:99]
ds_read_b64_tr_b16 v[52:53], v11 offset:128
v_mfma_f32_16x16x32_bf16 v[144:147], v[56:59], v[20:23], v[144:147]
ds_read_b64_tr_b16 v[54:55], v11 offset:1664
v_mfma_f32_16x16x32_bf16 v[192:195], v[56:59], v[24:27], v[192:195]
v_mfma_f32_16x16x32_bf16 v[240:243], v[56:59], v[28:31], v[240:243]
s_waitcnt lgkmcnt(4)
s_nop 0
v_mfma_f32_16x16x32_bf16 v[100:103], v[60:63], v[16:19], v[100:103]
ds_read_b64_tr_b16 v[56:57], v10 offset:12416
v_mfma_f32_16x16x32_bf16 v[148:151], v[60:63], v[20:23], v[148:151]
ds_read_b64_tr_b16 v[58:59], v10 offset:13952
v_mfma_f32_16x16x32_bf16 v[196:199], v[60:63], v[24:27], v[196:199]
v_mfma_f32_16x16x32_bf16 v[244:247], v[60:63], v[28:31], v[244:247]
s_waitcnt lgkmcnt(4)
s_nop 0
v_mfma_f32_16x16x32_bf16 v[80:83], v[48:51], v[16:19], v[80:83]
ds_read_b64_tr_b16 v[60:61], v11 offset:12416
v_mfma_f32_16x16x32_bf16 v[128:131], v[48:51], v[20:23], v[128:131]
ds_read_b64_tr_b16 v[62:63], v11 offset:13952
v_mfma_f32_16x16x32_bf16 v[176:179], v[48:51], v[24:27], v[176:179]
v_mfma_f32_16x16x32_bf16 v[224:227], v[48:51], v[28:31], v[224:227]
s_waitcnt lgkmcnt(4)
s_nop 0
v_mfma_f32_16x16x32_bf16 v[84:87], v[52:55], v[16:19], v[84:87]
s_waitcnt lgkmcnt(0)
s_barrier
v_mfma_f32_16x16x32_bf16 v[132:135], v[52:55], v[20:23], v[132:135]
ds_read_b128 v[32:35], v5 offset:0
v_mfma_f32_16x16x32_bf16 v[180:183], v[52:55], v[24:27], v[180:183]
ds_read_b128 v[36:39], v5 offset:2048
v_mfma_f32_16x16x32_bf16 v[228:231], v[52:55], v[28:31], v[228:231]
ds_read_b64_tr_b16 v[48:49], v10 offset:24576
v_mfma_f32_16x16x32_bf16 v[104:107], v[56:59], v[16:19], v[104:107]
ds_read_b64_tr_b16 v[50:51], v10 offset:26112
ds_read_b128 v[40:43], v5 offset:4096
v_mfma_f32_16x16x32_bf16 v[152:155], v[56:59], v[20:23], v[152:155]
ds_read_b128 v[44:47], v5 offset:6144
v_mfma_f32_16x16x32_bf16 v[200:203], v[56:59], v[24:27], v[200:203]
ds_read_b64_tr_b16 v[52:53], v11 offset:24576
v_mfma_f32_16x16x32_bf16 v[248:251], v[56:59], v[28:31], v[248:251]
ds_read_b64_tr_b16 v[54:55], v11 offset:26112
v_mfma_f32_16x16x32_bf16 v[108:111], v[60:63], v[16:19], v[108:111]
ds_read_b64_tr_b16 v[56:57], v10 offset:36864
v_mfma_f32_16x16x32_bf16 v[156:159], v[60:63], v[20:23], v[156:159]
ds_read_b64_tr_b16 v[58:59], v10 offset:38400
v_mfma_f32_16x16x32_bf16 v[204:207], v[60:63], v[24:27], v[204:207]
v_mfma_f32_16x16x32_bf16 v[252:255], v[60:63], v[28:31], v[252:255]
s_waitcnt lgkmcnt(4)
s_nop 0
v_mfma_f32_16x16x32_bf16 v[64:67], v[48:51], v[32:35], v[64:67]
ds_read_b64_tr_b16 v[60:61], v11 offset:36864
v_mfma_f32_16x16x32_bf16 v[112:115], v[48:51], v[36:39], v[112:115]
ds_read_b64_tr_b16 v[62:63], v11 offset:38400
v_mfma_f32_16x16x32_bf16 v[160:163], v[48:51], v[40:43], v[160:163]
v_mfma_f32_16x16x32_bf16 v[208:211], v[48:51], v[44:47], v[208:211]
s_waitcnt lgkmcnt(4)
s_nop 0
v_mfma_f32_16x16x32_bf16 v[68:71], v[52:55], v[32:35], v[68:71]
ds_read_b64_tr_b16 v[48:49], v12 offset:24576
v_mfma_f32_16x16x32_bf16 v[116:119], v[52:55], v[36:39], v[116:119]
ds_read_b64_tr_b16 v[50:51], v12 offset:26112
v_mfma_f32_16x16x32_bf16 v[164:167], v[52:55], v[40:43], v[164:167]
v_mfma_f32_16x16x32_bf16 v[212:215], v[52:55], v[44:47], v[212:215]
s_waitcnt lgkmcnt(4)
s_nop 0
v_mfma_f32_16x16x32_bf16 v[88:91], v[56:59], v[32:35], v[88:91]
ds_read_b64_tr_b16 v[52:53], v13 offset:24576
v_mfma_f32_16x16x32_bf16 v[136:139], v[56:59], v[36:39], v[136:139]
ds_read_b64_tr_b16 v[54:55], v13 offset:26112
v_mfma_f32_16x16x32_bf16 v[184:187], v[56:59], v[40:43], v[184:187]
v_mfma_f32_16x16x32_bf16 v[232:235], v[56:59], v[44:47], v[232:235]
s_waitcnt lgkmcnt(4)
s_nop 0
v_mfma_f32_16x16x32_bf16 v[92:95], v[60:63], v[32:35], v[92:95]
ds_read_b64_tr_b16 v[56:57], v12 offset:36864
v_mfma_f32_16x16x32_bf16 v[140:143], v[60:63], v[36:39], v[140:143]
ds_read_b64_tr_b16 v[58:59], v12 offset:38400
v_mfma_f32_16x16x32_bf16 v[188:191], v[60:63], v[40:43], v[188:191]
v_mfma_f32_16x16x32_bf16 v[236:239], v[60:63], v[44:47], v[236:239]
s_waitcnt lgkmcnt(4)
s_nop 0
v_mfma_f32_16x16x32_bf16 v[72:75], v[48:51], v[32:35], v[72:75]
ds_read_b64_tr_b16 v[60:61], v13 offset:36864
v_mfma_f32_16x16x32_bf16 v[120:123], v[48:51], v[36:39], v[120:123]
ds_read_b64_tr_b16 v[62:63], v13 offset:38400
v_mfma_f32_16x16x32_bf16 v[168:171], v[48:51], v[40:43], v[168:171]
v_mfma_f32_16x16x32_bf16 v[216:219], v[48:51], v[44:47], v[216:219]
s_waitcnt lgkmcnt(4)
s_nop 0
v_mfma_f32_16x16x32_bf16 v[76:79], v[52:55], v[32:35], v[76:79]
ds_read_b64_tr_b16 v[48:49], v10 offset:24704
v_mfma_f32_16x16x32_bf16 v[124:127], v[52:55], v[36:39], v[124:127]
ds_read_b64_tr_b16 v[50:51], v10 offset:26240
v_mfma_f32_16x16x32_bf16 v[172:175], v[52:55], v[40:43], v[172:175]
v_mfma_f32_16x16x32_bf16 v[220:223], v[52:55], v[44:47], v[220:223]
s_waitcnt lgkmcnt(4)
s_nop 0
v_mfma_f32_16x16x32_bf16 v[96:99], v[56:59], v[32:35], v[96:99]
ds_read_b64_tr_b16 v[52:53], v11 offset:24704
v_mfma_f32_16x16x32_bf16 v[144:147], v[56:59], v[36:39], v[144:147]
ds_read_b64_tr_b16 v[54:55], v11 offset:26240
v_mfma_f32_16x16x32_bf16 v[192:195], v[56:59], v[40:43], v[192:195]
v_mfma_f32_16x16x32_bf16 v[240:243], v[56:59], v[44:47], v[240:243]
s_waitcnt lgkmcnt(4)
s_nop 0
v_mfma_f32_16x16x32_bf16 v[100:103], v[60:63], v[32:35], v[100:103]
ds_read_b64_tr_b16 v[56:57], v10 offset:36992
v_mfma_f32_16x16x32_bf16 v[148:151], v[60:63], v[36:39], v[148:151]
ds_read_b64_tr_b16 v[58:59], v10 offset:38528
v_mfma_f32_16x16x32_bf16 v[196:199], v[60:63], v[40:43], v[196:199]
v_mfma_f32_16x16x32_bf16 v[244:247], v[60:63], v[44:47], v[244:247]
s_waitcnt lgkmcnt(4)
s_nop 0
v_mfma_f32_16x16x32_bf16 v[80:83], v[48:51], v[32:35], v[80:83]
ds_read_b64_tr_b16 v[60:61], v11 offset:36992
v_mfma_f32_16x16x32_bf16 v[128:131], v[48:51], v[36:39], v[128:131]
ds_read_b64_tr_b16 v[62:63], v11 offset:38528
v_mfma_f32_16x16x32_bf16 v[176:179], v[48:51], v[40:43], v[176:179]
v_mfma_f32_16x16x32_bf16 v[224:227], v[48:51], v[44:47], v[224:227]
s_waitcnt lgkmcnt(4)
s_nop 0
v_mfma_f32_16x16x32_bf16 v[84:87], v[52:55], v[32:35], v[84:87]
s_waitcnt lgkmcnt(0)
s_barrier
v_mfma_f32_16x16x32_bf16 v[132:135], v[52:55], v[36:39], v[132:135]
ds_read_b128 v[6:9], v14 offset:0
v_mfma_f32_16x16x32_bf16 v[180:183], v[52:55], v[40:43], v[180:183]
ds_read_b128 v[10:13], v14 offset:64
v_mfma_f32_16x16x32_bf16 v[228:231], v[52:55], v[44:47], v[228:231]
ds_read_b128 v[48:51], v14 offset:768
v_mfma_f32_16x16x32_bf16 v[104:107], v[56:59], v[32:35], v[104:107]
ds_read2_b32 v[16:17], v15 offset0:0 offset1:0
v_mfma_f32_16x16x32_bf16 v[152:155], v[56:59], v[36:39], v[152:155]
ds_read2_b32 v[20:21], v15 offset0:32 offset1:32
v_mfma_f32_16x16x32_bf16 v[200:203], v[56:59], v[40:43], v[200:203]
ds_read2_b32 v[24:25], v15 offset0:64 offset1:64
v_mfma_f32_16x16x32_bf16 v[248:251], v[56:59], v[44:47], v[248:251]
v_mfma_f32_16x16x32_bf16 v[108:111], v[60:63], v[32:35], v[108:111]
ds_read2_b32 v[28:29], v15 offset0:96 offset1:96
v_mfma_f32_16x16x32_bf16 v[156:159], v[60:63], v[36:39], v[156:159]
ds_read_b64 v[4:5], v1
v_mfma_f32_16x16x32_bf16 v[204:207], v[60:63], v[40:43], v[204:207]
ds_read_b128 v[52:55], v14 offset:832
v_mfma_f32_16x16x32_bf16 v[252:255], v[60:63], v[44:47], v[252:255]
H_EPI:
ds_read_b128 v[32:35], v14 offset:128
ds_read_b128 v[36:39], v14 offset:192
ds_read_b128 v[40:43], v14 offset:896
ds_read_b128 v[44:47], v14 offset:960
ds_read_b128 v[56:59], v14 offset:256
ds_read_b128 v[60:63], v14 offset:320
s_waitcnt lgkmcnt(6)
s_nop 0
v_pk_fma_f32 v[64:65], v[16:17], v[6:7], v[64:65]
v_pk_fma_f32 v[66:67], v[16:17], v[8:9], v[66:67]
v_pk_fma_f32 v[68:69], v[16:17], v[10:11], v[68:69]
v_pk_fma_f32 v[70:71], v[16:17], v[12:13], v[70:71]
v_pk_fma_f32 v[88:89], v[16:17], v[48:49], v[88:89]
v_pk_fma_f32 v[90:91], v[16:17], v[50:51], v[90:91]
v_pk_fma_f32 v[92:93], v[16:17], v[52:53], v[92:93]
v_pk_fma_f32 v[94:95], v[16:17], v[54:55], v[94:95]
v_pk_mul_f32 v[64:65], v[64:65], v[88:89]
v_pk_mul_f32 v[66:67], v[66:67], v[90:91]
v_pk_mul_f32 v[68:69], v[68:69], v[92:93]
v_pk_mul_f32 v[70:71], v[70:71], v[94:95]
v_cvt_pk_bf16_f32 v88, v64, v65
v_cvt_pk_bf16_f32 v89, v66, v67
v_cvt_pk_bf16_f32 v90, v68, v69
v_cvt_pk_bf16_f32 v91, v70, v71
buffer_store_dwordx4 v[88:91], v2, s[32:35], s70 offen offset:0 sc1
ds_read_b128 v[64:67], v14 offset:1024
ds_read_b128 v[68:71], v14 offset:1088
v_pk_fma_f32 v[112:113], v[20:21], v[6:7], v[112:113]
v_pk_fma_f32 v[114:115], v[20:21], v[8:9], v[114:115]
v_pk_fma_f32 v[116:117], v[20:21], v[10:11], v[116:117]
v_pk_fma_f32 v[118:119], v[20:21], v[12:13], v[118:119]
v_pk_fma_f32 v[136:137], v[20:21], v[48:49], v[136:137]
v_pk_fma_f32 v[138:139], v[20:21], v[50:51], v[138:139]
v_pk_fma_f32 v[140:141], v[20:21], v[52:53], v[140:141]
v_pk_fma_f32 v[142:143], v[20:21], v[54:55], v[142:143]
v_pk_mul_f32 v[112:113], v[112:113], v[136:137]
v_pk_mul_f32 v[114:115], v[114:115], v[138:139]
v_pk_mul_f32 v[116:117], v[116:117], v[140:141]
v_pk_mul_f32 v[118:119], v[118:119], v[142:143]
v_cvt_pk_bf16_f32 v136, v112, v113
v_cvt_pk_bf16_f32 v137, v114, v115
v_cvt_pk_bf16_f32 v138, v116, v117
v_cvt_pk_bf16_f32 v139, v118, v119
buffer_store_dwordx4 v[136:139], v2, s[32:35], s70 offen offset:1024 sc1
v_pk_fma_f32 v[160:161], v[24:25], v[6:7], v[160:161]
v_pk_fma_f32 v[162:163], v[24:25], v[8:9], v[162:163]
v_pk_fma_f32 v[164:165], v[24:25], v[10:11], v[164:165]
v_pk_fma_f32 v[166:167], v[24:25], v[12:13], v[166:167]
v_pk_fma_f32 v[184:185], v[24:25], v[48:49], v[184:185]
v_pk_fma_f32 v[186:187], v[24:25], v[50:51], v[186:187]
v_pk_fma_f32 v[188:189], v[24:25], v[52:53], v[188:189]
v_pk_fma_f32 v[190:191], v[24:25], v[54:55], v[190:191]
v_pk_mul_f32 v[160:161], v[160:161], v[184:185]
v_pk_mul_f32 v[162:163], v[162:163], v[186:187]
v_pk_mul_f32 v[164:165], v[164:165], v[188:189]
v_pk_mul_f32 v[166:167], v[166:167], v[190:191]
v_cvt_pk_bf16_f32 v184, v160, v161
v_cvt_pk_bf16_f32 v185, v162, v163
v_cvt_pk_bf16_f32 v186, v164, v165
v_cvt_pk_bf16_f32 v187, v166, v167
buffer_store_dwordx4 v[184:187], v2, s[32:35], s70 offen offset:2048 sc1
v_pk_fma_f32 v[208:209], v[28:29], v[6:7], v[208:209]
v_pk_fma_f32 v[210:211], v[28:29], v[8:9], v[210:211]
v_pk_fma_f32 v[212:213], v[28:29], v[10:11], v[212:213]
v_pk_fma_f32 v[214:215], v[28:29], v[12:13], v[214:215]
v_pk_fma_f32 v[232:233], v[28:29], v[48:49], v[232:233]
v_pk_fma_f32 v[234:235], v[28:29], v[50:51], v[234:235]
v_pk_fma_f32 v[236:237], v[28:29], v[52:53], v[236:237]
v_pk_fma_f32 v[238:239], v[28:29], v[54:55], v[238:239]
v_pk_mul_f32 v[208:209], v[208:209], v[232:233]
v_pk_mul_f32 v[210:211], v[210:211], v[234:235]
v_pk_mul_f32 v[212:213], v[212:213], v[236:237]
v_pk_mul_f32 v[214:215], v[214:215], v[238:239]
v_cvt_pk_bf16_f32 v232, v208, v209
v_cvt_pk_bf16_f32 v233, v210, v211
v_cvt_pk_bf16_f32 v234, v212, v213
v_cvt_pk_bf16_f32 v235, v214, v215
buffer_store_dwordx4 v[232:235], v2, s[32:35], s70 offen offset:3072 sc1
s_waitcnt lgkmcnt(0)
s_nop 0
v_pk_fma_f32 v[72:73], v[16:17], v[32:33], v[72:73]
v_pk_fma_f32 v[74:75], v[16:17], v[34:35], v[74:75]
v_pk_fma_f32 v[76:77], v[16:17], v[36:37], v[76:77]
v_pk_fma_f32 v[78:79], v[16:17], v[38:39], v[78:79]
v_pk_fma_f32 v[96:97], v[16:17], v[40:41], v[96:97]
v_pk_fma_f32 v[98:99], v[16:17], v[42:43], v[98:99]
v_pk_fma_f32 v[100:101], v[16:17], v[44:45], v[100:101]
v_pk_fma_f32 v[102:103], v[16:17], v[46:47], v[102:103]
v_pk_mul_f32 v[72:73], v[72:73], v[96:97]
v_pk_mul_f32 v[74:75], v[74:75], v[98:99]
v_pk_mul_f32 v[76:77], v[76:77], v[100:101]
v_pk_mul_f32 v[78:79], v[78:79], v[102:103]
v_cvt_pk_bf16_f32 v96, v72, v73
v_cvt_pk_bf16_f32 v97, v74, v75
v_cvt_pk_bf16_f32 v98, v76, v77
v_cvt_pk_bf16_f32 v99, v78, v79
buffer_store_dwordx4 v[96:99], v2, s[32:35], s71 offen offset:0 sc1
v_pk_fma_f32 v[120:121], v[20:21], v[32:33], v[120:121]
v_pk_fma_f32 v[122:123], v[20:21], v[34:35], v[122:123]
v_pk_fma_f32 v[124:125], v[20:21], v[36:37], v[124:125]
v_pk_fma_f32 v[126:127], v[20:21], v[38:39], v[126:127]
v_pk_fma_f32 v[144:145], v[20:21], v[40:41], v[144:145]
v_pk_fma_f32 v[146:147], v[20:21], v[42:43], v[146:147]
v_pk_fma_f32 v[148:149], v[20:21], v[44:45], v[148:149]
v_pk_fma_f32 v[150:151], v[20:21], v[46:47], v[150:151]
v_pk_mul_f32 v[120:121], v[120:121], v[144:145]
v_pk_mul_f32 v[122:123], v[122:123], v[146:147]
v_pk_mul_f32 v[124:125], v[124:125], v[148:149]
v_pk_mul_f32 v[126:127], v[126:127], v[150:151]
v_cvt_pk_bf16_f32 v144, v120, v121
v_cvt_pk_bf16_f32 v145, v122, v123
v_cvt_pk_bf16_f32 v146, v124, v125
v_cvt_pk_bf16_f32 v147, v126, v127
buffer_store_dwordx4 v[144:147], v2, s[32:35], s71 offen offset:1024 sc1
v_pk_fma_f32 v[168:169], v[24:25], v[32:33], v[168:169]
v_pk_fma_f32 v[170:171], v[24:25], v[34:35], v[170:171]
v_pk_fma_f32 v[172:173], v[24:25], v[36:37], v[172:173]
v_pk_fma_f32 v[174:175], v[24:25], v[38:39], v[174:175]
v_pk_fma_f32 v[192:193], v[24:25], v[40:41], v[192:193]
v_pk_fma_f32 v[194:195], v[24:25], v[42:43], v[194:195]
v_pk_fma_f32 v[196:197], v[24:25], v[44:45], v[196:197]
v_pk_fma_f32 v[198:199], v[24:25], v[46:47], v[198:199]
v_pk_mul_f32 v[168:169], v[168:169], v[192:193]
v_pk_mul_f32 v[170:171], v[170:171], v[194:195]
v_pk_mul_f32 v[172:173], v[172:173], v[196:197]
v_pk_mul_f32 v[174:175], v[174:175], v[198:199]
v_cvt_pk_bf16_f32 v192, v168, v169
v_cvt_pk_bf16_f32 v193, v170, v171
v_cvt_pk_bf16_f32 v194, v172, v173
v_cvt_pk_bf16_f32 v195, v174, v175
buffer_store_dwordx4 v[192:195], v2, s[32:35], s71 offen offset:2048 sc1
v_pk_fma_f32 v[216:217], v[28:29], v[32:33], v[216:217]
v_pk_fma_f32 v[218:219], v[28:29], v[34:35], v[218:219]
v_pk_fma_f32 v[220:221], v[28:29], v[36:37], v[220:221]
v_pk_fma_f32 v[222:223], v[28:29], v[38:39], v[222:223]
v_pk_fma_f32 v[240:241], v[28:29], v[40:41], v[240:241]
v_pk_fma_f32 v[242:243], v[28:29], v[42:43], v[242:243]
v_pk_fma_f32 v[244:245], v[28:29], v[44:45], v[244:245]
v_pk_fma_f32 v[246:247], v[28:29], v[46:47], v[246:247]
v_pk_mul_f32 v[216:217], v[216:217], v[240:241]
v_pk_mul_f32 v[218:219], v[218:219], v[242:243]
v_pk_mul_f32 v[220:221], v[220:221], v[244:245]
v_pk_mul_f32 v[222:223], v[222:223], v[246:247]
v_cvt_pk_bf16_f32 v240, v216, v217
v_cvt_pk_bf16_f32 v241, v218, v219
v_cvt_pk_bf16_f32 v242, v220, v221
v_cvt_pk_bf16_f32 v243, v222, v223
buffer_store_dwordx4 v[240:243], v2, s[32:35], s71 offen offset:3072 sc1
v_pk_fma_f32 v[80:81], v[16:17], v[56:57], v[80:81]
v_pk_fma_f32 v[82:83], v[16:17], v[58:59], v[82:83]
v_pk_fma_f32 v[84:85], v[16:17], v[60:61], v[84:85]
v_pk_fma_f32 v[86:87], v[16:17], v[62:63], v[86:87]
v_pk_fma_f32 v[104:105], v[16:17], v[64:65], v[104:105]
v_pk_fma_f32 v[106:107], v[16:17], v[66:67], v[106:107]
v_pk_fma_f32 v[108:109], v[16:17], v[68:69], v[108:109]
v_pk_fma_f32 v[110:111], v[16:17], v[70:71], v[110:111]
v_pk_mul_f32 v[80:81], v[80:81], v[104:105]
v_pk_mul_f32 v[82:83], v[82:83], v[106:107]
v_pk_mul_f32 v[84:85], v[84:85], v[108:109]
v_pk_mul_f32 v[86:87], v[86:87], v[110:111]
v_cvt_pk_bf16_f32 v104, v80, v81
v_cvt_pk_bf16_f32 v105, v82, v83
v_cvt_pk_bf16_f32 v106, v84, v85
v_cvt_pk_bf16_f32 v107, v86, v87
buffer_store_dwordx4 v[104:107], v2, s[32:35], s72 offen offset:0 sc1
v_pk_fma_f32 v[128:129], v[20:21], v[56:57], v[128:129]
v_pk_fma_f32 v[130:131], v[20:21], v[58:59], v[130:131]
v_pk_fma_f32 v[132:133], v[20:21], v[60:61], v[132:133]
v_pk_fma_f32 v[134:135], v[20:21], v[62:63], v[134:135]
v_pk_fma_f32 v[152:153], v[20:21], v[64:65], v[152:153]
v_pk_fma_f32 v[154:155], v[20:21], v[66:67], v[154:155]
v_pk_fma_f32 v[156:157], v[20:21], v[68:69], v[156:157]
v_pk_fma_f32 v[158:159], v[20:21], v[70:71], v[158:159]
v_pk_mul_f32 v[128:129], v[128:129], v[152:153]
v_pk_mul_f32 v[130:131], v[130:131], v[154:155]
v_pk_mul_f32 v[132:133], v[132:133], v[156:157]
v_pk_mul_f32 v[134:135], v[134:135], v[158:159]
v_cvt_pk_bf16_f32 v152, v128, v129
v_cvt_pk_bf16_f32 v153, v130, v131
v_cvt_pk_bf16_f32 v154, v132, v133
v_cvt_pk_bf16_f32 v155, v134, v135
buffer_store_dwordx4 v[152:155], v2, s[32:35], s72 offen offset:1024 sc1
v_pk_fma_f32 v[176:177], v[24:25], v[56:57], v[176:177]
v_pk_fma_f32 v[178:179], v[24:25], v[58:59], v[178:179]
v_pk_fma_f32 v[180:181], v[24:25], v[60:61], v[180:181]
v_pk_fma_f32 v[182:183], v[24:25], v[62:63], v[182:183]
v_pk_fma_f32 v[200:201], v[24:25], v[64:65], v[200:201]
v_pk_fma_f32 v[202:203], v[24:25], v[66:67], v[202:203]
v_pk_fma_f32 v[204:205], v[24:25], v[68:69], v[204:205]
v_pk_fma_f32 v[206:207], v[24:25], v[70:71], v[206:207]
v_pk_mul_f32 v[176:177], v[176:177], v[200:201]
v_pk_mul_f32 v[178:179], v[178:179], v[202:203]
v_pk_mul_f32 v[180:181], v[180:181], v[204:205]
v_pk_mul_f32 v[182:183], v[182:183], v[206:207]
v_cvt_pk_bf16_f32 v200, v176, v177
v_cvt_pk_bf16_f32 v201, v178, v179
v_cvt_pk_bf16_f32 v202, v180, v181
v_cvt_pk_bf16_f32 v203, v182, v183
buffer_store_dwordx4 v[200:203], v2, s[32:35], s72 offen offset:2048 sc1
v_pk_fma_f32 v[224:225], v[28:29], v[56:57], v[224:225]
v_pk_fma_f32 v[226:227], v[28:29], v[58:59], v[226:227]
v_pk_fma_f32 v[228:229], v[28:29], v[60:61], v[228:229]
v_pk_fma_f32 v[230:231], v[28:29], v[62:63], v[230:231]
v_pk_fma_f32 v[248:249], v[28:29], v[64:65], v[248:249]
v_pk_fma_f32 v[250:251], v[28:29], v[66:67], v[250:251]
v_pk_fma_f32 v[252:253], v[28:29], v[68:69], v[252:253]
v_pk_fma_f32 v[254:255], v[28:29], v[70:71], v[254:255]
v_pk_mul_f32 v[224:225], v[224:225], v[248:249]
v_pk_mul_f32 v[226:227], v[226:227], v[250:251]
v_pk_mul_f32 v[228:229], v[228:229], v[252:253]
v_pk_mul_f32 v[230:231], v[230:231], v[254:255]
v_cvt_pk_bf16_f32 v248, v224, v225
v_cvt_pk_bf16_f32 v249, v226, v227
v_cvt_pk_bf16_f32 v250, v228, v229
v_cvt_pk_bf16_f32 v251, v230, v231
buffer_store_dwordx4 v[248:251], v2, s[32:35], s72 offen offset:3072 sc1
s_barrier
v_readfirstlane_b32 s0, v4
v_readfirstlane_b32 s1, v5
v_lshlrev_b32 v6, 26, v0
v_add_u32 v18, 4096, v2
s_waitcnt vmcnt(0)
buffer_store_dwordx2 v[4:5], v6, s[32:35], s54 offen sc1
s_mul_i32 s75, s49, 61440
s_add_u32 s75, s75, s10
s_add_u32 s75, s75, 20480
buffer_load_dwordx4 v[76:79], v2, s[32:35], s75 offen offset:0 sc1
buffer_load_dwordx4 v[80:83], v2, s[32:35], s75 offen offset:1024 sc1
buffer_load_dwordx4 v[84:87], v2, s[32:35], s75 offen offset:2048 sc1
buffer_load_dwordx4 v[88:91], v2, s[32:35], s75 offen offset:3072 sc1
buffer_load_dwordx4 v[92:95], v18, s[32:35], s75 offen offset:0 sc1
s_mul_i32 s75, s49, 61440
s_add_u32 s75, s75, s10
s_add_u32 s75, s75, 25600
buffer_load_dwordx4 v[96:99], v2, s[32:35], s75 offen offset:0 sc1
buffer_load_dwordx4 v[100:103], v2, s[32:35], s75 offen offset:1024 sc1
buffer_load_dwordx4 v[104:107], v2, s[32:35], s75 offen offset:2048 sc1
buffer_load_dwordx4 v[108:111], v2, s[32:35], s75 offen offset:3072 sc1
buffer_load_dwordx4 v[112:115], v18, s[32:35], s75 offen offset:0 sc1
s_mul_i32 s75, s49, 61440
s_add_u32 s75, s75, s10
s_add_u32 s75, s75, 30720
buffer_load_dwordx4 v[116:119], v2, s[32:35], s75 offen offset:0 sc1
buffer_load_dwordx4 v[120:123], v2, s[32:35], s75 offen offset:1024 sc1
buffer_load_dwordx4 v[124:127], v2, s[32:35], s75 offen offset:2048 sc1
buffer_load_dwordx4 v[128:131], v2, s[32:35], s75 offen offset:3072 sc1
buffer_load_dwordx4 v[132:135], v18, s[32:35], s75 offen offset:0 sc1
s_branch P2_CQ
.p2align 12
H_L:
s_setprio 0
s_lshl3_add_u32 s46, s45, s44
s_lshl1_add_u32 s46, s46, 0
v_lshlrev_b32 v2, 4, v0
v_lshlrev_b32 v3, 2, v0
s_lshl_b32 s61, s45, 7
s_lshl3_add_u32 s61, s49, s61
v_lshrrev_b32 v4, 3, v0
v_add_u32 v4, s61, v4
v_mul_u32_u24 v4, 1280, v4
s_lshl_b32 s62, s3, 2
v_lshrrev_b32 v5, 4, v0
v_add_u32 v5, s62, v5
v_xor_b32 v5, v5, v0
v_and_b32 v5, 7, v5
v_lshl_add_u32 v12, v5, 4, v4
s_mov_b32 s26, 2621440
s_mov_b32 s27, 0x20000
s_mov_b32 s51, 0
s_lshl_b32 s53, s49, 10
s_waitcnt lgkmcnt(0)
s_mov_b64 s[24:25], s[4:5]
s_add_u32 m0, s53, 16384
s_nop 0
buffer_load_dwordx4 v12, s[24:27], s51 offen lds
s_add_u32 s51, s51, 40960
s_add_u32 m0, s53, 20480
s_nop 0
buffer_load_dwordx4 v12, s[24:27], s51 offen lds
s_add_u32 s51, s51, 40960
s_add_u32 m0, s53, 24576
s_nop 0
buffer_load_dwordx4 v12, s[24:27], s51 offen lds
s_add_u32 s51, s51, 40960
s_add_u32 m0, s53, 28672
s_nop 0
buffer_load_dwordx4 v12, s[24:27], s51 offen lds
s_add_u32 s51, s51, 4294844544
s_mul_i32 s61, s49, 24576
s_mul_i32 s75, s44, 384
s_add_u32 s61, s61, s75
s_and_b32 s75, s3, 1
s_lshl_b32 s75, s75, 2
v_add_u32 v5, 0, v0
v_mul_u32_u24 v4, 2731, v5
v_lshrrev_b32 v4, 16, v4
v_mul_u32_u24 v7, 24, v4
v_sub_u32 v5, v5, v7
v_and_b32 v6, 2, v4
v_or_b32 v6, s75, v6
v_xor_b32 v5, v5, v6
v_mul_u32_u24 v4, 3072, v4
v_lshl_add_u32 v4, v5, 4, v4
v_add_u32 v13, s61, v4
v_add_u32 v5, 64, v0
v_mul_u32_u24 v4, 2731, v5
v_lshrrev_b32 v4, 16, v4
v_mul_u32_u24 v7, 24, v4
v_sub_u32 v5, v5, v7
v_and_b32 v6, 2, v4
v_or_b32 v6, s75, v6
v_xor_b32 v5, v5, v6
v_mul_u32_u24 v4, 3072, v4
v_lshl_add_u32 v4, v5, 4, v4
v_add_u32 v14, s61, v4
v_add_u32 v5, 128, v0
v_mul_u32_u24 v4, 2731, v5
v_lshrrev_b32 v4, 16, v4
v_mul_u32_u24 v7, 24, v4
v_sub_u32 v5, v5, v7
v_and_b32 v6, 2, v4
v_or_b32 v6, s75, v6
v_xor_b32 v5, v5, v6
v_mul_u32_u24 v4, 3072, v4
v_lshl_add_u32 v4, v5, 4, v4
v_add_u32 v15, s61, v4
s_mov_b32 s50, 0
s_mul_i32 s52, s49, 3072
s_mov_b64 s[28:29], s[12:13]
s_mov_b32 s30, 1966080
s_mov_b32 s31, 0x20000
s_mov_b64 s[40:41], s[14:15]
s_mov_b32 s42, 1966080
s_mov_b32 s43, 0x20000
s_add_u32 m0, s52, 65536
s_nop 0
buffer_load_dwordx4 v13, s[28:31], s50 offen lds
s_add_u32 m0, s52, 66560
s_nop 0
buffer_load_dwordx4 v14, s[28:31], s50 offen lds
s_add_u32 m0, s52, 67584
s_nop 0
buffer_load_dwordx4 v15, s[28:31], s50 offen lds
s_add_u32 m0, s52, 77824
s_nop 0
buffer_load_dwordx4 v13, s[40:43], s50 offen lds
s_add_u32 m0, s52, 78848
s_nop 0
buffer_load_dwordx4 v14, s[40:43], s50 offen lds
s_add_u32 m0, s52, 79872
s_nop 0
buffer_load_dwordx4 v15, s[40:43], s50 offen lds
s_add_u32 s50, s50, 98304
v_add_u32 v18, 4096, v2
s_mov_b64 s[32:33], s[22:23]
s_mov_b32 s34, 33554432
s_mov_b32 s35, 0x20000
s_mov_b64 s[36:37], s[20:21]
s_mov_b32 s38, 256
s_mov_b32 s39, 0x20000
v_mul_u32_u24 v4, 43, v0
v_lshrrev_b32 v4, 8, v4
v_mul_u32_u24 v5, 6, v4
v_sub_u32 v5, v0, v5
v_lshrrev_b32 v6, 1, v5
v_and_b32 v5, 1, v5
v_mul_u32_u24 v6, 1280, v6
v_mul_u32_u24 v5, 156, v5
v_and_b32 v7, 4, v4
v_mad_u32_u24 v4, v7, 15, v4
v_mul_u32_u24 v4, 3840, v4
v_add3_u32 v4, v4, v5, v6
v_cmp_gt_u32 vcc, 48, v0
v_mov_b32 v5, 2147483648
s_add_u32 s58, s49, 2
s_lshl_b32 s58, s58, 5
s_add_u32 s58, s58, s45
s_mul_i32 s58, s58, 15360
s_mul_i32 s64, s44, 160
s_add_u32 s58, s58, s64
v_cndmask_b32 v17, v5, v4, vcc
s_mov_b64 s[12:13], s[6:7]
s_mov_b32 s14, 2457600
s_mov_b32 s15, 0x20000
s_bfe_u32 s47, s2, 0x30004
s_lshr_b32 s77, s2, 3
s_xor_b32 s77, s77, s47
s_and_b32 s77, s77, 1
s_lshr_b32 s48, s2, 7
s_lshl1_add_u32 s48, s48, s77
s_lshr_b32 s77, s44, 1
s_lshl_b32 s77, s77, 3
s_add_u32 s47, s77, s47
s_and_b32 s77, s44, 1
s_lshl_b32 s77, s77, 2
s_add_u32 s48, s77, s48
s_mul_i32 s10, s48, 348160
s_add_u32 s10, s10, 16777216
s_mul_i32 s59, s49, 5120
s_add_u32 s11, s10, s59
s_lshl_b32 s55, s3, 2
s_lshr_b32 s55, 0x76025413, s55
s_and_b32 s55, s55, 7
s_mul_i32 s55, s55, 20480
s_lshl_b32 s77, s45, 3
s_sub_u32 s77, s77, 1
v_min_u32 v4, 8, v0
v_add_u32 v4, s77, v4
v_max_i32 v4, 0, v4
v_lshl_add_u32 v4, v4, 1, 1
s_mul_i32 s77, s48, 5
s_lshr_b32 s77, s77, 2
s_sub_u32 s77, s77, 130
v_min_u32 v6, 49, v0
v_lshrrev_b32 v7, 1, v6
v_and_b32 v6, 1, v6
v_mad_u32_u24 v6, v7, 10, v6
v_add_lshl_u32 v6, v6, s77, 1
v_or_b32 v6, 1, v6
s_lshl1_add_u32 s77, s44, 4294967137
v_lshl_add_u32 v5, v0, 4, s77
v_cmp_gt_u32 vcc, 26, v0
s_nop 1
v_cndmask_b32 v6, v6, v5, vcc
v_cmp_gt_u32 vcc, 10, v0
s_nop 1
v_cndmask_b32 v6, v6, v4, vcc
v_lshlrev_b32 v29, 7, v6
s_mov_b32 s78, 23166976
s_lshl_b32 s61, s49, 6
v_add_u32 v20, s61, v0
v_lshlrev_b32 v22, 3, v20
v_and_b32 v4, 31, v0
v_min_u32 v4, 23, v4
s_mul_i32 s61, s49, 384
v_lshl_add_u32 v20, v4, 4, s61
v_lshrrev_b32 v5, 5, v0
v_mul_u32_u24 v5, 7680, v5
v_add_u32 v21, v5, v20
v_mov_b32 v23, 0
s_mul_i32 s62, s44, 15360
s_add_u32 s62, s62, 22020096
s_add_u32 s63, s62, 4608
s_lshl_b32 s64, s45, 10
s_add_u32 s64, s64, 20971520
s_cmp_lt_u32 s49, 2
s_cselect_b32 s64, s64, 2147483648
s_add_u32 m0, s52, 90112
s_nop 0
buffer_load_dwordx4 v13, s[28:31], s50 offen lds
s_add_u32 m0, s52, 91136
s_nop 0
buffer_load_dwordx4 v14, s[28:31], s50 offen lds
s_add_u32 m0, s52, 92160
s_nop 0
buffer_load_dwordx4 v15, s[28:31], s50 offen lds
s_add_u32 m0, s52, 102400
s_nop 0
buffer_load_dwordx4 v13, s[40:43], s50 offen lds
s_add_u32 m0, s52, 103424
s_nop 0
buffer_load_dwordx4 v14, s[40:43], s50 offen lds
s_add_u32 m0, s52, 104448
s_nop 0
buffer_load_dwordx4 v15, s[40:43], s50 offen lds
s_add_u32 s50, s50, 98304
s_add_u32 m0, s53, 0
s_nop 0
buffer_load_dwordx4 v12, s[24:27], s51 offen lds
s_add_u32 s51, s51, 40960
s_add_u32 m0, s53, 4096
s_nop 0
buffer_load_dwordx4 v12, s[24:27], s51 offen lds
s_add_u32 s51, s51, 40960
s_add_u32 m0, s53, 8192
s_nop 0
buffer_load_dwordx4 v12, s[24:27], s51 offen lds
s_add_u32 s51, s51, 40960
s_add_u32 m0, s53, 12288
s_nop 0
buffer_load_dwordx4 v12, s[24:27], s51 offen lds
s_add_u32 s51, s51, 4294844544
s_waitcnt vmcnt(10)
s_barrier
s_add_u32 m0, s52, 114688
s_nop 0
buffer_load_dwordx4 v13, s[28:31], s50 offen lds
s_add_u32 m0, s52, 115712
s_nop 0
buffer_load_dwordx4 v14, s[28:31], s50 offen lds
s_add_u32 m0, s52, 116736
s_nop 0
buffer_load_dwordx4 v15, s[28:31], s50 offen lds
s_add_u32 m0, s52, 126976
s_nop 0
buffer_load_dwordx4 v13, s[40:43], s50 offen lds
s_add_u32 m0, s52, 128000
s_nop 0
buffer_load_dwordx4 v14, s[40:43], s50 offen lds
s_add_u32 m0, s52, 129024
s_nop 0
buffer_load_dwordx4 v15, s[40:43], s50 offen lds
s_add_u32 s50, s50, 98304
s_add_u32 m0, s52, 139264
s_nop 0
buffer_load_dwordx4 v13, s[28:31], s50 offen lds
s_add_u32 m0, s52, 140288
s_nop 0
buffer_load_dwordx4 v14, s[28:31], s50 offen lds
s_add_u32 m0, s52, 141312
s_nop 0
buffer_load_dwordx4 v15, s[28:31], s50 offen lds
s_add_u32 m0, s52, 151552
s_nop 0
buffer_load_dwordx4 v13, s[40:43], s50 offen lds
s_waitcnt vmcnt(14)
s_barrier
s_add_u32 m0, s52, 152576
s_nop 0
buffer_load_dwordx4 v14, s[40:43], s50 offen lds
s_add_u32 m0, s52, 153600
s_nop 0
buffer_load_dwordx4 v15, s[40:43], s50 offen lds
s_add_u32 s50, s50, 98304
s_add_u32 m0, s53, 49152
s_nop 0
buffer_load_dwordx4 v12, s[24:27], s51 offen lds
s_add_u32 s51, s51, 40960
s_add_u32 m0, s53, 53248
s_nop 0
buffer_load_dwordx4 v12, s[24:27], s51 offen lds
s_add_u32 s51, s51, 40960
s_add_u32 m0, s53, 57344
s_nop 0
buffer_load_dwordx4 v12, s[24:27], s51 offen lds
s_add_u32 s51, s51, 40960
s_add_u32 m0, s53, 61440
s_nop 0
buffer_load_dwordx4 v12, s[24:27], s51 offen lds
s_add_u32 s51, s51, 4294844544
s_add_u32 m0, s53, 32768
s_nop 0
buffer_load_dwordx4 v12, s[24:27], s51 offen lds
s_add_u32 s51, s51, 40960
s_add_u32 m0, s53, 36864
s_nop 0
buffer_load_dwordx4 v12, s[24:27], s51 offen lds
s_add_u32 s51, s51, 40960
s_add_u32 m0, s53, 40960
s_nop 0
buffer_load_dwordx4 v12, s[24:27], s51 offen lds
s_add_u32 s51, s51, 40960
s_add_u32 m0, s53, 45056
s_nop 0
buffer_load_dwordx4 v12, s[24:27], s51 offen lds
s_add_u32 s51, s51, 4294844544
s_waitcnt vmcnt(14)
s_barrier
s_add_u32 m0, s52, 65536
s_nop 0
buffer_load_dwordx4 v13, s[28:31], s50 offen lds
s_add_u32 m0, s52, 66560
s_nop 0
buffer_load_dwordx4 v14, s[28:31], s50 offen lds
s_add_u32 m0, s52, 67584
s_nop 0
buffer_load_dwordx4 v15, s[28:31], s50 offen lds
s_add_u32 m0, s52, 77824
s_nop 0
buffer_load_dwordx4 v13, s[40:43], s50 offen lds
s_add_u32 m0, s52, 78848
s_nop 0
buffer_load_dwordx4 v14, s[40:43], s50 offen lds
s_add_u32 m0, s52, 79872
s_nop 0
buffer_load_dwordx4 v15, s[40:43], s50 offen lds
s_add_u32 s50, s50, 98304
s_add_u32 m0, s52, 90112
s_nop 0
buffer_load_dwordx4 v13, s[28:31], s50 offen lds
s_add_u32 m0, s52, 91136
s_nop 0
buffer_load_dwordx4 v14, s[28:31], s50 offen lds
s_add_u32 m0, s52, 92160
s_nop 0
buffer_load_dwordx4 v15, s[28:31], s50 offen lds
s_add_u32 m0, s52, 102400
s_nop 0
buffer_load_dwordx4 v13, s[40:43], s50 offen lds
s_waitcnt vmcnt(18)
s_barrier
s_add_u32 m0, s52, 103424
s_nop 0
buffer_load_dwordx4 v14, s[40:43], s50 offen lds
s_add_u32 m0, s52, 104448
s_nop 0
buffer_load_dwordx4 v15, s[40:43], s50 offen lds
s_add_u32 s50, s50, 98304
s_add_u32 m0, s53, 16384
s_nop 0
buffer_load_dwordx4 v12, s[24:27], s51 offen lds
s_add_u32 s51, s51, 40960
s_add_u32 m0, s53, 20480
s_nop 0
buffer_load_dwordx4 v12, s[24:27], s51 offen lds
s_add_u32 s51, s51, 40960
s_add_u32 m0, s53, 24576
s_nop 0
buffer_load_dwordx4 v12, s[24:27], s51 offen lds
s_add_u32 s51, s51, 40960
s_add_u32 m0, s53, 28672
s_nop 0
buffer_load_dwordx4 v12, s[24:27], s51 offen lds
s_add_u32 s51, s51, 4294844544
s_add_u32 m0, s52, 114688
s_nop 0
buffer_load_dwordx4 v13, s[28:31], s50 offen lds
s_add_u32 m0, s52, 115712
s_nop 0
buffer_load_dwordx4 v14, s[28:31], s50 offen lds
s_add_u32 m0, s52, 116736
s_nop 0
buffer_load_dwordx4 v15, s[28:31], s50 offen lds
s_add_u32 m0, s52, 126976
s_nop 0
buffer_load_dwordx4 v13, s[40:43], s50 offen lds
buffer_load_dword v16, v17, s[12:15], s58 offen
L2:
s_waitcnt vmcnt(15)
s_barrier
s_add_u32 m0, s52, 128000
s_nop 0
buffer_load_dwordx4 v14, s[40:43], s50 offen lds
s_add_u32 m0, s52, 129024
s_nop 0
buffer_load_dwordx4 v15, s[40:43], s50 offen lds
s_add_u32 s50, s50, 98304
s_waitcnt vmcnt(11)
s_barrier
s_add_u32 m0, s52, 139264
s_nop 0
buffer_load_dwordx4 v13, s[28:31], s50 offen lds
s_add_u32 m0, s52, 140288
s_nop 0
buffer_load_dwordx4 v14, s[28:31], s50 offen lds
s_add_u32 m0, s52, 141312
s_nop 0
buffer_load_dwordx4 v15, s[28:31], s50 offen lds
s_add_u32 m0, s52, 151552
s_nop 0
buffer_load_dwordx4 v13, s[40:43], s50 offen lds
s_add_u32 m0, s52, 152576
s_nop 0
buffer_load_dwordx4 v14, s[40:43], s50 offen lds
s_add_u32 m0, s52, 153600
s_nop 0
buffer_load_dwordx4 v15, s[40:43], s50 offen lds
s_add_u32 s50, s50, 98304
s_add_u32 m0, s53, 0
s_nop 0
buffer_load_dwordx4 v12, s[24:27], s51 offen lds
s_add_u32 s51, s51, 40960
s_add_u32 m0, s53, 4096
s_nop 0
buffer_load_dwordx4 v12, s[24:27], s51 offen lds
s_add_u32 s51, s51, 40960
s_waitcnt vmcnt(8)
s_barrier
s_add_u32 m0, s53, 8192
s_nop 0
buffer_load_dwordx4 v12, s[24:27], s51 offen lds
s_add_u32 s51, s51, 40960
s_add_u32 m0, s53, 12288
s_nop 0
buffer_load_dwordx4 v12, s[24:27], s51 offen lds
s_add_u32 s51, s51, 4294844544
s_add_u32 m0, s52, 65536
s_nop 0
buffer_load_dwordx4 v13, s[28:31], s50 offen lds
s_add_u32 m0, s52, 66560
s_nop 0
buffer_load_dwordx4 v14, s[28:31], s50 offen lds
s_add_u32 m0, s52, 67584
s_nop 0
buffer_load_dwordx4 v15, s[28:31], s50 offen lds
s_add_u32 m0, s52, 77824
s_nop 0
buffer_load_dwordx4 v13, s[40:43], s50 offen lds
s_add_u32 m0, s52, 78848
s_nop 0
buffer_load_dwordx4 v14, s[40:43], s50 offen lds
s_add_u32 m0, s52, 79872
s_nop 0
buffer_load_dwordx4 v15, s[40:43], s50 offen lds
s_add_u32 s50, s50, 98304
s_add_u32 m0, s52, 90112
s_nop 0
buffer_load_dwordx4 v13, s[28:31], s50 offen lds
s_add_u32 m0, s52, 91136
s_nop 0
buffer_load_dwordx4 v14, s[28:31], s50 offen lds
s_waitcnt vmcnt(12)
s_barrier
s_add_u32 m0, s52, 92160
s_nop 0
buffer_load_dwordx4 v15, s[28:31], s50 offen lds
s_add_u32 m0, s52, 102400
s_nop 0
buffer_load_dwordx4 v13, s[40:43], s50 offen lds
s_add_u32 m0, s52, 103424
s_nop 0
buffer_load_dwordx4 v14, s[40:43], s50 offen lds
s_add_u32 m0, s52, 104448
s_nop 0
buffer_load_dwordx4 v15, s[40:43], s50 offen lds
s_add_u32 s50, s50, 98304
s_add_u32 m0, s53, 49152
s_nop 0
buffer_load_dwordx4 v12, s[24:27], s51 offen lds
s_add_u32 s51, s51, 40960
s_add_u32 m0, s53, 53248
s_nop 0
buffer_load_dwordx4 v12, s[24:27], s51 offen lds
s_add_u32 s51, s51, 40960
s_add_u32 m0, s53, 57344
s_nop 0
buffer_load_dwordx4 v12, s[24:27], s51 offen lds
s_add_u32 s51, s51, 40960
s_add_u32 m0, s53, 61440
s_nop 0
buffer_load_dwordx4 v12, s[24:27], s51 offen lds
s_add_u32 s51, s51, 4294844544
s_add_u32 m0, s52, 114688
s_nop 0
buffer_load_dwordx4 v13, s[28:31], s50 offen lds
s_add_u32 m0, s52, 115712
s_nop 0
buffer_load_dwordx4 v14, s[28:31], s50 offen lds
s_waitcnt vmcnt(12)
s_barrier
s_add_u32 m0, s52, 116736
s_nop 0
buffer_load_dwordx4 v15, s[28:31], s50 offen lds
s_add_u32 m0, s52, 126976
s_nop 0
buffer_load_dwordx4 v13, s[40:43], s50 offen lds
s_add_u32 m0, s52, 128000
s_nop 0
buffer_load_dwordx4 v14, s[40:43], s50 offen lds
s_add_u32 m0, s52, 129024
s_nop 0
buffer_load_dwordx4 v15, s[40:43], s50 offen lds
s_add_u32 s50, s50, 98304
s_add_u32 m0, s52, 139264
s_nop 0
buffer_load_dwordx4 v13, s[28:31], s50 offen lds
s_add_u32 m0, s52, 140288
s_nop 0
buffer_load_dwordx4 v14, s[28:31], s50 offen lds
s_add_u32 m0, s52, 141312
s_nop 0
buffer_load_dwordx4 v15, s[28:31], s50 offen lds
s_add_u32 m0, s52, 151552
s_nop 0
buffer_load_dwordx4 v13, s[40:43], s50 offen lds
s_add_u32 m0, s52, 152576
s_nop 0
buffer_load_dwordx4 v14, s[40:43], s50 offen lds
s_add_u32 m0, s52, 153600
s_nop 0
buffer_load_dwordx4 v15, s[40:43], s50 offen lds
s_add_u32 s50, s50, 98304
s_waitcnt vmcnt(16)
s_barrier
s_add_u32 m0, s53, 32768
s_nop 0
buffer_load_dwordx4 v12, s[24:27], s51 offen lds
s_add_u32 s51, s51, 40960
s_add_u32 m0, s53, 36864
s_nop 0
buffer_load_dwordx4 v12, s[24:27], s51 offen lds
s_add_u32 s51, s51, 40960
s_add_u32 m0, s53, 40960
s_nop 0
buffer_load_dwordx4 v12, s[24:27], s51 offen lds
s_add_u32 s51, s51, 40960
s_add_u32 m0, s53, 45056
s_nop 0
buffer_load_dwordx4 v12, s[24:27], s51 offen lds
s_add_u32 s51, s51, 4294844544
s_add_u32 m0, s52, 65536
s_nop 0
buffer_load_dwordx4 v13, s[28:31], s50 offen lds
s_add_u32 m0, s52, 66560
s_nop 0
buffer_load_dwordx4 v14, s[28:31], s50 offen lds
s_add_u32 m0, s52, 67584
s_nop 0
buffer_load_dwordx4 v15, s[28:31], s50 offen lds
s_add_u32 m0, s52, 77824
s_nop 0
buffer_load_dwordx4 v13, s[40:43], s50 offen lds
s_add_u32 m0, s52, 78848
s_nop 0
buffer_load_dwordx4 v14, s[40:43], s50 offen lds
s_add_u32 m0, s52, 79872
s_nop 0
buffer_load_dwordx4 v15, s[40:43], s50 offen lds
s_add_u32 s50, s50, 98304
s_waitcnt vmcnt(16)
s_barrier
s_add_u32 m0, s52, 90112
s_nop 0
buffer_load_dwordx4 v13, s[28:31], s50 offen lds
s_add_u32 m0, s52, 91136
s_nop 0
buffer_load_dwordx4 v14, s[28:31], s50 offen lds
s_add_u32 m0, s52, 92160
s_nop 0
buffer_load_dwordx4 v15, s[28:31], s50 offen lds
s_add_u32 m0, s52, 102400
s_nop 0
buffer_load_dwordx4 v13, s[40:43], s50 offen lds
s_add_u32 m0, s52, 103424
s_nop 0
buffer_load_dwordx4 v14, s[40:43], s50 offen lds
s_add_u32 m0, s52, 104448
s_nop 0
buffer_load_dwordx4 v15, s[40:43], s50 offen lds
s_add_u32 s50, s50, 98304
s_add_u32 m0, s53, 16384
s_nop 0
buffer_load_dwordx4 v12, s[24:27], s51 offen lds
s_add_u32 s51, s51, 40960
s_add_u32 m0, s53, 20480
s_nop 0
buffer_load_dwordx4 v12, s[24:27], s51 offen lds
s_add_u32 s51, s51, 40960
s_add_u32 m0, s53, 24576
s_nop 0
buffer_load_dwordx4 v12, s[24:27], s51 offen lds
s_add_u32 s51, s51, 40960
s_add_u32 m0, s53, 28672
s_nop 0
buffer_load_dwordx4 v12, s[24:27], s51 offen lds
s_add_u32 s51, s51, 4294844544
s_waitcnt vmcnt(20)
s_barrier
s_add_u32 m0, s52, 114688
s_nop 0
buffer_load_dwordx4 v13, s[28:31], s50 offen lds
s_add_u32 m0, s52, 115712
s_nop 0
buffer_load_dwordx4 v14, s[28:31], s50 offen lds
s_add_u32 m0, s52, 116736
s_nop 0
buffer_load_dwordx4 v15, s[28:31], s50 offen lds
s_add_u32 m0, s52, 126976
s_nop 0
buffer_load_dwordx4 v13, s[40:43], s50 offen lds
s_add_u32 m0, s52, 128000
s_nop 0
buffer_load_dwordx4 v14, s[40:43], s50 offen lds
s_add_u32 m0, s52, 129024
s_nop 0
buffer_load_dwordx4 v15, s[40:43], s50 offen lds
s_add_u32 s50, s50, 98304
s_waitcnt vmcnt(16)
s_barrier
s_add_u32 m0, s52, 139264
s_nop 0
buffer_load_dwordx4 v13, s[28:31], s50 offen lds
s_add_u32 m0, s52, 140288
s_nop 0
buffer_load_dwordx4 v14, s[28:31], s50 offen lds
s_add_u32 m0, s52, 141312
s_nop 0
buffer_load_dwordx4 v15, s[28:31], s50 offen lds
s_add_u32 m0, s52, 151552
s_nop 0
buffer_load_dwordx4 v13, s[40:43], s50 offen lds
s_add_u32 m0, s52, 152576
s_nop 0
buffer_load_dwordx4 v14, s[40:43], s50 offen lds
s_add_u32 m0, s52, 153600
s_nop 0
buffer_load_dwordx4 v15, s[40:43], s50 offen lds
s_add_u32 s50, s50, 98304
s_add_u32 m0, s53, 0
s_nop 0
buffer_load_dwordx4 v12, s[24:27], s51 offen lds
s_add_u32 s51, s51, 40960
s_add_u32 m0, s53, 4096
s_nop 0
buffer_load_dwordx4 v12, s[24:27], s51 offen lds
s_add_u32 s51, s51, 40960
s_add_u32 m0, s53, 8192
s_nop 0
buffer_load_dwordx4 v12, s[24:27], s51 offen lds
s_add_u32 s51, s51, 40960
s_add_u32 m0, s53, 12288
s_nop 0
buffer_load_dwordx4 v12, s[24:27], s51 offen lds
s_add_u32 s51, s51, 4294844544
s_waitcnt vmcnt(20)
s_barrier
s_add_u32 m0, s52, 65536
s_nop 0
buffer_load_dwordx4 v13, s[28:31], s50 offen lds
s_add_u32 m0, s52, 66560
s_nop 0
buffer_load_dwordx4 v14, s[28:31], s50 offen lds
s_add_u32 m0, s52, 67584
s_nop 0
buffer_load_dwordx4 v15, s[28:31], s50 offen lds
s_add_u32 m0, s52, 77824
s_nop 0
buffer_load_dwordx4 v13, s[40:43], s50 offen lds
s_add_u32 m0, s52, 78848
s_nop 0
buffer_load_dwordx4 v14, s[40:43], s50 offen lds
s_add_u32 m0, s52, 79872
s_nop 0
buffer_load_dwordx4 v15, s[40:43], s50 offen lds
s_add_u32 s50, s50, 98304
s_waitcnt vmcnt(16)
s_barrier
buffer_load_dwordx2 v[34:35], off, s[36:39], 0 sc1
s_cmp_lg_u32 s3, 4
s_cbranch_scc1 L3
buffer_load_dwordx2 v[30:31], v29, s[32:35], s78 offen sc1
L3:
s_add_u32 m0, s52, 90112
s_nop 0
buffer_load_dwordx4 v13, s[28:31], s50 offen lds
s_add_u32 m0, s52, 91136
s_nop 0
buffer_load_dwordx4 v14, s[28:31], s50 offen lds
s_add_u32 m0, s52, 92160
s_nop 0
buffer_load_dwordx4 v15, s[28:31], s50 offen lds
s_add_u32 m0, s52, 102400
s_nop 0
buffer_load_dwordx4 v13, s[40:43], s50 offen lds
s_add_u32 m0, s52, 103424
s_nop 0
buffer_load_dwordx4 v14, s[40:43], s50 offen lds
s_add_u32 m0, s52, 104448
s_nop 0
buffer_load_dwordx4 v15, s[40:43], s50 offen lds
s_add_u32 s50, s50, 98304
s_waitcnt vmcnt(17)
s_barrier
s_add_u32 m0, s52, 114688
s_nop 0
buffer_load_dwordx4 v13, s[28:31], s50 offen lds
s_add_u32 m0, s52, 115712
s_nop 0
buffer_load_dwordx4 v14, s[28:31], s50 offen lds
s_add_u32 m0, s52, 116736
s_nop 0
buffer_load_dwordx4 v15, s[28:31], s50 offen lds
s_add_u32 m0, s52, 126976
s_nop 0
buffer_load_dwordx4 v13, s[40:43], s50 offen lds
s_add_u32 m0, s52, 128000
s_nop 0
buffer_load_dwordx4 v14, s[40:43], s50 offen lds
s_add_u32 m0, s52, 129024
s_nop 0
buffer_load_dwordx4 v15, s[40:43], s50 offen lds
s_add_u32 s50, s50, 98304
s_waitcnt vmcnt(12)
s_mov_b32 s79, 0
L4:
v_cmp_eq_u64 vcc, 0, v[34:35]
s_nop 4
s_cbranch_vccz L5
s_addk_i32 s79, 1
s_cmp_ge_u32 s79, 200000
s_cbranch_scc1 L5
s_sleep 8
buffer_load_dwordx2 v[34:35], off, s[36:39], 0 sc1
s_waitcnt vmcnt(0)
s_branch L4
L5:
v_readfirstlane_b32 s0, v34
v_readfirstlane_b32 s1, v35
s_nop 1
s_cmp_lg_u32 s3, 4
s_cbranch_scc1 L7
s_mov_b32 s79, 0
L6:
v_cmp_ne_u64 vcc, s[0:1], v[30:31]
s_nop 4
s_cbranch_vccz L7
s_addk_i32 s79, 1
s_cmp_ge_u32 s79, 200000
s_cbranch_scc1 L7
s_sleep 8
buffer_load_dwordx2 v[30:31], v29, s[32:35], s78 offen sc1
s_waitcnt vmcnt(0)
s_branch L6
L7:
s_barrier
buffer_load_dwordx4 v[40:43], v21, s[32:35], s62 offen offset:0 sc1
buffer_load_dwordx4 v[44:47], v21, s[32:35], s62 offen offset:1536 sc1
buffer_load_dwordx4 v[48:51], v21, s[32:35], s62 offen offset:3072 sc1
buffer_load_dwordx4 v[52:55], v21, s[32:35], s63 offen offset:0 sc1
buffer_load_dwordx4 v[56:59], v21, s[32:35], s63 offen offset:1536 sc1
buffer_load_dwordx2 v[60:61], v22, s[32:35], s64 offen sc1
s_add_u32 m0, s52, 139264
s_nop 0
buffer_load_dwordx4 v13, s[28:31], s50 offen lds
s_add_u32 m0, s52, 140288
s_nop 0
buffer_load_dwordx4 v14, s[28:31], s50 offen lds
s_add_u32 m0, s52, 141312
s_nop 0
buffer_load_dwordx4 v15, s[28:31], s50 offen lds
s_add_u32 m0, s52, 151552
s_nop 0
buffer_load_dwordx4 v13, s[40:43], s50 offen lds
s_add_u32 m0, s52, 152576
s_nop 0
buffer_load_dwordx4 v14, s[40:43], s50 offen lds
s_add_u32 m0, s52, 153600
s_nop 0
buffer_load_dwordx4 v15, s[40:43], s50 offen lds
s_add_u32 s50, s50, 98304
s_waitcnt vmcnt(18)
s_barrier
s_add_u32 s74, s11, 0
s_add_u32 m0, s59, 61440
s_nop 0
buffer_load_dwordx4 v2, s[32:35], s74 offen offset:0 sc1 lds
s_add_u32 m0, s59, 61440
s_nop 0
buffer_load_dwordx4 v2, s[32:35], s74 offen offset:1024 sc1 lds
s_add_u32 m0, s59, 61440
s_nop 0
buffer_load_dwordx4 v2, s[32:35], s74 offen offset:2048 sc1 lds
s_add_u32 m0, s59, 61440
s_nop 0
buffer_load_dwordx4 v2, s[32:35], s74 offen offset:3072 sc1 lds
s_add_u32 m0, s59, 65536
s_nop 0
buffer_load_dwordx4 v18, s[32:35], s74 offen offset:0 sc1 lds
s_mul_i32 s75, s49, 5120
s_add_u32 s75, s75, s10
s_add_u32 s75, s75, 327680
buffer_load_dwordx4 v[76:79], v2, s[32:35], s75 offen offset:0 sc1
buffer_load_dwordx4 v[80:83], v2, s[32:35], s75 offen offset:1024 sc1
buffer_load_dwordx4 v[84:87], v2, s[32:35], s75 offen offset:2048 sc1
buffer_load_dwordx4 v[88:91], v2, s[32:35], s75 offen offset:3072 sc1
buffer_load_dwordx4 v[92:95], v18, s[32:35], s75 offen offset:0 sc1
s_mul_i32 s75, s49, 20480
s_add_u32 s75, s75, s10
s_add_u32 s75, s75, 245760
s_waitcnt vmcnt(16)
s_barrier
s_add_u32 s74, s11, 61440
s_add_u32 m0, s59, 20480
s_nop 0
buffer_load_dwordx4 v2, s[32:35], s74 offen offset:0 sc1 lds
s_add_u32 m0, s59, 20480
s_nop 0
buffer_load_dwordx4 v2, s[32:35], s74 offen offset:1024 sc1 lds
s_add_u32 m0, s59, 20480
s_nop 0
buffer_load_dwordx4 v2, s[32:35], s74 offen offset:2048 sc1 lds
s_add_u32 m0, s59, 20480
s_nop 0
buffer_load_dwordx4 v2, s[32:35], s74 offen offset:3072 sc1 lds
s_add_u32 m0, s59, 24576
s_nop 0
buffer_load_dwordx4 v18, s[32:35], s74 offen offset:0 sc1 lds
s_add_u32 s74, s11, 122880
s_add_u32 m0, s59, 81920
s_nop 0
buffer_load_dwordx4 v2, s[32:35], s74 offen offset:0 sc1 lds
s_add_u32 m0, s59, 81920
s_nop 0
buffer_load_dwordx4 v2, s[32:35], s74 offen offset:1024 sc1 lds
s_add_u32 m0, s59, 81920
s_nop 0
buffer_load_dwordx4 v2, s[32:35], s74 offen offset:2048 sc1 lds
s_add_u32 m0, s59, 81920
s_nop 0
buffer_load_dwordx4 v2, s[32:35], s74 offen offset:3072 sc1 lds
s_add_u32 m0, s59, 86016
s_nop 0
buffer_load_dwordx4 v18, s[32:35], s74 offen offset:0 sc1 lds
v_add_f32 v40, v40, v44
v_add_f32 v48, v48, v52
v_add_f32 v40, v40, v56
v_add_f32 v40, v40, v48
v_add_f32 v41, v41, v45
v_add_f32 v49, v49, v53
v_add_f32 v41, v41, v57
v_add_f32 v41, v41, v49
v_add_f32 v42, v42, v46
v_add_f32 v50, v50, v54
v_add_f32 v42, v42, v58
v_add_f32 v42, v42, v50
v_add_f32 v43, v43, v47
v_add_f32 v51, v51, v55
v_add_f32 v43, v43, v59
v_add_f32 v43, v43, v51
s_waitcnt vmcnt(20)
s_barrier
s_add_u32 s74, s11, 184320
s_add_u32 m0, s59, 102400
s_nop 0
buffer_load_dwordx4 v2, s[32:35], s74 offen offset:0 sc1 lds
s_add_u32 m0, s59, 102400
s_nop 0
buffer_load_dwordx4 v2, s[32:35], s74 offen offset:1024 sc1 lds
s_add_u32 m0, s59, 102400
s_nop 0
buffer_load_dwordx4 v2, s[32:35], s74 offen offset:2048 sc1 lds
s_add_u32 m0, s59, 102400
s_nop 0
buffer_load_dwordx4 v2, s[32:35], s74 offen offset:3072 sc1 lds
s_add_u32 m0, s59, 106496
s_nop 0
buffer_load_dwordx4 v18, s[32:35], s74 offen offset:0 sc1 lds
buffer_load_dwordx4 v[96:99], v2, s[32:35], s75 offen offset:0 sc1
buffer_load_dwordx4 v[100:103], v2, s[32:35], s75 offen offset:1024 sc1
buffer_load_dwordx4 v[104:107], v2, s[32:35], s75 offen offset:2048 sc1
buffer_load_dwordx4 v[108:111], v2, s[32:35], s75 offen offset:3072 sc1
buffer_load_dwordx4 v[112:115], v18, s[32:35], s75 offen offset:0 sc1
s_mul_i32 s75, s49, 20480
s_add_u32 s75, s75, s10
s_add_u32 s75, s75, 250880
v_mov_b32 v44, v40
v_mov_b32 v45, v41
v_mov_b32 v46, v42
v_mov_b32 v47, v43
s_nop 1
v_permlane32_swap_b32 v40, v44
v_permlane32_swap_b32 v41, v45
v_permlane32_swap_b32 v42, v46
v_permlane32_swap_b32 v43, v47
s_nop 0
v_add_f32 v40, v40, v44
v_add_f32 v41, v41, v45
v_add_f32 v42, v42, v46
v_add_f32 v43, v43, v47
ds_write_b128 v20, v[40:43] offset:56320
ds_write_b64 v22, v[60:61] offset:58368
ds_write_b64 v23, v[34:35] offset:60416
s_waitcnt lgkmcnt(0)
s_barrier
H_LT:
v_mov_b32 v14, 0
v_mov_b32 v15, 0
s_lshr_b32 s73, s47, 1
s_lshl2_add_u32 s73, s73, s49
s_lshl_b32 s73, s73, 8
s_add_u32 s73, s73, 23134208
v_and_b32 v13, 1, v0
v_lshlrev_b32 v13, 7, v13
v_add_u32 v11, s55, v2
s_mov_b64 s[40:41], s[18:19]
s_mov_b32 s42, 2621440
s_mov_b32 s43, 0x20000
s_lshl_b32 s72, s47, 6
s_lshl3_add_u32 s72, s3, s72
s_lshl3_add_u32 s60, s72, 20971524
s_mul_i32 s72, s72, 1280
s_mul_i32 s70, s48, 160
s_add_u32 s70, s70, s72
v_add_u32 v16, 0, v0
v_mul_u32_u24 v17, 3277, v16
v_lshrrev_b32 v17, 16, v17
v_mul_u32_u24 v19, 20, v17
v_sub_u32 v16, v16, v19
v_lshlrev_b32 v1, 3, v17
v_bfe_u32 v19, v17, 1, 2
v_xor_b32 v16, v16, v19
v_mul_u32_u24 v17, 1280, v17
v_lshl_add_u32 v4, v16, 3, v17
v_add_u32 v16, 64, v0
v_mul_u32_u24 v17, 3277, v16
v_lshrrev_b32 v17, 16, v17
v_mul_u32_u24 v19, 20, v17
v_sub_u32 v16, v16, v19
v_lshlrev_b32 v3, 3, v17
v_bfe_u32 v19, v17, 1, 2
v_xor_b32 v16, v16, v19
v_mul_u32_u24 v17, 1280, v17
v_lshl_add_u32 v5, v16, 3, v17
v_add_u32 v16, 128, v0
v_mul_u32_u24 v17, 3277, v16
v_lshrrev_b32 v17, 16, v17
v_mul_u32_u24 v19, 20, v17
v_sub_u32 v16, v16, v19
v_lshlrev_b32 v75, 3, v17
v_bfe_u32 v19, v17, 1, 2
v_xor_b32 v16, v16, v19
v_mul_u32_u24 v17, 1280, v17
v_lshl_add_u32 v6, v16, 3, v17
v_lshrrev_b32 v16, 5, v0
v_lshl_add_u32 v6, v16, 26, v6
v_and_b32 v16, 15, v0
v_lshrrev_b32 v17, 4, v0
v_bfe_u32 v19, v0, 1, 2
v_xor_b32 v17, v17, v19
v_mul_u32_u24 v16, 320, v16
v_lshl_add_u32 v16, v17, 4, v16
v_add_u32 v7, s55, v16
s_mul_i32 s72, s3, 2560
v_add_u32 v8, s72, v2
v_add_u32 v9, 61440, v8
v_add_u32 v10, 122880, v8
s_lshl2_add_u32 s71, s47, s49
s_lshl_b32 s71, s71, 9
s_add_u32 s71, s71, 23068672
v_and_b32 v12, 3, v0
v_lshlrev_b32 v12, 7, v12
s_mul_i32 s72, s47, 278528
s_mul_i32 s61, s49, 4096
s_add_u32 s61, s61, s72
s_add_u32 s61, s61, 262144
s_mul_i32 s62, s49, 16384
s_add_u32 s62, s62, s72
s_add_u32 s62, s62, 196608
s_mul_i32 s63, s49, 16384
s_add_u32 s63, s63, s72
s_add_u32 s63, s63, 200704
s_mul_i32 s64, s49, 16384
s_add_u32 s64, s64, s72
s_add_u32 s64, s64, 204800
s_mul_i32 s65, s49, 16384
s_add_u32 s65, s65, s72
s_add_u32 s65, s65, 208896
s_mul_i32 s66, s49, 49152
s_add_u32 s66, s66, s72
s_add_u32 s66, s66, 36864
s_mul_i32 s67, s49, 49152
s_add_u32 s67, s67, s72
s_add_u32 s67, s67, 40960
s_mul_i32 s68, s49, 49152
s_add_u32 s68, s68, s72
s_add_u32 s68, s68, 45056
s_waitcnt vmcnt(0)
s_barrier
buffer_load_dwordx4 v[116:119], v2, s[32:35], s75 offen offset:0 sc1
buffer_load_dwordx4 v[120:123], v2, s[32:35], s75 offen offset:1024 sc1
buffer_load_dwordx4 v[124:127], v2, s[32:35], s75 offen offset:2048 sc1
buffer_load_dwordx4 v[128:131], v2, s[32:35], s75 offen offset:3072 sc1
buffer_load_dwordx4 v[132:135], v18, s[32:35], s75 offen offset:0 sc1
s_mul_i32 s75, s49, 20480
s_add_u32 s75, s75, s10
s_add_u32 s75, s75, 256000
buffer_load_dwordx4 v[136:139], v2, s[32:35], s75 offen offset:0 sc1
buffer_load_dwordx4 v[140:143], v2, s[32:35], s75 offen offset:1024 sc1
buffer_load_dwordx4 v[144:147], v2, s[32:35], s75 offen offset:2048 sc1
buffer_load_dwordx4 v[148:151], v2, s[32:35], s75 offen offset:3072 sc1
buffer_load_dwordx4 v[152:155], v18, s[32:35], s75 offen offset:0 sc1
s_mul_i32 s75, s49, 20480
s_add_u32 s75, s75, s10
s_add_u32 s75, s75, 261120
buffer_load_dwordx4 v[156:159], v2, s[32:35], s75 offen offset:0 sc1
buffer_load_dwordx4 v[160:163], v2, s[32:35], s75 offen offset:1024 sc1
buffer_load_dwordx4 v[164:167], v2, s[32:35], s75 offen offset:2048 sc1
buffer_load_dwordx4 v[168:171], v2, s[32:35], s75 offen offset:3072 sc1
buffer_load_dwordx4 v[172:175], v18, s[32:35], s75 offen offset:0 sc1
s_mul_i32 s74, s49, 61440
s_add_u32 s74, s74, s10
s_add_u32 s74, s74, 46080
.p2align 3
s_add_u32 m0, s55, 0
s_nop 0
.p2align 3
buffer_load_dwordx4 v2, s[32:35], s74 offen offset:0 sc1 lds
s_add_u32 m0, s55, 0
s_nop 0
.p2align 3
buffer_load_dwordx4 v2, s[32:35], s74 offen offset:1024 sc1 lds
s_add_u32 m0, s55, 0
s_nop 0
.p2align 3
buffer_load_dwordx4 v2, s[32:35], s74 offen offset:2048 sc1 lds
s_add_u32 m0, s55, 0
s_nop 0
.p2align 3
buffer_load_dwordx4 v2, s[32:35], s74 offen offset:3072 sc1 lds
s_add_u32 m0, s55, 4096
s_nop 0
.p2align 3
buffer_load_dwordx4 v18, s[32:35], s74 offen offset:0 sc1 lds
s_mul_i32 s74, s49, 61440
s_add_u32 s74, s74, s10
s_add_u32 s74, s74, 51200
.p2align 3
s_add_u32 m0, s55, 5120
s_nop 0
.p2align 3
buffer_load_dwordx4 v2, s[32:35], s74 offen offset:0 sc1 lds
s_add_u32 m0, s55, 5120
s_nop 0
.p2align 3
buffer_load_dwordx4 v2, s[32:35], s74 offen offset:1024 sc1 lds
s_add_u32 m0, s55, 5120
s_nop 0
.p2align 3
buffer_load_dwordx4 v2, s[32:35], s74 offen offset:2048 sc1 lds
s_add_u32 m0, s55, 5120
s_nop 0
.p2align 3
buffer_load_dwordx4 v2, s[32:35], s74 offen offset:3072 sc1 lds
s_add_u32 m0, s55, 9216
s_nop 0
.p2align 3
buffer_load_dwordx4 v18, s[32:35], s74 offen offset:0 sc1 lds
s_branch P2_LQ
.p2align 12
Q_C:
s_lshl3_add_u32 s46, s45, s44
s_lshl1_add_u32 s46, s46, 1
v_lshlrev_b32 v2, 4, v0
v_lshlrev_b32 v3, 2, v0
s_waitcnt lgkmcnt(0)
s_lshr_b32 s60, s46, 1
s_lshl2_add_u32 s60, s60, s49
s_mul_i32 s60, s60, 5120
v_lshrrev_b32 v4, 4, v0
v_lshl_add_u32 v4, v4, 10, v2
s_mov_b64 s[24:25], s[4:5]
s_mov_b32 s26, 2621440
s_mov_b32 s27, 0x20000
buffer_load_dwordx4 v[112:115], v4, s[24:27], s60 offen offset:0
buffer_load_dwordx4 v[116:119], v4, s[24:27], s60 offen offset:256
buffer_load_dwordx4 v[120:123], v4, s[24:27], s60 offen offset:512
buffer_load_dwordx4 v[124:127], v4, s[24:27], s60 offen offset:768
buffer_load_dwordx4 v[128:131], v4, s[24:27], s60 offen offset:1024
s_mov_b64 s[32:33], s[22:23]
s_mov_b32 s34, 33554432
s_mov_b32 s35, 0x20000
s_bfe_u32 s47, s2, 0x30004
s_lshr_b32 s77, s2, 3
s_xor_b32 s77, s77, s47
s_and_b32 s77, s77, 1
s_lshr_b32 s48, s2, 7
s_lshl1_add_u32 s48, s48, s77
s_lshr_b32 s77, s44, 1
s_lshl_b32 s77, s77, 3
s_add_u32 s47, s77, s47
s_and_b32 s77, s44, 1
s_lshl_b32 s77, s77, 2
s_add_u32 s48, s77, s48
s_mul_i32 s10, s48, 348160
s_add_u32 s10, s10, 16777216
s_mul_i32 s59, s49, 5120
s_add_u32 s11, s10, s59
s_lshl_b32 s55, s3, 2
s_lshr_b32 s55, 0x32104576, s55
s_and_b32 s55, s55, 7
s_mul_i32 s55, s55, 20480
s_xor_b32 s62, s3, 4
v_and_b32 v4, 15, v0
v_lshrrev_b32 v5, 4, v0
s_mul_i32 s61, s62, 8320
v_mul_u32_u24 v6, 520, v4
v_add_u32 v7, s61, v6
v_add_u32 v25, v7, v6
v_lshl_add_u32 v24, v5, 3, v25
v_lshl_add_u32 v6, v5, 3, v7
v_mov_b32 v1, 68480
s_mov_b32 vcc_lo, 0x55555555
s_mov_b32 vcc_hi, 0x55555555
v_cndmask_b32 v20, v1, v6, vcc
v_cndmask_b32 v22, v6, v1, vcc
s_mov_b64 vcc, 0x5555
v_cndmask_b32 v21, v1, v7, vcc
s_mov_b64 vcc, 0xaaaa
v_cndmask_b32 v23, v1, v7, vcc
v_lshrrev_b32 v6, 2, v0
v_and_b32 v7, 3, v0
v_mul_u32_u24 v6, 1040, v6
v_add_u32 v6, s61, v6
v_lshl_add_u32 v26, v7, 3, v6
v_mad_u32_u24 v27, v7, 40, v6
v_lshrrev_b32 v6, 5, v0
v_lshlrev_b32 v6, 8, v6
v_lshl_add_u32 v6, v4, 4, v6
v_and_b32 v7, 1, v5
v_lshl_add_u32 v16, v7, 26, v6
v_and_b32 v6, 1, v0
v_add_u32 v32, -1, v6
v_sub_u32 v33, 0, v6
s_lshl_b32 s64, s62, 7
s_add_u32 s64, s64, 79872
v_lshl_add_u32 v9, v4, 3, s64
v_lshl_add_u32 v10, v6, 3, s64
v_lshl_add_u32 v10, v5, 6, v10
s_or_b32 s64, s45, s62
s_cmp_eq_u32 s64, 0
s_cselect_b32 s64, 8, 0
v_bfe_u32 v6, v0, 1, 3
v_add_u32 v7, 1, v6
v_max_u32 v7, s64, v7
v_add_u32 v6, 8, v6
v_lshlrev_b32 v5, 2, v5
v_sub_u32 v6, v6, v7
v_sub_u32 v5, v5, v7
v_mov_b32 v4, 0xf149f2ca
v_add_u32 v7, 0, v5
v_cmp_ge_u32 vcc, v6, v7
s_nop 1
v_cndmask_b32_e64 v28, v4, 0, vcc
v_add_u32 v7, 1, v5
v_cmp_ge_u32 vcc, v6, v7
s_nop 1
v_cndmask_b32_e64 v29, v4, 0, vcc
v_add_u32 v7, 2, v5
v_cmp_ge_u32 vcc, v6, v7
s_nop 1
v_cndmask_b32_e64 v30, v4, 0, vcc
v_add_u32 v7, 3, v5
v_cmp_ge_u32 vcc, v6, v7
s_nop 1
v_cndmask_b32_e64 v31, v4, 0, vcc
s_mov_b32 s66, 0xffff0000
s_mov_b32 s67, 0
s_mov_b32 s68, 0
s_mov_b32 s69, 0xffff
s_mov_b32 s70, 0
s_mov_b32 s71, 0xffff0000
s_lshr_b32 s61, s3, 2
s_xor_b32 s61, s61, 1
s_lshl1_add_u32 s61, s45, s61
s_mul_i32 s61, s61, 278528
s_lshl_b32 s62, s49, 10
s_add_u32 s61, s61, s62
s_lshl_b32 s62, s44, 13
s_add_u32 s62, s62, s61
s_add_u32 s62, s62, 196608
s_add_u32 s63, s62, 4096
s_lshr_b32 s72, s44, 1
s_lshl_b32 s72, s72, 12
s_add_u32 s61, s61, s72
s_and_b32 s72, s44, 1
s_lshl_b32 s72, s72, 9
s_add_u32 s61, s61, s72
s_add_u32 s61, s61, 262144
s_lshr_b32 s54, s46, 1
s_lshl_b32 s54, s54, 7
s_add_u32 s54, s54, 23134208
v_mov_b32 v68, 0x3f803f80
v_mov_b32 v69, v68
v_mov_b32 v70, v68
v_mov_b32 v71, v68
v_lshrrev_b32 v4, 3, v0
v_min_u32 v4, 2, v4
v_mul_u32_u24 v4, 18432, v4
v_and_b32 v5, 7, v0
v_lshl_add_u32 v4, v5, 4, v4
v_add_u32 v4, 61440, v4
ds_write_b128 v4, v[68:71]
v_lshrrev_b32 v4, 5, v0
v_bfe_u32 v5, v0, 4, 1
v_bfe_u32 v6, v0, 2, 2
v_lshl_add_u32 v4, v4, 4, v6
v_lshl_add_u32 v4, v5, 2, v4
v_mul_u32_u24 v4, 480, v4
v_and_b32 v5, 3, v0
v_lshlrev_b32 v5, 3, v5
s_lshl_b32 s64, s3, 7
v_add3_u32 v8, v4, v5, s64
v_and_b32 v4, 15, v0
v_mul_u32_u24 v5, 520, v4
v_lshrrev_b32 v6, 4, v0
v_lshlrev_b32 v6, 3, v6
v_add3_u32 v17, v5, v6, s64
v_lshlrev_b32 v4, 3, v4
v_add_u32 v19, 79872, v4
v_add_u32 v18, 66560, v17
v_and_b32 v6, 15, v0
v_lshrrev_b32 v7, 4, v0
v_bfe_u32 v5, v0, 1, 3
v_xor_b32 v5, v5, v7
v_lshlrev_b32 v5, 4, v5
v_lshl_add_u32 v4, v6, 7, v5
v_add_u32 v4, 61440, v4
v_xor_b32 v5, 64, v4
v_mov_b32 v92, 0
v_mov_b32 v93, 0
v_mov_b32 v94, 0
v_mov_b32 v95, 0
v_mov_b32 v108, 0
v_mov_b32 v109, 0
v_mov_b32 v110, 0
v_mov_b32 v111, 0
v_mov_b32 v1, 81408
s_mov_b32 s60, 0xffff0000
s_waitcnt vmcnt(0)
v_lshlrev_b32 v132, 16, v112
v_and_b32 v133, s60, v112
v_lshlrev_b32 v134, 16, v113
v_and_b32 v135, s60, v113
v_lshlrev_b32 v136, 16, v114
v_and_b32 v137, s60, v114
v_lshlrev_b32 v138, 16, v115
v_and_b32 v139, s60, v115
v_lshlrev_b32 v140, 16, v116
v_and_b32 v141, s60, v116
v_lshlrev_b32 v142, 16, v117
v_and_b32 v143, s60, v117
v_lshlrev_b32 v144, 16, v118
v_and_b32 v145, s60, v118
v_lshlrev_b32 v146, 16, v119
v_and_b32 v147, s60, v119
v_lshlrev_b32 v148, 16, v120
v_and_b32 v149, s60, v120
v_lshlrev_b32 v150, 16, v121
v_and_b32 v151, s60, v121
v_lshlrev_b32 v152, 16, v122
v_and_b32 v153, s60, v122
v_lshlrev_b32 v154, 16, v123
v_and_b32 v155, s60, v123
v_lshlrev_b32 v156, 16, v124
v_and_b32 v157, s60, v124
v_lshlrev_b32 v158, 16, v125
v_and_b32 v159, s60, v125
v_lshlrev_b32 v160, 16, v126
v_and_b32 v161, s60, v126
v_lshlrev_b32 v162, 16, v127
v_and_b32 v163, s60, v127
v_lshlrev_b32 v164, 16, v128
v_and_b32 v165, s60, v128
v_lshlrev_b32 v166, 16, v129
v_and_b32 v167, s60, v129
v_lshlrev_b32 v168, 16, v130
v_and_b32 v169, s60, v130
v_lshlrev_b32 v170, 16, v131
v_and_b32 v171, s60, v131
.p2align 3
v_pk_add_f32 v[172:173], v[132:133], v[140:141]
v_pk_add_f32 v[174:175], v[134:135], v[142:143]
v_pk_add_f32 v[176:177], v[136:137], v[144:145]
v_pk_add_f32 v[178:179], v[138:139], v[146:147]
v_pk_add_f32 v[172:173], v[172:173], v[148:149]
v_pk_add_f32 v[174:175], v[174:175], v[150:151]
v_pk_add_f32 v[176:177], v[176:177], v[152:153]
v_pk_add_f32 v[178:179], v[178:179], v[154:155]
v_pk_add_f32 v[172:173], v[172:173], v[156:157]
v_pk_add_f32 v[174:175], v[174:175], v[158:159]
v_pk_add_f32 v[176:177], v[176:177], v[160:161]
v_pk_add_f32 v[178:179], v[178:179], v[162:163]
v_pk_add_f32 v[172:173], v[172:173], v[164:165]
v_pk_add_f32 v[174:175], v[174:175], v[166:167]
v_pk_add_f32 v[176:177], v[176:177], v[168:169]
v_pk_add_f32 v[178:179], v[178:179], v[170:171]
v_pk_add_f32 v[172:173], v[172:173], v[174:175]
v_pk_add_f32 v[176:177], v[176:177], v[178:179]
v_pk_add_f32 v[172:173], v[172:173], v[176:177]
v_add_f32 v36, v172, v173
s_nop 1
v_add_f32_dpp v36, v36, v36 quad_perm:[1,0,3,2] row_mask:0xf bank_mask:0xf
s_nop 1
v_add_f32_dpp v36, v36, v36 quad_perm:[2,3,0,1] row_mask:0xf bank_mask:0xf
s_nop 1
v_add_f32_dpp v36, v36, v36 row_half_mirror row_mask:0xf bank_mask:0xf
s_nop 1
v_add_f32_dpp v36, v36, v36 row_mirror row_mask:0xf bank_mask:0xf
v_mul_f32 v36, 0xbacccccd, v36
v_mov_b32 v37, v36
.p2align 3
v_pk_add_f32 v[132:133], v[132:133], v[36:37]
v_pk_add_f32 v[134:135], v[134:135], v[36:37]
v_pk_add_f32 v[136:137], v[136:137], v[36:37]
v_pk_add_f32 v[138:139], v[138:139], v[36:37]
v_pk_add_f32 v[140:141], v[140:141], v[36:37]
v_pk_add_f32 v[142:143], v[142:143], v[36:37]
v_pk_add_f32 v[144:145], v[144:145], v[36:37]
v_pk_add_f32 v[146:147], v[146:147], v[36:37]
v_pk_add_f32 v[148:149], v[148:149], v[36:37]
v_pk_add_f32 v[150:151], v[150:151], v[36:37]
v_pk_add_f32 v[152:153], v[152:153], v[36:37]
v_pk_add_f32 v[154:155], v[154:155], v[36:37]
v_pk_add_f32 v[156:157], v[156:157], v[36:37]
v_pk_add_f32 v[158:159], v[158:159], v[36:37]
v_pk_add_f32 v[160:161], v[160:161], v[36:37]
v_pk_add_f32 v[162:163], v[162:163], v[36:37]
v_pk_add_f32 v[164:165], v[164:165], v[36:37]
v_pk_add_f32 v[166:167], v[166:167], v[36:37]
v_pk_add_f32 v[168:169], v[168:169], v[36:37]
v_pk_add_f32 v[170:171], v[170:171], v[36:37]
v_pk_mul_f32 v[172:173], v[132:133], v[132:133]
v_pk_mul_f32 v[174:175], v[134:135], v[134:135]
v_pk_mul_f32 v[176:177], v[136:137], v[136:137]
v_pk_mul_f32 v[178:179], v[138:139], v[138:139]
v_pk_fma_f32 v[172:173], v[140:141], v[140:141], v[172:173]
v_pk_fma_f32 v[174:175], v[142:143], v[142:143], v[174:175]
v_pk_fma_f32 v[176:177], v[144:145], v[144:145], v[176:177]
v_pk_fma_f32 v[178:179], v[146:147], v[146:147], v[178:179]
v_pk_fma_f32 v[172:173], v[148:149], v[148:149], v[172:173]
v_pk_fma_f32 v[174:175], v[150:151], v[150:151], v[174:175]
v_pk_fma_f32 v[176:177], v[152:153], v[152:153], v[176:177]
v_pk_fma_f32 v[178:179], v[154:155], v[154:155], v[178:179]
v_pk_fma_f32 v[172:173], v[156:157], v[156:157], v[172:173]
v_pk_fma_f32 v[174:175], v[158:159], v[158:159], v[174:175]
v_pk_fma_f32 v[176:177], v[160:161], v[160:161], v[176:177]
v_pk_fma_f32 v[178:179], v[162:163], v[162:163], v[178:179]
v_pk_fma_f32 v[172:173], v[164:165], v[164:165], v[172:173]
v_pk_fma_f32 v[174:175], v[166:167], v[166:167], v[174:175]
v_pk_fma_f32 v[176:177], v[168:169], v[168:169], v[176:177]
v_pk_fma_f32 v[178:179], v[170:171], v[170:171], v[178:179]
v_pk_add_f32 v[172:173], v[172:173], v[174:175]
v_pk_add_f32 v[176:177], v[176:177], v[178:179]
v_pk_add_f32 v[172:173], v[172:173], v[176:177]
v_add_f32 v38, v172, v173
s_nop 1
v_add_f32_dpp v38, v38, v38 quad_perm:[1,0,3,2] row_mask:0xf bank_mask:0xf
s_nop 1
v_add_f32_dpp v38, v38, v38 quad_perm:[2,3,0,1] row_mask:0xf bank_mask:0xf
s_nop 1
v_add_f32_dpp v38, v38, v38 row_half_mirror row_mask:0xf bank_mask:0xf
s_nop 1
v_add_f32_dpp v38, v38, v38 row_mirror row_mask:0xf bank_mask:0xf
v_mov_b32 v37, 0x3727c5ac
v_fmac_f32 v37, 0x3acccccd, v38
v_rsq_f32 v37, v37
s_lshl_b32 s60, s49, 5
s_add_u32 s60, s60, 163712
v_lshrrev_b32 v52, 4, v0
v_lshl_add_u32 v52, v52, 3, s60
ds_write_b64 v52, v[36:37]
s_setprio 1
s_cmp_eq_u32 s3, 3
s_waitcnt vmcnt(0) lgkmcnt(0)
s_barrier
s_cbranch_scc1 L8
s_nop 0
ds_read_b64_tr_b16 v[92:93], v8 offset:96
ds_read_b64_tr_b16 v[94:95], v8 offset:3936
L8:
ds_read_b64_tr_b16 v[80:81], v8 offset:0
ds_read_b64_tr_b16 v[82:83], v8 offset:3840
ds_read_b64_tr_b16 v[84:85], v8 offset:32
ds_read_b64_tr_b16 v[86:87], v8 offset:3872
ds_read_b64_tr_b16 v[88:89], v8 offset:64
ds_read_b64_tr_b16 v[90:91], v8 offset:3904
ds_read_b128 v[56:59], v4 offset:0
ds_read_b128 v[60:63], v4 offset:2048
ds_read_b128 v[64:67], v4 offset:4096
.p2align 3
s_waitcnt lgkmcnt(2)
s_nop 0
v_mfma_f32_16x16x32_bf16 v[112:115], v[80:83], v[56:59], 0
ds_read_b128 v[68:71], v4 offset:6144
v_mfma_f32_16x16x32_bf16 v[116:119], v[84:87], v[56:59], 0
v_mfma_f32_16x16x32_bf16 v[120:123], v[88:91], v[56:59], 0
v_mfma_f32_16x16x32_bf16 v[124:127], v[92:95], v[56:59], 0
s_waitcnt lgkmcnt(2)
s_nop 0
v_mfma_f32_16x16x32_bf16 v[128:131], v[80:83], v[60:63], 0
ds_read_b128 v[56:59], v4 offset:8192
v_mfma_f32_16x16x32_bf16 v[132:135], v[84:87], v[60:63], 0
v_mfma_f32_16x16x32_bf16 v[136:139], v[88:91], v[60:63], 0
v_mfma_f32_16x16x32_bf16 v[140:143], v[92:95], v[60:63], 0
s_waitcnt lgkmcnt(2)
s_nop 0
v_mfma_f32_16x16x32_bf16 v[144:147], v[80:83], v[64:67], 0
ds_read_b128 v[60:63], v4 offset:10240
v_mfma_f32_16x16x32_bf16 v[148:151], v[84:87], v[64:67], 0
v_mfma_f32_16x16x32_bf16 v[152:155], v[88:91], v[64:67], 0
v_mfma_f32_16x16x32_bf16 v[156:159], v[92:95], v[64:67], 0
s_waitcnt lgkmcnt(2)
s_nop 0
v_mfma_f32_16x16x32_bf16 v[160:163], v[80:83], v[68:71], 0
ds_read_b128 v[64:67], v4 offset:12288
v_mfma_f32_16x16x32_bf16 v[164:167], v[84:87], v[68:71], 0
v_mfma_f32_16x16x32_bf16 v[168:171], v[88:91], v[68:71], 0
v_mfma_f32_16x16x32_bf16 v[172:175], v[92:95], v[68:71], 0
s_waitcnt lgkmcnt(2)
s_nop 0
v_mfma_f32_16x16x32_bf16 v[176:179], v[80:83], v[56:59], 0
ds_read_b128 v[68:71], v4 offset:14336
v_mfma_f32_16x16x32_bf16 v[180:183], v[84:87], v[56:59], 0
v_mfma_f32_16x16x32_bf16 v[184:187], v[88:91], v[56:59], 0
v_mfma_f32_16x16x32_bf16 v[188:191], v[92:95], v[56:59], 0
s_waitcnt lgkmcnt(2)
s_nop 0
v_mfma_f32_16x16x32_bf16 v[192:195], v[80:83], v[60:63], 0
ds_read_b128 v[56:59], v4 offset:16384
v_mfma_f32_16x16x32_bf16 v[196:199], v[84:87], v[60:63], 0
v_mfma_f32_16x16x32_bf16 v[200:203], v[88:91], v[60:63], 0
v_mfma_f32_16x16x32_bf16 v[204:207], v[92:95], v[60:63], 0
s_waitcnt lgkmcnt(0)
s_barrier
v_mfma_f32_16x16x32_bf16 v[208:211], v[80:83], v[64:67], 0
s_cbranch_scc1 L9
s_nop 0
ds_read_b64_tr_b16 v[108:109], v8 offset:15456
ds_read_b64_tr_b16 v[110:111], v8 offset:19296
L9:
v_mfma_f32_16x16x32_bf16 v[212:215], v[84:87], v[64:67], 0
ds_read_b64_tr_b16 v[96:97], v8 offset:15360
v_mfma_f32_16x16x32_bf16 v[216:219], v[88:91], v[64:67], 0
ds_read_b64_tr_b16 v[98:99], v8 offset:19200
v_mfma_f32_16x16x32_bf16 v[220:223], v[92:95], v[64:67], 0
ds_read_b128 v[60:63], v5 offset:0
v_mfma_f32_16x16x32_bf16 v[224:227], v[80:83], v[68:71], 0
ds_read_b64_tr_b16 v[100:101], v8 offset:15392
v_mfma_f32_16x16x32_bf16 v[228:231], v[84:87], v[68:71], 0
ds_read_b64_tr_b16 v[102:103], v8 offset:19232
v_mfma_f32_16x16x32_bf16 v[232:235], v[88:91], v[68:71], 0
ds_read_b64_tr_b16 v[104:105], v8 offset:15424
v_mfma_f32_16x16x32_bf16 v[236:239], v[92:95], v[68:71], 0
ds_read_b128 v[64:67], v5 offset:2048
v_mfma_f32_16x16x32_bf16 v[240:243], v[80:83], v[56:59], 0
ds_read_b64_tr_b16 v[106:107], v8 offset:19264
v_mfma_f32_16x16x32_bf16 v[244:247], v[84:87], v[56:59], 0
ds_read_b128 v[68:71], v5 offset:4096
v_mfma_f32_16x16x32_bf16 v[248:251], v[88:91], v[56:59], 0
v_mfma_f32_16x16x32_bf16 v[252:255], v[92:95], v[56:59], 0
s_waitcnt lgkmcnt(1)
s_nop 0
v_mfma_f32_16x16x32_bf16 v[112:115], v[96:99], v[60:63], v[112:115]
ds_read_b128 v[56:59], v5 offset:6144
v_mfma_f32_16x16x32_bf16 v[116:119], v[100:103], v[60:63], v[116:119]
v_mfma_f32_16x16x32_bf16 v[120:123], v[104:107], v[60:63], v[120:123]
v_mfma_f32_16x16x32_bf16 v[124:127], v[108:111], v[60:63], v[124:127]
v_mfma_f32_16x16x32_bf16 v[128:131], v[96:99], v[64:67], v[128:131]
ds_read_b128 v[60:63], v5 offset:8192
v_mfma_f32_16x16x32_bf16 v[132:135], v[100:103], v[64:67], v[132:135]
v_mfma_f32_16x16x32_bf16 v[136:139], v[104:107], v[64:67], v[136:139]
v_mfma_f32_16x16x32_bf16 v[140:143], v[108:111], v[64:67], v[140:143]
s_waitcnt lgkmcnt(2)
s_nop 0
v_mfma_f32_16x16x32_bf16 v[144:147], v[96:99], v[68:71], v[144:147]
ds_read_b128 v[64:67], v5 offset:10240
v_mfma_f32_16x16x32_bf16 v[148:151], v[100:103], v[68:71], v[148:151]
v_mfma_f32_16x16x32_bf16 v[152:155], v[104:107], v[68:71], v[152:155]
v_mfma_f32_16x16x32_bf16 v[156:159], v[108:111], v[68:71], v[156:159]
s_waitcnt lgkmcnt(2)
s_nop 0
v_mfma_f32_16x16x32_bf16 v[160:163], v[96:99], v[56:59], v[160:163]
ds_read_b128 v[68:71], v5 offset:12288
v_mfma_f32_16x16x32_bf16 v[164:167], v[100:103], v[56:59], v[164:167]
v_mfma_f32_16x16x32_bf16 v[168:171], v[104:107], v[56:59], v[168:171]
v_mfma_f32_16x16x32_bf16 v[172:175], v[108:111], v[56:59], v[172:175]
s_waitcnt lgkmcnt(2)
s_nop 0
v_mfma_f32_16x16x32_bf16 v[176:179], v[96:99], v[60:63], v[176:179]
ds_read_b128 v[56:59], v5 offset:14336
v_mfma_f32_16x16x32_bf16 v[180:183], v[100:103], v[60:63], v[180:183]
v_mfma_f32_16x16x32_bf16 v[184:187], v[104:107], v[60:63], v[184:187]
v_mfma_f32_16x16x32_bf16 v[188:191], v[108:111], v[60:63], v[188:191]
s_waitcnt lgkmcnt(2)
s_nop 0
v_mfma_f32_16x16x32_bf16 v[192:195], v[96:99], v[64:67], v[192:195]
ds_read_b128 v[60:63], v5 offset:16384
v_mfma_f32_16x16x32_bf16 v[196:199], v[100:103], v[64:67], v[196:199]
v_mfma_f32_16x16x32_bf16 v[200:203], v[104:107], v[64:67], v[200:203]
v_mfma_f32_16x16x32_bf16 v[204:207], v[108:111], v[64:67], v[204:207]
s_waitcnt lgkmcnt(0)
s_barrier
v_mfma_f32_16x16x32_bf16 v[208:211], v[96:99], v[68:71], v[208:211]
s_cbranch_scc1 L10
s_nop 0
ds_read_b64_tr_b16 v[92:93], v8 offset:30816
ds_read_b64_tr_b16 v[94:95], v8 offset:34656
L10:
v_mfma_f32_16x16x32_bf16 v[212:215], v[100:103], v[68:71], v[212:215]
ds_read_b64_tr_b16 v[80:81], v8 offset:30720
v_mfma_f32_16x16x32_bf16 v[216:219], v[104:107], v[68:71], v[216:219]
ds_read_b64_tr_b16 v[82:83], v8 offset:34560
v_mfma_f32_16x16x32_bf16 v[220:223], v[108:111], v[68:71], v[220:223]
ds_read_b128 v[64:67], v4 offset:18432
v_mfma_f32_16x16x32_bf16 v[224:227], v[96:99], v[56:59], v[224:227]
ds_read_b64_tr_b16 v[84:85], v8 offset:30752
v_mfma_f32_16x16x32_bf16 v[228:231], v[100:103], v[56:59], v[228:231]
ds_read_b64_tr_b16 v[86:87], v8 offset:34592
v_mfma_f32_16x16x32_bf16 v[232:235], v[104:107], v[56:59], v[232:235]
ds_read_b64_tr_b16 v[88:89], v8 offset:30784
v_mfma_f32_16x16x32_bf16 v[236:239], v[108:111], v[56:59], v[236:239]
ds_read_b128 v[68:71], v4 offset:20480
v_mfma_f32_16x16x32_bf16 v[240:243], v[96:99], v[60:63], v[240:243]
ds_read_b64_tr_b16 v[90:91], v8 offset:34624
v_mfma_f32_16x16x32_bf16 v[244:247], v[100:103], v[60:63], v[244:247]
ds_read_b128 v[56:59], v4 offset:22528
v_mfma_f32_16x16x32_bf16 v[248:251], v[104:107], v[60:63], v[248:251]
v_mfma_f32_16x16x32_bf16 v[252:255], v[108:111], v[60:63], v[252:255]
s_waitcnt lgkmcnt(1)
s_nop 0
v_mfma_f32_16x16x32_bf16 v[112:115], v[80:83], v[64:67], v[112:115]
ds_read_b128 v[60:63], v4 offset:24576
v_mfma_f32_16x16x32_bf16 v[116:119], v[84:87], v[64:67], v[116:119]
v_mfma_f32_16x16x32_bf16 v[120:123], v[88:91], v[64:67], v[120:123]
v_mfma_f32_16x16x32_bf16 v[124:127], v[92:95], v[64:67], v[124:127]
v_mfma_f32_16x16x32_bf16 v[128:131], v[80:83], v[68:71], v[128:131]
ds_read_b128 v[64:67], v4 offset:26624
v_mfma_f32_16x16x32_bf16 v[132:135], v[84:87], v[68:71], v[132:135]
v_mfma_f32_16x16x32_bf16 v[136:139], v[88:91], v[68:71], v[136:139]
v_mfma_f32_16x16x32_bf16 v[140:143], v[92:95], v[68:71], v[140:143]
s_waitcnt lgkmcnt(2)
s_nop 0
v_mfma_f32_16x16x32_bf16 v[144:147], v[80:83], v[56:59], v[144:147]
ds_read_b128 v[68:71], v4 offset:28672
v_mfma_f32_16x16x32_bf16 v[148:151], v[84:87], v[56:59], v[148:151]
v_mfma_f32_16x16x32_bf16 v[152:155], v[88:91], v[56:59], v[152:155]
v_mfma_f32_16x16x32_bf16 v[156:159], v[92:95], v[56:59], v[156:159]
s_waitcnt lgkmcnt(2)
s_nop 0
v_mfma_f32_16x16x32_bf16 v[160:163], v[80:83], v[60:63], v[160:163]
ds_read_b128 v[56:59], v4 offset:30720
v_mfma_f32_16x16x32_bf16 v[164:167], v[84:87], v[60:63], v[164:167]
v_mfma_f32_16x16x32_bf16 v[168:171], v[88:91], v[60:63], v[168:171]
v_mfma_f32_16x16x32_bf16 v[172:175], v[92:95], v[60:63], v[172:175]
s_waitcnt lgkmcnt(2)
s_nop 0
v_mfma_f32_16x16x32_bf16 v[176:179], v[80:83], v[64:67], v[176:179]
ds_read_b128 v[60:63], v4 offset:32768
v_mfma_f32_16x16x32_bf16 v[180:183], v[84:87], v[64:67], v[180:183]
v_mfma_f32_16x16x32_bf16 v[184:187], v[88:91], v[64:67], v[184:187]
v_mfma_f32_16x16x32_bf16 v[188:191], v[92:95], v[64:67], v[188:191]
s_waitcnt lgkmcnt(2)
s_nop 0
v_mfma_f32_16x16x32_bf16 v[192:195], v[80:83], v[68:71], v[192:195]
ds_read_b128 v[64:67], v4 offset:34816
v_mfma_f32_16x16x32_bf16 v[196:199], v[84:87], v[68:71], v[196:199]
v_mfma_f32_16x16x32_bf16 v[200:203], v[88:91], v[68:71], v[200:203]
v_mfma_f32_16x16x32_bf16 v[204:207], v[92:95], v[68:71], v[204:207]
s_waitcnt lgkmcnt(0)
s_barrier
v_mfma_f32_16x16x32_bf16 v[208:211], v[80:83], v[56:59], v[208:211]
s_cbranch_scc1 L11
s_nop 0
ds_read_b64_tr_b16 v[108:109], v8 offset:46176
ds_read_b64_tr_b16 v[110:111], v8 offset:50016
L11:
v_mfma_f32_16x16x32_bf16 v[212:215], v[84:87], v[56:59], v[212:215]
ds_read_b64_tr_b16 v[96:97], v8 offset:46080
v_mfma_f32_16x16x32_bf16 v[216:219], v[88:91], v[56:59], v[216:219]
ds_read_b64_tr_b16 v[98:99], v8 offset:49920
v_mfma_f32_16x16x32_bf16 v[220:223], v[92:95], v[56:59], v[220:223]
ds_read_b128 v[68:71], v5 offset:18432
v_mfma_f32_16x16x32_bf16 v[224:227], v[80:83], v[60:63], v[224:227]
ds_read_b64_tr_b16 v[100:101], v8 offset:46112
v_mfma_f32_16x16x32_bf16 v[228:231], v[84:87], v[60:63], v[228:231]
ds_read_b64_tr_b16 v[102:103], v8 offset:49952
v_mfma_f32_16x16x32_bf16 v[232:235], v[88:91], v[60:63], v[232:235]
ds_read_b64_tr_b16 v[104:105], v8 offset:46144
v_mfma_f32_16x16x32_bf16 v[236:239], v[92:95], v[60:63], v[236:239]
ds_read_b128 v[56:59], v5 offset:20480
v_mfma_f32_16x16x32_bf16 v[240:243], v[80:83], v[64:67], v[240:243]
ds_read_b64_tr_b16 v[106:107], v8 offset:49984
v_mfma_f32_16x16x32_bf16 v[244:247], v[84:87], v[64:67], v[244:247]
ds_read_b128 v[60:63], v5 offset:22528
v_mfma_f32_16x16x32_bf16 v[248:251], v[88:91], v[64:67], v[248:251]
v_mfma_f32_16x16x32_bf16 v[252:255], v[92:95], v[64:67], v[252:255]
s_waitcnt lgkmcnt(1)
s_nop 0
v_mfma_f32_16x16x32_bf16 v[112:115], v[96:99], v[68:71], v[112:115]
ds_read_b128 v[64:67], v5 offset:24576
v_mfma_f32_16x16x32_bf16 v[116:119], v[100:103], v[68:71], v[116:119]
v_mfma_f32_16x16x32_bf16 v[120:123], v[104:107], v[68:71], v[120:123]
v_mfma_f32_16x16x32_bf16 v[124:127], v[108:111], v[68:71], v[124:127]
v_mfma_f32_16x16x32_bf16 v[128:131], v[96:99], v[56:59], v[128:131]
ds_read_b128 v[68:71], v5 offset:26624
v_mfma_f32_16x16x32_bf16 v[132:135], v[100:103], v[56:59], v[132:135]
v_mfma_f32_16x16x32_bf16 v[136:139], v[104:107], v[56:59], v[136:139]
v_mfma_f32_16x16x32_bf16 v[140:143], v[108:111], v[56:59], v[140:143]
s_waitcnt lgkmcnt(2)
s_nop 0
v_mfma_f32_16x16x32_bf16 v[144:147], v[96:99], v[60:63], v[144:147]
ds_read_b128 v[56:59], v5 offset:28672
v_mfma_f32_16x16x32_bf16 v[148:151], v[100:103], v[60:63], v[148:151]
v_mfma_f32_16x16x32_bf16 v[152:155], v[104:107], v[60:63], v[152:155]
v_mfma_f32_16x16x32_bf16 v[156:159], v[108:111], v[60:63], v[156:159]
s_waitcnt lgkmcnt(2)
s_nop 0
v_mfma_f32_16x16x32_bf16 v[160:163], v[96:99], v[64:67], v[160:163]
ds_read_b128 v[60:63], v5 offset:30720
v_mfma_f32_16x16x32_bf16 v[164:167], v[100:103], v[64:67], v[164:167]
v_mfma_f32_16x16x32_bf16 v[168:171], v[104:107], v[64:67], v[168:171]
v_mfma_f32_16x16x32_bf16 v[172:175], v[108:111], v[64:67], v[172:175]
s_waitcnt lgkmcnt(2)
s_nop 0
v_mfma_f32_16x16x32_bf16 v[176:179], v[96:99], v[68:71], v[176:179]
ds_read_b128 v[64:67], v5 offset:32768
v_mfma_f32_16x16x32_bf16 v[180:183], v[100:103], v[68:71], v[180:183]
v_mfma_f32_16x16x32_bf16 v[184:187], v[104:107], v[68:71], v[184:187]
v_mfma_f32_16x16x32_bf16 v[188:191], v[108:111], v[68:71], v[188:191]
s_waitcnt lgkmcnt(2)
s_nop 0
v_mfma_f32_16x16x32_bf16 v[192:195], v[96:99], v[56:59], v[192:195]
ds_read_b128 v[68:71], v5 offset:34816
v_mfma_f32_16x16x32_bf16 v[196:199], v[100:103], v[56:59], v[196:199]
v_mfma_f32_16x16x32_bf16 v[200:203], v[104:107], v[56:59], v[200:203]
v_mfma_f32_16x16x32_bf16 v[204:207], v[108:111], v[56:59], v[204:207]
s_waitcnt lgkmcnt(0)
s_barrier
v_mfma_f32_16x16x32_bf16 v[208:211], v[96:99], v[60:63], v[208:211]
s_cbranch_scc1 L12
s_nop 0
ds_read_b64_tr_b16 v[92:93], v8 offset:96
ds_read_b64_tr_b16 v[94:95], v8 offset:3936
L12:
v_mfma_f32_16x16x32_bf16 v[212:215], v[100:103], v[60:63], v[212:215]
ds_read_b64_tr_b16 v[80:81], v8 offset:0
v_mfma_f32_16x16x32_bf16 v[216:219], v[104:107], v[60:63], v[216:219]
ds_read_b64_tr_b16 v[82:83], v8 offset:3840
v_mfma_f32_16x16x32_bf16 v[220:223], v[108:111], v[60:63], v[220:223]
ds_read_b128 v[56:59], v4 offset:36864
v_mfma_f32_16x16x32_bf16 v[224:227], v[96:99], v[64:67], v[224:227]
ds_read_b64_tr_b16 v[84:85], v8 offset:32
v_mfma_f32_16x16x32_bf16 v[228:231], v[100:103], v[64:67], v[228:231]
ds_read_b64_tr_b16 v[86:87], v8 offset:3872
v_mfma_f32_16x16x32_bf16 v[232:235], v[104:107], v[64:67], v[232:235]
ds_read_b64_tr_b16 v[88:89], v8 offset:64
v_mfma_f32_16x16x32_bf16 v[236:239], v[108:111], v[64:67], v[236:239]
ds_read_b128 v[60:63], v4 offset:38912
v_mfma_f32_16x16x32_bf16 v[240:243], v[96:99], v[68:71], v[240:243]
ds_read_b64_tr_b16 v[90:91], v8 offset:3904
v_mfma_f32_16x16x32_bf16 v[244:247], v[100:103], v[68:71], v[244:247]
ds_read_b128 v[64:67], v4 offset:40960
v_mfma_f32_16x16x32_bf16 v[248:251], v[104:107], v[68:71], v[248:251]
v_mfma_f32_16x16x32_bf16 v[252:255], v[108:111], v[68:71], v[252:255]
s_waitcnt lgkmcnt(1)
s_nop 0
v_mfma_f32_16x16x32_bf16 v[112:115], v[80:83], v[56:59], v[112:115]
ds_read_b128 v[68:71], v4 offset:43008
v_mfma_f32_16x16x32_bf16 v[116:119], v[84:87], v[56:59], v[116:119]
v_mfma_f32_16x16x32_bf16 v[120:123], v[88:91], v[56:59], v[120:123]
v_mfma_f32_16x16x32_bf16 v[124:127], v[92:95], v[56:59], v[124:127]
v_mfma_f32_16x16x32_bf16 v[128:131], v[80:83], v[60:63], v[128:131]
ds_read_b128 v[56:59], v4 offset:45056
v_mfma_f32_16x16x32_bf16 v[132:135], v[84:87], v[60:63], v[132:135]
v_mfma_f32_16x16x32_bf16 v[136:139], v[88:91], v[60:63], v[136:139]
v_mfma_f32_16x16x32_bf16 v[140:143], v[92:95], v[60:63], v[140:143]
s_waitcnt lgkmcnt(2)
s_nop 0
v_mfma_f32_16x16x32_bf16 v[144:147], v[80:83], v[64:67], v[144:147]
ds_read_b128 v[60:63], v4 offset:47104
v_mfma_f32_16x16x32_bf16 v[148:151], v[84:87], v[64:67], v[148:151]
v_mfma_f32_16x16x32_bf16 v[152:155], v[88:91], v[64:67], v[152:155]
v_mfma_f32_16x16x32_bf16 v[156:159], v[92:95], v[64:67], v[156:159]
s_waitcnt lgkmcnt(2)
s_nop 0
v_mfma_f32_16x16x32_bf16 v[160:163], v[80:83], v[68:71], v[160:163]
ds_read_b128 v[64:67], v4 offset:49152
v_mfma_f32_16x16x32_bf16 v[164:167], v[84:87], v[68:71], v[164:167]
v_mfma_f32_16x16x32_bf16 v[168:171], v[88:91], v[68:71], v[168:171]
v_mfma_f32_16x16x32_bf16 v[172:175], v[92:95], v[68:71], v[172:175]
s_waitcnt lgkmcnt(2)
s_nop 0
v_mfma_f32_16x16x32_bf16 v[176:179], v[80:83], v[56:59], v[176:179]
ds_read_b128 v[68:71], v4 offset:51200
v_mfma_f32_16x16x32_bf16 v[180:183], v[84:87], v[56:59], v[180:183]
v_mfma_f32_16x16x32_bf16 v[184:187], v[88:91], v[56:59], v[184:187]
v_mfma_f32_16x16x32_bf16 v[188:191], v[92:95], v[56:59], v[188:191]
s_waitcnt lgkmcnt(2)
s_nop 0
v_mfma_f32_16x16x32_bf16 v[192:195], v[80:83], v[60:63], v[192:195]
ds_read_b128 v[56:59], v4 offset:53248
v_mfma_f32_16x16x32_bf16 v[196:199], v[84:87], v[60:63], v[196:199]
v_mfma_f32_16x16x32_bf16 v[200:203], v[88:91], v[60:63], v[200:203]
v_mfma_f32_16x16x32_bf16 v[204:207], v[92:95], v[60:63], v[204:207]
s_waitcnt lgkmcnt(0)
s_barrier
v_mfma_f32_16x16x32_bf16 v[208:211], v[80:83], v[64:67], v[208:211]
s_cbranch_scc1 L13
s_nop 0
ds_read_b64_tr_b16 v[108:109], v8 offset:15456
ds_read_b64_tr_b16 v[110:111], v8 offset:19296
L13:
v_mfma_f32_16x16x32_bf16 v[212:215], v[84:87], v[64:67], v[212:215]
ds_read_b64_tr_b16 v[96:97], v8 offset:15360
v_mfma_f32_16x16x32_bf16 v[216:219], v[88:91], v[64:67], v[216:219]
ds_read_b64_tr_b16 v[98:99], v8 offset:19200
v_mfma_f32_16x16x32_bf16 v[220:223], v[92:95], v[64:67], v[220:223]
ds_read_b128 v[60:63], v5 offset:36864
v_mfma_f32_16x16x32_bf16 v[224:227], v[80:83], v[68:71], v[224:227]
ds_read_b64_tr_b16 v[100:101], v8 offset:15392
v_mfma_f32_16x16x32_bf16 v[228:231], v[84:87], v[68:71], v[228:231]
ds_read_b64_tr_b16 v[102:103], v8 offset:19232
v_mfma_f32_16x16x32_bf16 v[232:235], v[88:91], v[68:71], v[232:235]
ds_read_b64_tr_b16 v[104:105], v8 offset:15424
v_mfma_f32_16x16x32_bf16 v[236:239], v[92:95], v[68:71], v[236:239]
ds_read_b128 v[64:67], v5 offset:38912
v_mfma_f32_16x16x32_bf16 v[240:243], v[80:83], v[56:59], v[240:243]
ds_read_b64_tr_b16 v[106:107], v8 offset:19264
v_mfma_f32_16x16x32_bf16 v[244:247], v[84:87], v[56:59], v[244:247]
ds_read_b128 v[68:71], v5 offset:40960
v_mfma_f32_16x16x32_bf16 v[248:251], v[88:91], v[56:59], v[248:251]
v_mfma_f32_16x16x32_bf16 v[252:255], v[92:95], v[56:59], v[252:255]
s_waitcnt lgkmcnt(1)
s_nop 0
v_mfma_f32_16x16x32_bf16 v[112:115], v[96:99], v[60:63], v[112:115]
ds_read_b128 v[56:59], v5 offset:43008
v_mfma_f32_16x16x32_bf16 v[116:119], v[100:103], v[60:63], v[116:119]
v_mfma_f32_16x16x32_bf16 v[120:123], v[104:107], v[60:63], v[120:123]
v_mfma_f32_16x16x32_bf16 v[124:127], v[108:111], v[60:63], v[124:127]
v_mfma_f32_16x16x32_bf16 v[128:131], v[96:99], v[64:67], v[128:131]
ds_read_b128 v[60:63], v5 offset:45056
v_mfma_f32_16x16x32_bf16 v[132:135], v[100:103], v[64:67], v[132:135]
v_mfma_f32_16x16x32_bf16 v[136:139], v[104:107], v[64:67], v[136:139]
v_mfma_f32_16x16x32_bf16 v[140:143], v[108:111], v[64:67], v[140:143]
s_waitcnt lgkmcnt(2)
s_nop 0
v_mfma_f32_16x16x32_bf16 v[144:147], v[96:99], v[68:71], v[144:147]
ds_read_b128 v[64:67], v5 offset:47104
v_mfma_f32_16x16x32_bf16 v[148:151], v[100:103], v[68:71], v[148:151]
v_mfma_f32_16x16x32_bf16 v[152:155], v[104:107], v[68:71], v[152:155]
v_mfma_f32_16x16x32_bf16 v[156:159], v[108:111], v[68:71], v[156:159]
s_waitcnt lgkmcnt(2)
s_nop 0
v_mfma_f32_16x16x32_bf16 v[160:163], v[96:99], v[56:59], v[160:163]
ds_read_b128 v[68:71], v5 offset:49152
v_mfma_f32_16x16x32_bf16 v[164:167], v[100:103], v[56:59], v[164:167]
v_mfma_f32_16x16x32_bf16 v[168:171], v[104:107], v[56:59], v[168:171]
v_mfma_f32_16x16x32_bf16 v[172:175], v[108:111], v[56:59], v[172:175]
s_waitcnt lgkmcnt(2)
s_nop 0
v_mfma_f32_16x16x32_bf16 v[176:179], v[96:99], v[60:63], v[176:179]
ds_read_b128 v[56:59], v5 offset:51200
v_mfma_f32_16x16x32_bf16 v[180:183], v[100:103], v[60:63], v[180:183]
v_mfma_f32_16x16x32_bf16 v[184:187], v[104:107], v[60:63], v[184:187]
v_mfma_f32_16x16x32_bf16 v[188:191], v[108:111], v[60:63], v[188:191]
s_waitcnt lgkmcnt(2)
s_nop 0
v_mfma_f32_16x16x32_bf16 v[192:195], v[96:99], v[64:67], v[192:195]
ds_read_b128 v[60:63], v5 offset:53248
v_mfma_f32_16x16x32_bf16 v[196:199], v[100:103], v[64:67], v[196:199]
v_mfma_f32_16x16x32_bf16 v[200:203], v[104:107], v[64:67], v[200:203]
v_mfma_f32_16x16x32_bf16 v[204:207], v[108:111], v[64:67], v[204:207]
s_waitcnt lgkmcnt(0)
s_barrier
v_mfma_f32_16x16x32_bf16 v[208:211], v[96:99], v[68:71], v[208:211]
s_cbranch_scc1 L14
s_nop 0
ds_read_b64_tr_b16 v[92:93], v8 offset:30816
ds_read_b64_tr_b16 v[94:95], v8 offset:34656
L14:
v_mfma_f32_16x16x32_bf16 v[212:215], v[100:103], v[68:71], v[212:215]
ds_read_b64_tr_b16 v[80:81], v8 offset:30720
v_mfma_f32_16x16x32_bf16 v[216:219], v[104:107], v[68:71], v[216:219]
ds_read_b64_tr_b16 v[82:83], v8 offset:34560
v_mfma_f32_16x16x32_bf16 v[220:223], v[108:111], v[68:71], v[220:223]
ds_read_b128 v[64:67], v4 offset:0
v_mfma_f32_16x16x32_bf16 v[224:227], v[96:99], v[56:59], v[224:227]
ds_read_b64_tr_b16 v[84:85], v8 offset:30752
v_mfma_f32_16x16x32_bf16 v[228:231], v[100:103], v[56:59], v[228:231]
ds_read_b64_tr_b16 v[86:87], v8 offset:34592
v_mfma_f32_16x16x32_bf16 v[232:235], v[104:107], v[56:59], v[232:235]
ds_read_b64_tr_b16 v[88:89], v8 offset:30784
v_mfma_f32_16x16x32_bf16 v[236:239], v[108:111], v[56:59], v[236:239]
ds_read_b128 v[68:71], v4 offset:2048
v_mfma_f32_16x16x32_bf16 v[240:243], v[96:99], v[60:63], v[240:243]
ds_read_b64_tr_b16 v[90:91], v8 offset:34624
v_mfma_f32_16x16x32_bf16 v[244:247], v[100:103], v[60:63], v[244:247]
ds_read_b128 v[56:59], v4 offset:4096
v_mfma_f32_16x16x32_bf16 v[248:251], v[104:107], v[60:63], v[248:251]
v_mfma_f32_16x16x32_bf16 v[252:255], v[108:111], v[60:63], v[252:255]
s_waitcnt lgkmcnt(1)
s_nop 0
v_mfma_f32_16x16x32_bf16 v[112:115], v[80:83], v[64:67], v[112:115]
ds_read_b128 v[60:63], v4 offset:6144
v_mfma_f32_16x16x32_bf16 v[116:119], v[84:87], v[64:67], v[116:119]
v_mfma_f32_16x16x32_bf16 v[120:123], v[88:91], v[64:67], v[120:123]
v_mfma_f32_16x16x32_bf16 v[124:127], v[92:95], v[64:67], v[124:127]
v_mfma_f32_16x16x32_bf16 v[128:131], v[80:83], v[68:71], v[128:131]
ds_read_b128 v[64:67], v4 offset:8192
v_mfma_f32_16x16x32_bf16 v[132:135], v[84:87], v[68:71], v[132:135]
v_mfma_f32_16x16x32_bf16 v[136:139], v[88:91], v[68:71], v[136:139]
v_mfma_f32_16x16x32_bf16 v[140:143], v[92:95], v[68:71], v[140:143]
s_waitcnt lgkmcnt(2)
s_nop 0
v_mfma_f32_16x16x32_bf16 v[144:147], v[80:83], v[56:59], v[144:147]
ds_read_b128 v[68:71], v4 offset:10240
v_mfma_f32_16x16x32_bf16 v[148:151], v[84:87], v[56:59], v[148:151]
v_mfma_f32_16x16x32_bf16 v[152:155], v[88:91], v[56:59], v[152:155]
v_mfma_f32_16x16x32_bf16 v[156:159], v[92:95], v[56:59], v[156:159]
s_waitcnt lgkmcnt(2)
s_nop 0
v_mfma_f32_16x16x32_bf16 v[160:163], v[80:83], v[60:63], v[160:163]
ds_read_b128 v[56:59], v4 offset:12288
v_mfma_f32_16x16x32_bf16 v[164:167], v[84:87], v[60:63], v[164:167]
v_mfma_f32_16x16x32_bf16 v[168:171], v[88:91], v[60:63], v[168:171]
v_mfma_f32_16x16x32_bf16 v[172:175], v[92:95], v[60:63], v[172:175]
s_waitcnt lgkmcnt(2)
s_nop 0
v_mfma_f32_16x16x32_bf16 v[176:179], v[80:83], v[64:67], v[176:179]
ds_read_b128 v[60:63], v4 offset:14336
v_mfma_f32_16x16x32_bf16 v[180:183], v[84:87], v[64:67], v[180:183]
v_mfma_f32_16x16x32_bf16 v[184:187], v[88:91], v[64:67], v[184:187]
v_mfma_f32_16x16x32_bf16 v[188:191], v[92:95], v[64:67], v[188:191]
s_waitcnt lgkmcnt(2)
s_nop 0
v_mfma_f32_16x16x32_bf16 v[192:195], v[80:83], v[68:71], v[192:195]
ds_read_b128 v[64:67], v4 offset:16384
v_mfma_f32_16x16x32_bf16 v[196:199], v[84:87], v[68:71], v[196:199]
v_mfma_f32_16x16x32_bf16 v[200:203], v[88:91], v[68:71], v[200:203]
v_mfma_f32_16x16x32_bf16 v[204:207], v[92:95], v[68:71], v[204:207]
s_waitcnt lgkmcnt(0)
s_barrier
v_mfma_f32_16x16x32_bf16 v[208:211], v[80:83], v[56:59], v[208:211]
s_cbranch_scc1 L15
s_nop 0
ds_read_b64_tr_b16 v[108:109], v8 offset:46176
ds_read_b64_tr_b16 v[110:111], v8 offset:50016
L15:
v_mfma_f32_16x16x32_bf16 v[212:215], v[84:87], v[56:59], v[212:215]
ds_read_b64_tr_b16 v[96:97], v8 offset:46080
v_mfma_f32_16x16x32_bf16 v[216:219], v[88:91], v[56:59], v[216:219]
ds_read_b64_tr_b16 v[98:99], v8 offset:49920
v_mfma_f32_16x16x32_bf16 v[220:223], v[92:95], v[56:59], v[220:223]
ds_read_b128 v[68:71], v5 offset:0
v_mfma_f32_16x16x32_bf16 v[224:227], v[80:83], v[60:63], v[224:227]
ds_read_b64_tr_b16 v[100:101], v8 offset:46112
v_mfma_f32_16x16x32_bf16 v[228:231], v[84:87], v[60:63], v[228:231]
ds_read_b64_tr_b16 v[102:103], v8 offset:49952
v_mfma_f32_16x16x32_bf16 v[232:235], v[88:91], v[60:63], v[232:235]
ds_read_b64_tr_b16 v[104:105], v8 offset:46144
v_mfma_f32_16x16x32_bf16 v[236:239], v[92:95], v[60:63], v[236:239]
ds_read_b128 v[56:59], v5 offset:2048
v_mfma_f32_16x16x32_bf16 v[240:243], v[80:83], v[64:67], v[240:243]
ds_read_b64_tr_b16 v[106:107], v8 offset:49984
v_mfma_f32_16x16x32_bf16 v[244:247], v[84:87], v[64:67], v[244:247]
ds_read_b128 v[60:63], v5 offset:4096
v_mfma_f32_16x16x32_bf16 v[248:251], v[88:91], v[64:67], v[248:251]
v_mfma_f32_16x16x32_bf16 v[252:255], v[92:95], v[64:67], v[252:255]
s_waitcnt lgkmcnt(1)
s_nop 0
v_mfma_f32_16x16x32_bf16 v[112:115], v[96:99], v[68:71], v[112:115]
ds_read_b128 v[64:67], v5 offset:6144
v_mfma_f32_16x16x32_bf16 v[116:119], v[100:103], v[68:71], v[116:119]
v_mfma_f32_16x16x32_bf16 v[120:123], v[104:107], v[68:71], v[120:123]
v_mfma_f32_16x16x32_bf16 v[124:127], v[108:111], v[68:71], v[124:127]
v_mfma_f32_16x16x32_bf16 v[128:131], v[96:99], v[56:59], v[128:131]
ds_read_b128 v[68:71], v5 offset:8192
v_mfma_f32_16x16x32_bf16 v[132:135], v[100:103], v[56:59], v[132:135]
v_mfma_f32_16x16x32_bf16 v[136:139], v[104:107], v[56:59], v[136:139]
v_mfma_f32_16x16x32_bf16 v[140:143], v[108:111], v[56:59], v[140:143]
s_waitcnt lgkmcnt(2)
s_nop 0
v_mfma_f32_16x16x32_bf16 v[144:147], v[96:99], v[60:63], v[144:147]
ds_read_b128 v[56:59], v5 offset:10240
v_mfma_f32_16x16x32_bf16 v[148:151], v[100:103], v[60:63], v[148:151]
v_mfma_f32_16x16x32_bf16 v[152:155], v[104:107], v[60:63], v[152:155]
v_mfma_f32_16x16x32_bf16 v[156:159], v[108:111], v[60:63], v[156:159]
s_waitcnt lgkmcnt(2)
s_nop 0
v_mfma_f32_16x16x32_bf16 v[160:163], v[96:99], v[64:67], v[160:163]
ds_read_b128 v[60:63], v5 offset:12288
v_mfma_f32_16x16x32_bf16 v[164:167], v[100:103], v[64:67], v[164:167]
v_mfma_f32_16x16x32_bf16 v[168:171], v[104:107], v[64:67], v[168:171]
v_mfma_f32_16x16x32_bf16 v[172:175], v[108:111], v[64:67], v[172:175]
s_waitcnt lgkmcnt(2)
s_nop 0
v_mfma_f32_16x16x32_bf16 v[176:179], v[96:99], v[68:71], v[176:179]
ds_read_b128 v[64:67], v5 offset:14336
v_mfma_f32_16x16x32_bf16 v[180:183], v[100:103], v[68:71], v[180:183]
v_mfma_f32_16x16x32_bf16 v[184:187], v[104:107], v[68:71], v[184:187]
v_mfma_f32_16x16x32_bf16 v[188:191], v[108:111], v[68:71], v[188:191]
s_waitcnt lgkmcnt(2)
s_nop 0
v_mfma_f32_16x16x32_bf16 v[192:195], v[96:99], v[56:59], v[192:195]
ds_read_b128 v[68:71], v5 offset:16384
v_mfma_f32_16x16x32_bf16 v[196:199], v[100:103], v[56:59], v[196:199]
v_mfma_f32_16x16x32_bf16 v[200:203], v[104:107], v[56:59], v[200:203]
v_mfma_f32_16x16x32_bf16 v[204:207], v[108:111], v[56:59], v[204:207]
s_waitcnt lgkmcnt(0)
s_barrier
v_mfma_f32_16x16x32_bf16 v[208:211], v[96:99], v[60:63], v[208:211]
s_cbranch_scc1 L16
s_nop 0
ds_read_b64_tr_b16 v[92:93], v8 offset:96
ds_read_b64_tr_b16 v[94:95], v8 offset:3936
L16:
v_mfma_f32_16x16x32_bf16 v[212:215], v[100:103], v[60:63], v[212:215]
ds_read_b64_tr_b16 v[80:81], v8 offset:0
v_mfma_f32_16x16x32_bf16 v[216:219], v[104:107], v[60:63], v[216:219]
ds_read_b64_tr_b16 v[82:83], v8 offset:3840
v_mfma_f32_16x16x32_bf16 v[220:223], v[108:111], v[60:63], v[220:223]
ds_read_b128 v[56:59], v4 offset:18432
v_mfma_f32_16x16x32_bf16 v[224:227], v[96:99], v[64:67], v[224:227]
ds_read_b64_tr_b16 v[84:85], v8 offset:32
v_mfma_f32_16x16x32_bf16 v[228:231], v[100:103], v[64:67], v[228:231]
ds_read_b64_tr_b16 v[86:87], v8 offset:3872
v_mfma_f32_16x16x32_bf16 v[232:235], v[104:107], v[64:67], v[232:235]
ds_read_b64_tr_b16 v[88:89], v8 offset:64
v_mfma_f32_16x16x32_bf16 v[236:239], v[108:111], v[64:67], v[236:239]
ds_read_b128 v[60:63], v4 offset:20480
v_mfma_f32_16x16x32_bf16 v[240:243], v[96:99], v[68:71], v[240:243]
ds_read_b64_tr_b16 v[90:91], v8 offset:3904
v_mfma_f32_16x16x32_bf16 v[244:247], v[100:103], v[68:71], v[244:247]
ds_read_b128 v[64:67], v4 offset:22528
v_mfma_f32_16x16x32_bf16 v[248:251], v[104:107], v[68:71], v[248:251]
v_mfma_f32_16x16x32_bf16 v[252:255], v[108:111], v[68:71], v[252:255]
s_waitcnt lgkmcnt(1)
s_nop 0
v_mfma_f32_16x16x32_bf16 v[112:115], v[80:83], v[56:59], v[112:115]
ds_read_b128 v[68:71], v4 offset:24576
v_mfma_f32_16x16x32_bf16 v[116:119], v[84:87], v[56:59], v[116:119]
v_mfma_f32_16x16x32_bf16 v[120:123], v[88:91], v[56:59], v[120:123]
v_mfma_f32_16x16x32_bf16 v[124:127], v[92:95], v[56:59], v[124:127]
v_mfma_f32_16x16x32_bf16 v[128:131], v[80:83], v[60:63], v[128:131]
ds_read_b128 v[56:59], v4 offset:26624
v_mfma_f32_16x16x32_bf16 v[132:135], v[84:87], v[60:63], v[132:135]
v_mfma_f32_16x16x32_bf16 v[136:139], v[88:91], v[60:63], v[136:139]
v_mfma_f32_16x16x32_bf16 v[140:143], v[92:95], v[60:63], v[140:143]
s_waitcnt lgkmcnt(2)
s_nop 0
v_mfma_f32_16x16x32_bf16 v[144:147], v[80:83], v[64:67], v[144:147]
ds_read_b128 v[60:63], v4 offset:28672
v_mfma_f32_16x16x32_bf16 v[148:151], v[84:87], v[64:67], v[148:151]
v_mfma_f32_16x16x32_bf16 v[152:155], v[88:91], v[64:67], v[152:155]
v_mfma_f32_16x16x32_bf16 v[156:159], v[92:95], v[64:67], v[156:159]
s_waitcnt lgkmcnt(2)
s_nop 0
v_mfma_f32_16x16x32_bf16 v[160:163], v[80:83], v[68:71], v[160:163]
ds_read_b128 v[64:67], v4 offset:30720
v_mfma_f32_16x16x32_bf16 v[164:167], v[84:87], v[68:71], v[164:167]
v_mfma_f32_16x16x32_bf16 v[168:171], v[88:91], v[68:71], v[168:171]
v_mfma_f32_16x16x32_bf16 v[172:175], v[92:95], v[68:71], v[172:175]
s_waitcnt lgkmcnt(2)
s_nop 0
v_mfma_f32_16x16x32_bf16 v[176:179], v[80:83], v[56:59], v[176:179]
ds_read_b128 v[68:71], v4 offset:32768
v_mfma_f32_16x16x32_bf16 v[180:183], v[84:87], v[56:59], v[180:183]
v_mfma_f32_16x16x32_bf16 v[184:187], v[88:91], v[56:59], v[184:187]
v_mfma_f32_16x16x32_bf16 v[188:191], v[92:95], v[56:59], v[188:191]
s_waitcnt lgkmcnt(2)
s_nop 0
v_mfma_f32_16x16x32_bf16 v[192:195], v[80:83], v[60:63], v[192:195]
ds_read_b128 v[56:59], v4 offset:34816
v_mfma_f32_16x16x32_bf16 v[196:199], v[84:87], v[60:63], v[196:199]
v_mfma_f32_16x16x32_bf16 v[200:203], v[88:91], v[60:63], v[200:203]
v_mfma_f32_16x16x32_bf16 v[204:207], v[92:95], v[60:63], v[204:207]
s_waitcnt lgkmcnt(0)
s_barrier
v_mfma_f32_16x16x32_bf16 v[208:211], v[80:83], v[64:67], v[208:211]
s_cbranch_scc1 L17
s_nop 0
ds_read_b64_tr_b16 v[108:109], v8 offset:15456
ds_read_b64_tr_b16 v[110:111], v8 offset:19296
L17:
v_mfma_f32_16x16x32_bf16 v[212:215], v[84:87], v[64:67], v[212:215]
ds_read_b64_tr_b16 v[96:97], v8 offset:15360
v_mfma_f32_16x16x32_bf16 v[216:219], v[88:91], v[64:67], v[216:219]
ds_read_b64_tr_b16 v[98:99], v8 offset:19200
v_mfma_f32_16x16x32_bf16 v[220:223], v[92:95], v[64:67], v[220:223]
ds_read_b128 v[60:63], v5 offset:18432
v_mfma_f32_16x16x32_bf16 v[224:227], v[80:83], v[68:71], v[224:227]
ds_read_b64_tr_b16 v[100:101], v8 offset:15392
v_mfma_f32_16x16x32_bf16 v[228:231], v[84:87], v[68:71], v[228:231]
ds_read_b64_tr_b16 v[102:103], v8 offset:19232
v_mfma_f32_16x16x32_bf16 v[232:235], v[88:91], v[68:71], v[232:235]
ds_read_b64_tr_b16 v[104:105], v8 offset:15424
v_mfma_f32_16x16x32_bf16 v[236:239], v[92:95], v[68:71], v[236:239]
ds_read_b128 v[64:67], v5 offset:20480
v_mfma_f32_16x16x32_bf16 v[240:243], v[80:83], v[56:59], v[240:243]
ds_read_b64_tr_b16 v[106:107], v8 offset:19264
v_mfma_f32_16x16x32_bf16 v[244:247], v[84:87], v[56:59], v[244:247]
ds_read_b128 v[68:71], v5 offset:22528
v_mfma_f32_16x16x32_bf16 v[248:251], v[88:91], v[56:59], v[248:251]
v_mfma_f32_16x16x32_bf16 v[252:255], v[92:95], v[56:59], v[252:255]
s_waitcnt lgkmcnt(1)
s_nop 0
v_mfma_f32_16x16x32_bf16 v[112:115], v[96:99], v[60:63], v[112:115]
ds_read_b128 v[56:59], v5 offset:24576
v_mfma_f32_16x16x32_bf16 v[116:119], v[100:103], v[60:63], v[116:119]
v_mfma_f32_16x16x32_bf16 v[120:123], v[104:107], v[60:63], v[120:123]
v_mfma_f32_16x16x32_bf16 v[124:127], v[108:111], v[60:63], v[124:127]
v_mfma_f32_16x16x32_bf16 v[128:131], v[96:99], v[64:67], v[128:131]
ds_read_b128 v[60:63], v5 offset:26624
v_mfma_f32_16x16x32_bf16 v[132:135], v[100:103], v[64:67], v[132:135]
v_mfma_f32_16x16x32_bf16 v[136:139], v[104:107], v[64:67], v[136:139]
v_mfma_f32_16x16x32_bf16 v[140:143], v[108:111], v[64:67], v[140:143]
s_waitcnt lgkmcnt(2)
s_nop 0
v_mfma_f32_16x16x32_bf16 v[144:147], v[96:99], v[68:71], v[144:147]
ds_read_b128 v[64:67], v5 offset:28672
v_mfma_f32_16x16x32_bf16 v[148:151], v[100:103], v[68:71], v[148:151]
v_mfma_f32_16x16x32_bf16 v[152:155], v[104:107], v[68:71], v[152:155]
v_mfma_f32_16x16x32_bf16 v[156:159], v[108:111], v[68:71], v[156:159]
s_waitcnt lgkmcnt(2)
s_nop 0
v_mfma_f32_16x16x32_bf16 v[160:163], v[96:99], v[56:59], v[160:163]
ds_read_b128 v[68:71], v5 offset:30720
v_mfma_f32_16x16x32_bf16 v[164:167], v[100:103], v[56:59], v[164:167]
v_mfma_f32_16x16x32_bf16 v[168:171], v[104:107], v[56:59], v[168:171]
v_mfma_f32_16x16x32_bf16 v[172:175], v[108:111], v[56:59], v[172:175]
s_waitcnt lgkmcnt(2)
s_nop 0
v_mfma_f32_16x16x32_bf16 v[176:179], v[96:99], v[60:63], v[176:179]
ds_read_b128 v[56:59], v5 offset:32768
v_mfma_f32_16x16x32_bf16 v[180:183], v[100:103], v[60:63], v[180:183]
v_mfma_f32_16x16x32_bf16 v[184:187], v[104:107], v[60:63], v[184:187]
v_mfma_f32_16x16x32_bf16 v[188:191], v[108:111], v[60:63], v[188:191]
s_waitcnt lgkmcnt(2)
s_nop 0
v_mfma_f32_16x16x32_bf16 v[192:195], v[96:99], v[64:67], v[192:195]
ds_read_b128 v[60:63], v5 offset:34816
v_mfma_f32_16x16x32_bf16 v[196:199], v[100:103], v[64:67], v[196:199]
v_mfma_f32_16x16x32_bf16 v[200:203], v[104:107], v[64:67], v[200:203]
v_mfma_f32_16x16x32_bf16 v[204:207], v[108:111], v[64:67], v[204:207]
s_waitcnt lgkmcnt(0)
s_barrier
v_mfma_f32_16x16x32_bf16 v[208:211], v[96:99], v[68:71], v[208:211]
s_cbranch_scc1 L18
s_nop 0
ds_read_b64_tr_b16 v[92:93], v8 offset:30816
ds_read_b64_tr_b16 v[94:95], v8 offset:34656
L18:
v_mfma_f32_16x16x32_bf16 v[212:215], v[100:103], v[68:71], v[212:215]
ds_read_b64_tr_b16 v[80:81], v8 offset:30720
v_mfma_f32_16x16x32_bf16 v[216:219], v[104:107], v[68:71], v[216:219]
ds_read_b64_tr_b16 v[82:83], v8 offset:34560
v_mfma_f32_16x16x32_bf16 v[220:223], v[108:111], v[68:71], v[220:223]
ds_read_b128 v[64:67], v4 offset:36864
v_mfma_f32_16x16x32_bf16 v[224:227], v[96:99], v[56:59], v[224:227]
ds_read_b64_tr_b16 v[84:85], v8 offset:30752
v_mfma_f32_16x16x32_bf16 v[228:231], v[100:103], v[56:59], v[228:231]
ds_read_b64_tr_b16 v[86:87], v8 offset:34592
v_mfma_f32_16x16x32_bf16 v[232:235], v[104:107], v[56:59], v[232:235]
ds_read_b64_tr_b16 v[88:89], v8 offset:30784
v_mfma_f32_16x16x32_bf16 v[236:239], v[108:111], v[56:59], v[236:239]
ds_read_b128 v[68:71], v4 offset:38912
v_mfma_f32_16x16x32_bf16 v[240:243], v[96:99], v[60:63], v[240:243]
ds_read_b64_tr_b16 v[90:91], v8 offset:34624
v_mfma_f32_16x16x32_bf16 v[244:247], v[100:103], v[60:63], v[244:247]
ds_read_b128 v[56:59], v4 offset:40960
v_mfma_f32_16x16x32_bf16 v[248:251], v[104:107], v[60:63], v[248:251]
v_mfma_f32_16x16x32_bf16 v[252:255], v[108:111], v[60:63], v[252:255]
s_waitcnt lgkmcnt(1)
s_nop 0
v_mfma_f32_16x16x32_bf16 v[112:115], v[80:83], v[64:67], v[112:115]
ds_read_b128 v[60:63], v4 offset:43008
v_mfma_f32_16x16x32_bf16 v[116:119], v[84:87], v[64:67], v[116:119]
v_mfma_f32_16x16x32_bf16 v[120:123], v[88:91], v[64:67], v[120:123]
v_mfma_f32_16x16x32_bf16 v[124:127], v[92:95], v[64:67], v[124:127]
v_mfma_f32_16x16x32_bf16 v[128:131], v[80:83], v[68:71], v[128:131]
ds_read_b128 v[64:67], v4 offset:45056
v_mfma_f32_16x16x32_bf16 v[132:135], v[84:87], v[68:71], v[132:135]
v_mfma_f32_16x16x32_bf16 v[136:139], v[88:91], v[68:71], v[136:139]
v_mfma_f32_16x16x32_bf16 v[140:143], v[92:95], v[68:71], v[140:143]
s_waitcnt lgkmcnt(2)
s_nop 0
v_mfma_f32_16x16x32_bf16 v[144:147], v[80:83], v[56:59], v[144:147]
ds_read_b128 v[68:71], v4 offset:47104
v_mfma_f32_16x16x32_bf16 v[148:151], v[84:87], v[56:59], v[148:151]
v_mfma_f32_16x16x32_bf16 v[152:155], v[88:91], v[56:59], v[152:155]
v_mfma_f32_16x16x32_bf16 v[156:159], v[92:95], v[56:59], v[156:159]
s_waitcnt lgkmcnt(2)
s_nop 0
v_mfma_f32_16x16x32_bf16 v[160:163], v[80:83], v[60:63], v[160:163]
ds_read_b128 v[56:59], v4 offset:49152
v_mfma_f32_16x16x32_bf16 v[164:167], v[84:87], v[60:63], v[164:167]
v_mfma_f32_16x16x32_bf16 v[168:171], v[88:91], v[60:63], v[168:171]
v_mfma_f32_16x16x32_bf16 v[172:175], v[92:95], v[60:63], v[172:175]
s_waitcnt lgkmcnt(2)
s_nop 0
v_mfma_f32_16x16x32_bf16 v[176:179], v[80:83], v[64:67], v[176:179]
ds_read_b128 v[60:63], v4 offset:51200
v_mfma_f32_16x16x32_bf16 v[180:183], v[84:87], v[64:67], v[180:183]
v_mfma_f32_16x16x32_bf16 v[184:187], v[88:91], v[64:67], v[184:187]
v_mfma_f32_16x16x32_bf16 v[188:191], v[92:95], v[64:67], v[188:191]
s_waitcnt lgkmcnt(2)
s_nop 0
v_mfma_f32_16x16x32_bf16 v[192:195], v[80:83], v[68:71], v[192:195]
ds_read_b128 v[64:67], v4 offset:53248
v_mfma_f32_16x16x32_bf16 v[196:199], v[84:87], v[68:71], v[196:199]
v_mfma_f32_16x16x32_bf16 v[200:203], v[88:91], v[68:71], v[200:203]
v_mfma_f32_16x16x32_bf16 v[204:207], v[92:95], v[68:71], v[204:207]
s_waitcnt lgkmcnt(0)
s_barrier
v_mfma_f32_16x16x32_bf16 v[208:211], v[80:83], v[56:59], v[208:211]
s_cbranch_scc1 L19
s_nop 0
ds_read_b64_tr_b16 v[108:109], v8 offset:46176
ds_read_b64_tr_b16 v[110:111], v8 offset:50016
L19:
v_mfma_f32_16x16x32_bf16 v[212:215], v[84:87], v[56:59], v[212:215]
ds_read_b64_tr_b16 v[96:97], v8 offset:46080
v_mfma_f32_16x16x32_bf16 v[216:219], v[88:91], v[56:59], v[216:219]
ds_read_b64_tr_b16 v[98:99], v8 offset:49920
v_mfma_f32_16x16x32_bf16 v[220:223], v[92:95], v[56:59], v[220:223]
ds_read_b128 v[68:71], v5 offset:36864
v_mfma_f32_16x16x32_bf16 v[224:227], v[80:83], v[60:63], v[224:227]
ds_read_b64_tr_b16 v[100:101], v8 offset:46112
v_mfma_f32_16x16x32_bf16 v[228:231], v[84:87], v[60:63], v[228:231]
ds_read_b64_tr_b16 v[102:103], v8 offset:49952
v_mfma_f32_16x16x32_bf16 v[232:235], v[88:91], v[60:63], v[232:235]
ds_read_b64_tr_b16 v[104:105], v8 offset:46144
v_mfma_f32_16x16x32_bf16 v[236:239], v[92:95], v[60:63], v[236:239]
ds_read_b128 v[56:59], v5 offset:38912
v_mfma_f32_16x16x32_bf16 v[240:243], v[80:83], v[64:67], v[240:243]
ds_read_b64_tr_b16 v[106:107], v8 offset:49984
v_mfma_f32_16x16x32_bf16 v[244:247], v[84:87], v[64:67], v[244:247]
ds_read_b128 v[60:63], v5 offset:40960
v_mfma_f32_16x16x32_bf16 v[248:251], v[88:91], v[64:67], v[248:251]
v_mfma_f32_16x16x32_bf16 v[252:255], v[92:95], v[64:67], v[252:255]
s_waitcnt lgkmcnt(1)
s_nop 0
v_mfma_f32_16x16x32_bf16 v[112:115], v[96:99], v[68:71], v[112:115]
ds_read_b128 v[64:67], v5 offset:43008
v_mfma_f32_16x16x32_bf16 v[116:119], v[100:103], v[68:71], v[116:119]
v_mfma_f32_16x16x32_bf16 v[120:123], v[104:107], v[68:71], v[120:123]
v_mfma_f32_16x16x32_bf16 v[124:127], v[108:111], v[68:71], v[124:127]
v_mfma_f32_16x16x32_bf16 v[128:131], v[96:99], v[56:59], v[128:131]
ds_read_b128 v[68:71], v5 offset:45056
v_mfma_f32_16x16x32_bf16 v[132:135], v[100:103], v[56:59], v[132:135]
v_mfma_f32_16x16x32_bf16 v[136:139], v[104:107], v[56:59], v[136:139]
v_mfma_f32_16x16x32_bf16 v[140:143], v[108:111], v[56:59], v[140:143]
s_waitcnt lgkmcnt(2)
s_nop 0
v_mfma_f32_16x16x32_bf16 v[144:147], v[96:99], v[60:63], v[144:147]
ds_read_b128 v[56:59], v5 offset:47104
v_mfma_f32_16x16x32_bf16 v[148:151], v[100:103], v[60:63], v[148:151]
v_mfma_f32_16x16x32_bf16 v[152:155], v[104:107], v[60:63], v[152:155]
v_mfma_f32_16x16x32_bf16 v[156:159], v[108:111], v[60:63], v[156:159]
s_waitcnt lgkmcnt(2)
s_nop 0
v_mfma_f32_16x16x32_bf16 v[160:163], v[96:99], v[64:67], v[160:163]
ds_read_b128 v[60:63], v5 offset:49152
v_mfma_f32_16x16x32_bf16 v[164:167], v[100:103], v[64:67], v[164:167]
v_mfma_f32_16x16x32_bf16 v[168:171], v[104:107], v[64:67], v[168:171]
v_mfma_f32_16x16x32_bf16 v[172:175], v[108:111], v[64:67], v[172:175]
s_waitcnt lgkmcnt(2)
s_nop 0
v_mfma_f32_16x16x32_bf16 v[176:179], v[96:99], v[68:71], v[176:179]
ds_read_b128 v[64:67], v5 offset:51200
v_mfma_f32_16x16x32_bf16 v[180:183], v[100:103], v[68:71], v[180:183]
v_mfma_f32_16x16x32_bf16 v[184:187], v[104:107], v[68:71], v[184:187]
v_mfma_f32_16x16x32_bf16 v[188:191], v[108:111], v[68:71], v[188:191]
s_waitcnt lgkmcnt(2)
s_nop 0
v_mfma_f32_16x16x32_bf16 v[192:195], v[96:99], v[56:59], v[192:195]
ds_read_b128 v[68:71], v5 offset:53248
v_mfma_f32_16x16x32_bf16 v[196:199], v[100:103], v[56:59], v[196:199]
v_mfma_f32_16x16x32_bf16 v[200:203], v[104:107], v[56:59], v[200:203]
v_mfma_f32_16x16x32_bf16 v[204:207], v[108:111], v[56:59], v[204:207]
s_waitcnt lgkmcnt(0)
s_barrier
v_mfma_f32_16x16x32_bf16 v[208:211], v[96:99], v[60:63], v[208:211]
s_cbranch_scc1 L20
s_nop 0
ds_read_b64_tr_b16 v[92:93], v8 offset:96
ds_read_b64_tr_b16 v[94:95], v8 offset:3936
L20:
v_mfma_f32_16x16x32_bf16 v[212:215], v[100:103], v[60:63], v[212:215]
ds_read_b64_tr_b16 v[80:81], v8 offset:0
v_mfma_f32_16x16x32_bf16 v[216:219], v[104:107], v[60:63], v[216:219]
ds_read_b64_tr_b16 v[82:83], v8 offset:3840
v_mfma_f32_16x16x32_bf16 v[220:223], v[108:111], v[60:63], v[220:223]
ds_read_b128 v[56:59], v4 offset:0
v_mfma_f32_16x16x32_bf16 v[224:227], v[96:99], v[64:67], v[224:227]
ds_read_b64_tr_b16 v[84:85], v8 offset:32
v_mfma_f32_16x16x32_bf16 v[228:231], v[100:103], v[64:67], v[228:231]
ds_read_b64_tr_b16 v[86:87], v8 offset:3872
v_mfma_f32_16x16x32_bf16 v[232:235], v[104:107], v[64:67], v[232:235]
ds_read_b64_tr_b16 v[88:89], v8 offset:64
v_mfma_f32_16x16x32_bf16 v[236:239], v[108:111], v[64:67], v[236:239]
ds_read_b128 v[60:63], v4 offset:2048
v_mfma_f32_16x16x32_bf16 v[240:243], v[96:99], v[68:71], v[240:243]
ds_read_b64_tr_b16 v[90:91], v8 offset:3904
v_mfma_f32_16x16x32_bf16 v[244:247], v[100:103], v[68:71], v[244:247]
ds_read_b128 v[64:67], v4 offset:4096
v_mfma_f32_16x16x32_bf16 v[248:251], v[104:107], v[68:71], v[248:251]
v_mfma_f32_16x16x32_bf16 v[252:255], v[108:111], v[68:71], v[252:255]
s_waitcnt lgkmcnt(1)
s_nop 0
v_mfma_f32_16x16x32_bf16 v[112:115], v[80:83], v[56:59], v[112:115]
ds_read_b128 v[68:71], v4 offset:6144
v_mfma_f32_16x16x32_bf16 v[116:119], v[84:87], v[56:59], v[116:119]
v_mfma_f32_16x16x32_bf16 v[120:123], v[88:91], v[56:59], v[120:123]
v_mfma_f32_16x16x32_bf16 v[124:127], v[92:95], v[56:59], v[124:127]
v_mfma_f32_16x16x32_bf16 v[128:131], v[80:83], v[60:63], v[128:131]
ds_read_b128 v[56:59], v4 offset:8192
v_mfma_f32_16x16x32_bf16 v[132:135], v[84:87], v[60:63], v[132:135]
v_mfma_f32_16x16x32_bf16 v[136:139], v[88:91], v[60:63], v[136:139]
v_mfma_f32_16x16x32_bf16 v[140:143], v[92:95], v[60:63], v[140:143]
s_waitcnt lgkmcnt(2)
s_nop 0
v_mfma_f32_16x16x32_bf16 v[144:147], v[80:83], v[64:67], v[144:147]
ds_read_b128 v[60:63], v4 offset:10240
v_mfma_f32_16x16x32_bf16 v[148:151], v[84:87], v[64:67], v[148:151]
v_mfma_f32_16x16x32_bf16 v[152:155], v[88:91], v[64:67], v[152:155]
v_mfma_f32_16x16x32_bf16 v[156:159], v[92:95], v[64:67], v[156:159]
s_waitcnt lgkmcnt(2)
s_nop 0
v_mfma_f32_16x16x32_bf16 v[160:163], v[80:83], v[68:71], v[160:163]
ds_read_b128 v[64:67], v4 offset:12288
v_mfma_f32_16x16x32_bf16 v[164:167], v[84:87], v[68:71], v[164:167]
v_mfma_f32_16x16x32_bf16 v[168:171], v[88:91], v[68:71], v[168:171]
v_mfma_f32_16x16x32_bf16 v[172:175], v[92:95], v[68:71], v[172:175]
s_waitcnt lgkmcnt(2)
s_nop 0
v_mfma_f32_16x16x32_bf16 v[176:179], v[80:83], v[56:59], v[176:179]
ds_read_b128 v[68:71], v4 offset:14336
v_mfma_f32_16x16x32_bf16 v[180:183], v[84:87], v[56:59], v[180:183]
v_mfma_f32_16x16x32_bf16 v[184:187], v[88:91], v[56:59], v[184:187]
v_mfma_f32_16x16x32_bf16 v[188:191], v[92:95], v[56:59], v[188:191]
s_waitcnt lgkmcnt(2)
s_nop 0
v_mfma_f32_16x16x32_bf16 v[192:195], v[80:83], v[60:63], v[192:195]
ds_read_b128 v[56:59], v4 offset:16384
v_mfma_f32_16x16x32_bf16 v[196:199], v[84:87], v[60:63], v[196:199]
v_mfma_f32_16x16x32_bf16 v[200:203], v[88:91], v[60:63], v[200:203]
v_mfma_f32_16x16x32_bf16 v[204:207], v[92:95], v[60:63], v[204:207]
s_waitcnt lgkmcnt(0)
s_barrier
v_mfma_f32_16x16x32_bf16 v[208:211], v[80:83], v[64:67], v[208:211]
s_cbranch_scc1 L21
s_nop 0
ds_read_b64_tr_b16 v[108:109], v8 offset:15456
ds_read_b64_tr_b16 v[110:111], v8 offset:19296
L21:
v_mfma_f32_16x16x32_bf16 v[212:215], v[84:87], v[64:67], v[212:215]
ds_read_b64_tr_b16 v[96:97], v8 offset:15360
v_mfma_f32_16x16x32_bf16 v[216:219], v[88:91], v[64:67], v[216:219]
ds_read_b64_tr_b16 v[98:99], v8 offset:19200
v_mfma_f32_16x16x32_bf16 v[220:223], v[92:95], v[64:67], v[220:223]
ds_read_b128 v[60:63], v5 offset:0
v_mfma_f32_16x16x32_bf16 v[224:227], v[80:83], v[68:71], v[224:227]
ds_read_b64_tr_b16 v[100:101], v8 offset:15392
v_mfma_f32_16x16x32_bf16 v[228:231], v[84:87], v[68:71], v[228:231]
ds_read_b64_tr_b16 v[102:103], v8 offset:19232
v_mfma_f32_16x16x32_bf16 v[232:235], v[88:91], v[68:71], v[232:235]
ds_read_b64_tr_b16 v[104:105], v8 offset:15424
v_mfma_f32_16x16x32_bf16 v[236:239], v[92:95], v[68:71], v[236:239]
ds_read_b128 v[64:67], v5 offset:2048
v_mfma_f32_16x16x32_bf16 v[240:243], v[80:83], v[56:59], v[240:243]
ds_read_b64_tr_b16 v[106:107], v8 offset:19264
v_mfma_f32_16x16x32_bf16 v[244:247], v[84:87], v[56:59], v[244:247]
ds_read_b128 v[68:71], v5 offset:4096
v_mfma_f32_16x16x32_bf16 v[248:251], v[88:91], v[56:59], v[248:251]
v_mfma_f32_16x16x32_bf16 v[252:255], v[92:95], v[56:59], v[252:255]
s_waitcnt lgkmcnt(1)
s_nop 0
v_mfma_f32_16x16x32_bf16 v[112:115], v[96:99], v[60:63], v[112:115]
ds_read_b128 v[56:59], v5 offset:6144
v_mfma_f32_16x16x32_bf16 v[116:119], v[100:103], v[60:63], v[116:119]
v_mfma_f32_16x16x32_bf16 v[120:123], v[104:107], v[60:63], v[120:123]
v_mfma_f32_16x16x32_bf16 v[124:127], v[108:111], v[60:63], v[124:127]
v_mfma_f32_16x16x32_bf16 v[128:131], v[96:99], v[64:67], v[128:131]
ds_read_b128 v[60:63], v5 offset:8192
v_mfma_f32_16x16x32_bf16 v[132:135], v[100:103], v[64:67], v[132:135]
v_mfma_f32_16x16x32_bf16 v[136:139], v[104:107], v[64:67], v[136:139]
v_mfma_f32_16x16x32_bf16 v[140:143], v[108:111], v[64:67], v[140:143]
s_waitcnt lgkmcnt(2)
s_nop 0
v_mfma_f32_16x16x32_bf16 v[144:147], v[96:99], v[68:71], v[144:147]
ds_read_b128 v[64:67], v5 offset:10240
v_mfma_f32_16x16x32_bf16 v[148:151], v[100:103], v[68:71], v[148:151]
v_mfma_f32_16x16x32_bf16 v[152:155], v[104:107], v[68:71], v[152:155]
v_mfma_f32_16x16x32_bf16 v[156:159], v[108:111], v[68:71], v[156:159]
s_waitcnt lgkmcnt(2)
s_nop 0
v_mfma_f32_16x16x32_bf16 v[160:163], v[96:99], v[56:59], v[160:163]
ds_read_b128 v[68:71], v5 offset:12288
v_mfma_f32_16x16x32_bf16 v[164:167], v[100:103], v[56:59], v[164:167]
v_mfma_f32_16x16x32_bf16 v[168:171], v[104:107], v[56:59], v[168:171]
v_mfma_f32_16x16x32_bf16 v[172:175], v[108:111], v[56:59], v[172:175]
s_waitcnt lgkmcnt(2)
s_nop 0
v_mfma_f32_16x16x32_bf16 v[176:179], v[96:99], v[60:63], v[176:179]
ds_read_b128 v[56:59], v5 offset:14336
v_mfma_f32_16x16x32_bf16 v[180:183], v[100:103], v[60:63], v[180:183]
v_mfma_f32_16x16x32_bf16 v[184:187], v[104:107], v[60:63], v[184:187]
v_mfma_f32_16x16x32_bf16 v[188:191], v[108:111], v[60:63], v[188:191]
s_waitcnt lgkmcnt(2)
s_nop 0
v_mfma_f32_16x16x32_bf16 v[192:195], v[96:99], v[64:67], v[192:195]
ds_read_b128 v[60:63], v5 offset:16384
v_mfma_f32_16x16x32_bf16 v[196:199], v[100:103], v[64:67], v[196:199]
v_mfma_f32_16x16x32_bf16 v[200:203], v[104:107], v[64:67], v[200:203]
v_mfma_f32_16x16x32_bf16 v[204:207], v[108:111], v[64:67], v[204:207]
s_waitcnt lgkmcnt(0)
s_barrier
v_mfma_f32_16x16x32_bf16 v[208:211], v[96:99], v[68:71], v[208:211]
s_cbranch_scc1 L22
s_nop 0
ds_read_b64_tr_b16 v[92:93], v8 offset:30816
ds_read_b64_tr_b16 v[94:95], v8 offset:34656
L22:
v_mfma_f32_16x16x32_bf16 v[212:215], v[100:103], v[68:71], v[212:215]
ds_read_b64_tr_b16 v[80:81], v8 offset:30720
v_mfma_f32_16x16x32_bf16 v[216:219], v[104:107], v[68:71], v[216:219]
ds_read_b64_tr_b16 v[82:83], v8 offset:34560
v_mfma_f32_16x16x32_bf16 v[220:223], v[108:111], v[68:71], v[220:223]
ds_read_b128 v[64:67], v4 offset:18432
v_mfma_f32_16x16x32_bf16 v[224:227], v[96:99], v[56:59], v[224:227]
ds_read_b64_tr_b16 v[84:85], v8 offset:30752
v_mfma_f32_16x16x32_bf16 v[228:231], v[100:103], v[56:59], v[228:231]
ds_read_b64_tr_b16 v[86:87], v8 offset:34592
v_mfma_f32_16x16x32_bf16 v[232:235], v[104:107], v[56:59], v[232:235]
ds_read_b64_tr_b16 v[88:89], v8 offset:30784
v_mfma_f32_16x16x32_bf16 v[236:239], v[108:111], v[56:59], v[236:239]
ds_read_b128 v[68:71], v4 offset:20480
v_mfma_f32_16x16x32_bf16 v[240:243], v[96:99], v[60:63], v[240:243]
ds_read_b64_tr_b16 v[90:91], v8 offset:34624
v_mfma_f32_16x16x32_bf16 v[244:247], v[100:103], v[60:63], v[244:247]
ds_read_b128 v[56:59], v4 offset:22528
v_mfma_f32_16x16x32_bf16 v[248:251], v[104:107], v[60:63], v[248:251]
v_mfma_f32_16x16x32_bf16 v[252:255], v[108:111], v[60:63], v[252:255]
s_waitcnt lgkmcnt(1)
s_nop 0
v_mfma_f32_16x16x32_bf16 v[112:115], v[80:83], v[64:67], v[112:115]
ds_read_b128 v[60:63], v4 offset:24576
v_mfma_f32_16x16x32_bf16 v[116:119], v[84:87], v[64:67], v[116:119]
v_mfma_f32_16x16x32_bf16 v[120:123], v[88:91], v[64:67], v[120:123]
v_mfma_f32_16x16x32_bf16 v[124:127], v[92:95], v[64:67], v[124:127]
v_mfma_f32_16x16x32_bf16 v[128:131], v[80:83], v[68:71], v[128:131]
ds_read_b128 v[64:67], v4 offset:26624
v_mfma_f32_16x16x32_bf16 v[132:135], v[84:87], v[68:71], v[132:135]
v_mfma_f32_16x16x32_bf16 v[136:139], v[88:91], v[68:71], v[136:139]
v_mfma_f32_16x16x32_bf16 v[140:143], v[92:95], v[68:71], v[140:143]
s_waitcnt lgkmcnt(2)
s_nop 0
v_mfma_f32_16x16x32_bf16 v[144:147], v[80:83], v[56:59], v[144:147]
ds_read_b128 v[68:71], v4 offset:28672
v_mfma_f32_16x16x32_bf16 v[148:151], v[84:87], v[56:59], v[148:151]
v_mfma_f32_16x16x32_bf16 v[152:155], v[88:91], v[56:59], v[152:155]
v_mfma_f32_16x16x32_bf16 v[156:159], v[92:95], v[56:59], v[156:159]
s_waitcnt lgkmcnt(2)
s_nop 0
v_mfma_f32_16x16x32_bf16 v[160:163], v[80:83], v[60:63], v[160:163]
ds_read_b128 v[56:59], v4 offset:30720
v_mfma_f32_16x16x32_bf16 v[164:167], v[84:87], v[60:63], v[164:167]
v_mfma_f32_16x16x32_bf16 v[168:171], v[88:91], v[60:63], v[168:171]
v_mfma_f32_16x16x32_bf16 v[172:175], v[92:95], v[60:63], v[172:175]
s_waitcnt lgkmcnt(2)
s_nop 0
v_mfma_f32_16x16x32_bf16 v[176:179], v[80:83], v[64:67], v[176:179]
ds_read_b128 v[60:63], v4 offset:32768
v_mfma_f32_16x16x32_bf16 v[180:183], v[84:87], v[64:67], v[180:183]
v_mfma_f32_16x16x32_bf16 v[184:187], v[88:91], v[64:67], v[184:187]
v_mfma_f32_16x16x32_bf16 v[188:191], v[92:95], v[64:67], v[188:191]
s_waitcnt lgkmcnt(2)
s_nop 0
v_mfma_f32_16x16x32_bf16 v[192:195], v[80:83], v[68:71], v[192:195]
ds_read_b128 v[64:67], v4 offset:34816
v_mfma_f32_16x16x32_bf16 v[196:199], v[84:87], v[68:71], v[196:199]
v_mfma_f32_16x16x32_bf16 v[200:203], v[88:91], v[68:71], v[200:203]
v_mfma_f32_16x16x32_bf16 v[204:207], v[92:95], v[68:71], v[204:207]
s_waitcnt lgkmcnt(0)
s_barrier
v_mfma_f32_16x16x32_bf16 v[208:211], v[80:83], v[56:59], v[208:211]
s_cbranch_scc1 L23
s_nop 0
ds_read_b64_tr_b16 v[108:109], v8 offset:46176
ds_read_b64_tr_b16 v[110:111], v8 offset:50016
L23:
v_mfma_f32_16x16x32_bf16 v[212:215], v[84:87], v[56:59], v[212:215]
ds_read_b64_tr_b16 v[96:97], v8 offset:46080
v_mfma_f32_16x16x32_bf16 v[216:219], v[88:91], v[56:59], v[216:219]
ds_read_b64_tr_b16 v[98:99], v8 offset:49920
v_mfma_f32_16x16x32_bf16 v[220:223], v[92:95], v[56:59], v[220:223]
ds_read_b128 v[68:71], v5 offset:18432
v_mfma_f32_16x16x32_bf16 v[224:227], v[80:83], v[60:63], v[224:227]
ds_read_b64_tr_b16 v[100:101], v8 offset:46112
v_mfma_f32_16x16x32_bf16 v[228:231], v[84:87], v[60:63], v[228:231]
ds_read_b64_tr_b16 v[102:103], v8 offset:49952
v_mfma_f32_16x16x32_bf16 v[232:235], v[88:91], v[60:63], v[232:235]
ds_read_b64_tr_b16 v[104:105], v8 offset:46144
v_mfma_f32_16x16x32_bf16 v[236:239], v[92:95], v[60:63], v[236:239]
ds_read_b128 v[56:59], v5 offset:20480
v_mfma_f32_16x16x32_bf16 v[240:243], v[80:83], v[64:67], v[240:243]
ds_read_b64_tr_b16 v[106:107], v8 offset:49984
v_mfma_f32_16x16x32_bf16 v[244:247], v[84:87], v[64:67], v[244:247]
ds_read_b128 v[60:63], v5 offset:22528
v_mfma_f32_16x16x32_bf16 v[248:251], v[88:91], v[64:67], v[248:251]
v_mfma_f32_16x16x32_bf16 v[252:255], v[92:95], v[64:67], v[252:255]
s_waitcnt lgkmcnt(1)
s_nop 0
v_mfma_f32_16x16x32_bf16 v[112:115], v[96:99], v[68:71], v[112:115]
ds_read_b128 v[64:67], v5 offset:24576
v_mfma_f32_16x16x32_bf16 v[116:119], v[100:103], v[68:71], v[116:119]
v_mfma_f32_16x16x32_bf16 v[120:123], v[104:107], v[68:71], v[120:123]
v_mfma_f32_16x16x32_bf16 v[124:127], v[108:111], v[68:71], v[124:127]
v_mfma_f32_16x16x32_bf16 v[128:131], v[96:99], v[56:59], v[128:131]
ds_read_b128 v[68:71], v5 offset:26624
v_mfma_f32_16x16x32_bf16 v[132:135], v[100:103], v[56:59], v[132:135]
v_mfma_f32_16x16x32_bf16 v[136:139], v[104:107], v[56:59], v[136:139]
v_mfma_f32_16x16x32_bf16 v[140:143], v[108:111], v[56:59], v[140:143]
s_waitcnt lgkmcnt(2)
s_nop 0
v_mfma_f32_16x16x32_bf16 v[144:147], v[96:99], v[60:63], v[144:147]
ds_read_b128 v[56:59], v5 offset:28672
v_mfma_f32_16x16x32_bf16 v[148:151], v[100:103], v[60:63], v[148:151]
v_mfma_f32_16x16x32_bf16 v[152:155], v[104:107], v[60:63], v[152:155]
v_mfma_f32_16x16x32_bf16 v[156:159], v[108:111], v[60:63], v[156:159]
s_waitcnt lgkmcnt(2)
s_nop 0
v_mfma_f32_16x16x32_bf16 v[160:163], v[96:99], v[64:67], v[160:163]
ds_read_b128 v[60:63], v5 offset:30720
v_mfma_f32_16x16x32_bf16 v[164:167], v[100:103], v[64:67], v[164:167]
v_mfma_f32_16x16x32_bf16 v[168:171], v[104:107], v[64:67], v[168:171]
v_mfma_f32_16x16x32_bf16 v[172:175], v[108:111], v[64:67], v[172:175]
s_waitcnt lgkmcnt(2)
s_nop 0
v_mfma_f32_16x16x32_bf16 v[176:179], v[96:99], v[68:71], v[176:179]
ds_read_b128 v[64:67], v5 offset:32768
v_mfma_f32_16x16x32_bf16 v[180:183], v[100:103], v[68:71], v[180:183]
v_mfma_f32_16x16x32_bf16 v[184:187], v[104:107], v[68:71], v[184:187]
v_mfma_f32_16x16x32_bf16 v[188:191], v[108:111], v[68:71], v[188:191]
s_waitcnt lgkmcnt(2)
s_nop 0
v_mfma_f32_16x16x32_bf16 v[192:195], v[96:99], v[56:59], v[192:195]
ds_read_b128 v[68:71], v5 offset:34816
v_mfma_f32_16x16x32_bf16 v[196:199], v[100:103], v[56:59], v[196:199]
v_mfma_f32_16x16x32_bf16 v[200:203], v[104:107], v[56:59], v[200:203]
v_mfma_f32_16x16x32_bf16 v[204:207], v[108:111], v[56:59], v[204:207]
s_waitcnt lgkmcnt(0)
s_barrier
v_mfma_f32_16x16x32_bf16 v[208:211], v[96:99], v[60:63], v[208:211]
s_cbranch_scc1 L24
s_nop 0
ds_read_b64_tr_b16 v[92:93], v8 offset:96
ds_read_b64_tr_b16 v[94:95], v8 offset:3936
L24:
v_mfma_f32_16x16x32_bf16 v[212:215], v[100:103], v[60:63], v[212:215]
ds_read_b64_tr_b16 v[80:81], v8 offset:0
v_mfma_f32_16x16x32_bf16 v[216:219], v[104:107], v[60:63], v[216:219]
ds_read_b64_tr_b16 v[82:83], v8 offset:3840
v_mfma_f32_16x16x32_bf16 v[220:223], v[108:111], v[60:63], v[220:223]
ds_read_b128 v[56:59], v4 offset:36864
v_mfma_f32_16x16x32_bf16 v[224:227], v[96:99], v[64:67], v[224:227]
ds_read_b64_tr_b16 v[84:85], v8 offset:32
v_mfma_f32_16x16x32_bf16 v[228:231], v[100:103], v[64:67], v[228:231]
ds_read_b64_tr_b16 v[86:87], v8 offset:3872
v_mfma_f32_16x16x32_bf16 v[232:235], v[104:107], v[64:67], v[232:235]
ds_read_b64_tr_b16 v[88:89], v8 offset:64
v_mfma_f32_16x16x32_bf16 v[236:239], v[108:111], v[64:67], v[236:239]
ds_read_b128 v[60:63], v4 offset:38912
v_mfma_f32_16x16x32_bf16 v[240:243], v[96:99], v[68:71], v[240:243]
ds_read_b64_tr_b16 v[90:91], v8 offset:3904
v_mfma_f32_16x16x32_bf16 v[244:247], v[100:103], v[68:71], v[244:247]
ds_read_b128 v[64:67], v4 offset:40960
v_mfma_f32_16x16x32_bf16 v[248:251], v[104:107], v[68:71], v[248:251]
v_mfma_f32_16x16x32_bf16 v[252:255], v[108:111], v[68:71], v[252:255]
s_waitcnt lgkmcnt(1)
s_nop 0
v_mfma_f32_16x16x32_bf16 v[112:115], v[80:83], v[56:59], v[112:115]
ds_read_b128 v[68:71], v4 offset:43008
v_mfma_f32_16x16x32_bf16 v[116:119], v[84:87], v[56:59], v[116:119]
v_mfma_f32_16x16x32_bf16 v[120:123], v[88:91], v[56:59], v[120:123]
v_mfma_f32_16x16x32_bf16 v[124:127], v[92:95], v[56:59], v[124:127]
v_mfma_f32_16x16x32_bf16 v[128:131], v[80:83], v[60:63], v[128:131]
ds_read_b128 v[56:59], v4 offset:45056
v_mfma_f32_16x16x32_bf16 v[132:135], v[84:87], v[60:63], v[132:135]
v_mfma_f32_16x16x32_bf16 v[136:139], v[88:91], v[60:63], v[136:139]
v_mfma_f32_16x16x32_bf16 v[140:143], v[92:95], v[60:63], v[140:143]
s_waitcnt lgkmcnt(2)
s_nop 0
v_mfma_f32_16x16x32_bf16 v[144:147], v[80:83], v[64:67], v[144:147]
ds_read_b128 v[60:63], v4 offset:47104
v_mfma_f32_16x16x32_bf16 v[148:151], v[84:87], v[64:67], v[148:151]
v_mfma_f32_16x16x32_bf16 v[152:155], v[88:91], v[64:67], v[152:155]
v_mfma_f32_16x16x32_bf16 v[156:159], v[92:95], v[64:67], v[156:159]
s_waitcnt lgkmcnt(2)
s_nop 0
v_mfma_f32_16x16x32_bf16 v[160:163], v[80:83], v[68:71], v[160:163]
ds_read_b128 v[64:67], v4 offset:49152
v_mfma_f32_16x16x32_bf16 v[164:167], v[84:87], v[68:71], v[164:167]
v_mfma_f32_16x16x32_bf16 v[168:171], v[88:91], v[68:71], v[168:171]
v_mfma_f32_16x16x32_bf16 v[172:175], v[92:95], v[68:71], v[172:175]
s_waitcnt lgkmcnt(2)
s_nop 0
v_mfma_f32_16x16x32_bf16 v[176:179], v[80:83], v[56:59], v[176:179]
ds_read_b128 v[68:71], v4 offset:51200
v_mfma_f32_16x16x32_bf16 v[180:183], v[84:87], v[56:59], v[180:183]
v_mfma_f32_16x16x32_bf16 v[184:187], v[88:91], v[56:59], v[184:187]
v_mfma_f32_16x16x32_bf16 v[188:191], v[92:95], v[56:59], v[188:191]
s_waitcnt lgkmcnt(2)
s_nop 0
v_mfma_f32_16x16x32_bf16 v[192:195], v[80:83], v[60:63], v[192:195]
ds_read_b128 v[56:59], v4 offset:53248
v_mfma_f32_16x16x32_bf16 v[196:199], v[84:87], v[60:63], v[196:199]
v_mfma_f32_16x16x32_bf16 v[200:203], v[88:91], v[60:63], v[200:203]
v_mfma_f32_16x16x32_bf16 v[204:207], v[92:95], v[60:63], v[204:207]
s_waitcnt lgkmcnt(0)
s_barrier
v_mfma_f32_16x16x32_bf16 v[208:211], v[80:83], v[64:67], v[208:211]
s_cbranch_scc1 L25
s_nop 0
ds_read_b64_tr_b16 v[108:109], v8 offset:15456
ds_read_b64_tr_b16 v[110:111], v8 offset:19296
L25:
v_mfma_f32_16x16x32_bf16 v[212:215], v[84:87], v[64:67], v[212:215]
ds_read_b64_tr_b16 v[96:97], v8 offset:15360
v_mfma_f32_16x16x32_bf16 v[216:219], v[88:91], v[64:67], v[216:219]
ds_read_b64_tr_b16 v[98:99], v8 offset:19200
v_mfma_f32_16x16x32_bf16 v[220:223], v[92:95], v[64:67], v[220:223]
ds_read_b128 v[60:63], v5 offset:36864
v_mfma_f32_16x16x32_bf16 v[224:227], v[80:83], v[68:71], v[224:227]
ds_read_b64_tr_b16 v[100:101], v8 offset:15392
v_mfma_f32_16x16x32_bf16 v[228:231], v[84:87], v[68:71], v[228:231]
ds_read_b64_tr_b16 v[102:103], v8 offset:19232
v_mfma_f32_16x16x32_bf16 v[232:235], v[88:91], v[68:71], v[232:235]
ds_read_b64_tr_b16 v[104:105], v8 offset:15424
v_mfma_f32_16x16x32_bf16 v[236:239], v[92:95], v[68:71], v[236:239]
ds_read_b128 v[64:67], v5 offset:38912
v_mfma_f32_16x16x32_bf16 v[240:243], v[80:83], v[56:59], v[240:243]
ds_read_b64_tr_b16 v[106:107], v8 offset:19264
v_mfma_f32_16x16x32_bf16 v[244:247], v[84:87], v[56:59], v[244:247]
ds_read_b128 v[68:71], v5 offset:40960
v_mfma_f32_16x16x32_bf16 v[248:251], v[88:91], v[56:59], v[248:251]
v_mfma_f32_16x16x32_bf16 v[252:255], v[92:95], v[56:59], v[252:255]
s_waitcnt lgkmcnt(1)
s_nop 0
v_mfma_f32_16x16x32_bf16 v[112:115], v[96:99], v[60:63], v[112:115]
ds_read_b128 v[56:59], v5 offset:43008
v_mfma_f32_16x16x32_bf16 v[116:119], v[100:103], v[60:63], v[116:119]
v_mfma_f32_16x16x32_bf16 v[120:123], v[104:107], v[60:63], v[120:123]
v_mfma_f32_16x16x32_bf16 v[124:127], v[108:111], v[60:63], v[124:127]
v_mfma_f32_16x16x32_bf16 v[128:131], v[96:99], v[64:67], v[128:131]
ds_read_b128 v[60:63], v5 offset:45056
v_mfma_f32_16x16x32_bf16 v[132:135], v[100:103], v[64:67], v[132:135]
v_mfma_f32_16x16x32_bf16 v[136:139], v[104:107], v[64:67], v[136:139]
v_mfma_f32_16x16x32_bf16 v[140:143], v[108:111], v[64:67], v[140:143]
s_waitcnt lgkmcnt(2)
s_nop 0
v_mfma_f32_16x16x32_bf16 v[144:147], v[96:99], v[68:71], v[144:147]
ds_read_b128 v[64:67], v5 offset:47104
v_mfma_f32_16x16x32_bf16 v[148:151], v[100:103], v[68:71], v[148:151]
v_mfma_f32_16x16x32_bf16 v[152:155], v[104:107], v[68:71], v[152:155]
v_mfma_f32_16x16x32_bf16 v[156:159], v[108:111], v[68:71], v[156:159]
s_waitcnt lgkmcnt(2)
s_nop 0
v_mfma_f32_16x16x32_bf16 v[160:163], v[96:99], v[56:59], v[160:163]
ds_read_b128 v[68:71], v5 offset:49152
v_mfma_f32_16x16x32_bf16 v[164:167], v[100:103], v[56:59], v[164:167]
v_mfma_f32_16x16x32_bf16 v[168:171], v[104:107], v[56:59], v[168:171]
v_mfma_f32_16x16x32_bf16 v[172:175], v[108:111], v[56:59], v[172:175]
s_waitcnt lgkmcnt(2)
s_nop 0
v_mfma_f32_16x16x32_bf16 v[176:179], v[96:99], v[60:63], v[176:179]
ds_read_b128 v[56:59], v5 offset:51200
v_mfma_f32_16x16x32_bf16 v[180:183], v[100:103], v[60:63], v[180:183]
v_mfma_f32_16x16x32_bf16 v[184:187], v[104:107], v[60:63], v[184:187]
v_mfma_f32_16x16x32_bf16 v[188:191], v[108:111], v[60:63], v[188:191]
s_waitcnt lgkmcnt(2)
s_nop 0
v_mfma_f32_16x16x32_bf16 v[192:195], v[96:99], v[64:67], v[192:195]
ds_read_b128 v[60:63], v5 offset:53248
v_mfma_f32_16x16x32_bf16 v[196:199], v[100:103], v[64:67], v[196:199]
v_mfma_f32_16x16x32_bf16 v[200:203], v[104:107], v[64:67], v[200:203]
v_mfma_f32_16x16x32_bf16 v[204:207], v[108:111], v[64:67], v[204:207]
s_waitcnt lgkmcnt(0)
s_barrier
v_mfma_f32_16x16x32_bf16 v[208:211], v[96:99], v[68:71], v[208:211]
s_cbranch_scc1 L26
s_nop 0
ds_read_b64_tr_b16 v[92:93], v8 offset:30816
ds_read_b64_tr_b16 v[94:95], v8 offset:34656
L26:
v_mfma_f32_16x16x32_bf16 v[212:215], v[100:103], v[68:71], v[212:215]
ds_read_b64_tr_b16 v[80:81], v8 offset:30720
v_mfma_f32_16x16x32_bf16 v[216:219], v[104:107], v[68:71], v[216:219]
ds_read_b64_tr_b16 v[82:83], v8 offset:34560
v_mfma_f32_16x16x32_bf16 v[220:223], v[108:111], v[68:71], v[220:223]
ds_read_b128 v[64:67], v4 offset:0
v_mfma_f32_16x16x32_bf16 v[224:227], v[96:99], v[56:59], v[224:227]
ds_read_b64_tr_b16 v[84:85], v8 offset:30752
v_mfma_f32_16x16x32_bf16 v[228:231], v[100:103], v[56:59], v[228:231]
ds_read_b64_tr_b16 v[86:87], v8 offset:34592
v_mfma_f32_16x16x32_bf16 v[232:235], v[104:107], v[56:59], v[232:235]
ds_read_b64_tr_b16 v[88:89], v8 offset:30784
v_mfma_f32_16x16x32_bf16 v[236:239], v[108:111], v[56:59], v[236:239]
ds_read_b128 v[68:71], v4 offset:2048
v_mfma_f32_16x16x32_bf16 v[240:243], v[96:99], v[60:63], v[240:243]
ds_read_b64_tr_b16 v[90:91], v8 offset:34624
v_mfma_f32_16x16x32_bf16 v[244:247], v[100:103], v[60:63], v[244:247]
ds_read_b128 v[56:59], v4 offset:4096
v_mfma_f32_16x16x32_bf16 v[248:251], v[104:107], v[60:63], v[248:251]
v_mfma_f32_16x16x32_bf16 v[252:255], v[108:111], v[60:63], v[252:255]
s_waitcnt lgkmcnt(1)
s_nop 0
v_mfma_f32_16x16x32_bf16 v[112:115], v[80:83], v[64:67], v[112:115]
ds_read_b128 v[60:63], v4 offset:6144
v_mfma_f32_16x16x32_bf16 v[116:119], v[84:87], v[64:67], v[116:119]
v_mfma_f32_16x16x32_bf16 v[120:123], v[88:91], v[64:67], v[120:123]
v_mfma_f32_16x16x32_bf16 v[124:127], v[92:95], v[64:67], v[124:127]
v_mfma_f32_16x16x32_bf16 v[128:131], v[80:83], v[68:71], v[128:131]
ds_read_b128 v[64:67], v4 offset:8192
v_mfma_f32_16x16x32_bf16 v[132:135], v[84:87], v[68:71], v[132:135]
v_mfma_f32_16x16x32_bf16 v[136:139], v[88:91], v[68:71], v[136:139]
v_mfma_f32_16x16x32_bf16 v[140:143], v[92:95], v[68:71], v[140:143]
s_waitcnt lgkmcnt(2)
s_nop 0
v_mfma_f32_16x16x32_bf16 v[144:147], v[80:83], v[56:59], v[144:147]
ds_read_b128 v[68:71], v4 offset:10240
v_mfma_f32_16x16x32_bf16 v[148:151], v[84:87], v[56:59], v[148:151]
v_mfma_f32_16x16x32_bf16 v[152:155], v[88:91], v[56:59], v[152:155]
v_mfma_f32_16x16x32_bf16 v[156:159], v[92:95], v[56:59], v[156:159]
s_waitcnt lgkmcnt(2)
s_nop 0
v_mfma_f32_16x16x32_bf16 v[160:163], v[80:83], v[60:63], v[160:163]
ds_read_b128 v[56:59], v4 offset:12288
v_mfma_f32_16x16x32_bf16 v[164:167], v[84:87], v[60:63], v[164:167]
v_mfma_f32_16x16x32_bf16 v[168:171], v[88:91], v[60:63], v[168:171]
v_mfma_f32_16x16x32_bf16 v[172:175], v[92:95], v[60:63], v[172:175]
s_waitcnt lgkmcnt(2)
s_nop 0
v_mfma_f32_16x16x32_bf16 v[176:179], v[80:83], v[64:67], v[176:179]
ds_read_b128 v[60:63], v4 offset:14336
v_mfma_f32_16x16x32_bf16 v[180:183], v[84:87], v[64:67], v[180:183]
v_mfma_f32_16x16x32_bf16 v[184:187], v[88:91], v[64:67], v[184:187]
v_mfma_f32_16x16x32_bf16 v[188:191], v[92:95], v[64:67], v[188:191]
s_waitcnt lgkmcnt(2)
s_nop 0
v_mfma_f32_16x16x32_bf16 v[192:195], v[80:83], v[68:71], v[192:195]
ds_read_b128 v[64:67], v4 offset:16384
v_mfma_f32_16x16x32_bf16 v[196:199], v[84:87], v[68:71], v[196:199]
v_mfma_f32_16x16x32_bf16 v[200:203], v[88:91], v[68:71], v[200:203]
v_mfma_f32_16x16x32_bf16 v[204:207], v[92:95], v[68:71], v[204:207]
s_waitcnt lgkmcnt(0)
s_barrier
v_mfma_f32_16x16x32_bf16 v[208:211], v[80:83], v[56:59], v[208:211]
s_cbranch_scc1 L27
s_nop 0
ds_read_b64_tr_b16 v[108:109], v8 offset:46176
ds_read_b64_tr_b16 v[110:111], v8 offset:50016
L27:
v_mfma_f32_16x16x32_bf16 v[212:215], v[84:87], v[56:59], v[212:215]
ds_read_b64_tr_b16 v[96:97], v8 offset:46080
v_mfma_f32_16x16x32_bf16 v[216:219], v[88:91], v[56:59], v[216:219]
ds_read_b64_tr_b16 v[98:99], v8 offset:49920
v_mfma_f32_16x16x32_bf16 v[220:223], v[92:95], v[56:59], v[220:223]
ds_read_b128 v[68:71], v5 offset:0
v_mfma_f32_16x16x32_bf16 v[224:227], v[80:83], v[60:63], v[224:227]
ds_read_b64_tr_b16 v[100:101], v8 offset:46112
v_mfma_f32_16x16x32_bf16 v[228:231], v[84:87], v[60:63], v[228:231]
ds_read_b64_tr_b16 v[102:103], v8 offset:49952
v_mfma_f32_16x16x32_bf16 v[232:235], v[88:91], v[60:63], v[232:235]
ds_read_b64_tr_b16 v[104:105], v8 offset:46144
v_mfma_f32_16x16x32_bf16 v[236:239], v[92:95], v[60:63], v[236:239]
ds_read_b128 v[56:59], v5 offset:2048
v_mfma_f32_16x16x32_bf16 v[240:243], v[80:83], v[64:67], v[240:243]
ds_read_b64_tr_b16 v[106:107], v8 offset:49984
v_mfma_f32_16x16x32_bf16 v[244:247], v[84:87], v[64:67], v[244:247]
ds_read_b128 v[60:63], v5 offset:4096
v_mfma_f32_16x16x32_bf16 v[248:251], v[88:91], v[64:67], v[248:251]
v_mfma_f32_16x16x32_bf16 v[252:255], v[92:95], v[64:67], v[252:255]
s_waitcnt lgkmcnt(1)
s_nop 0
v_mfma_f32_16x16x32_bf16 v[112:115], v[96:99], v[68:71], v[112:115]
ds_read2_b32 v[36:37], v19 offset0:0 offset1:0
v_mfma_f32_16x16x32_bf16 v[116:119], v[100:103], v[68:71], v[116:119]
ds_read2_b32 v[38:39], v19 offset0:32 offset1:32
v_mfma_f32_16x16x32_bf16 v[120:123], v[104:107], v[68:71], v[120:123]
ds_read2_b32 v[40:41], v19 offset0:64 offset1:64
v_mfma_f32_16x16x32_bf16 v[124:127], v[108:111], v[68:71], v[124:127]
ds_read_b128 v[64:67], v5 offset:6144
v_mfma_f32_16x16x32_bf16 v[128:131], v[96:99], v[56:59], v[128:131]
ds_read2_b32 v[42:43], v19 offset0:96 offset1:96
v_mfma_f32_16x16x32_bf16 v[132:135], v[100:103], v[56:59], v[132:135]
ds_read2_b32 v[44:45], v19 offset0:128 offset1:128
v_mfma_f32_16x16x32_bf16 v[136:139], v[104:107], v[56:59], v[136:139]
ds_read2_b32 v[46:47], v19 offset0:160 offset1:160
v_mfma_f32_16x16x32_bf16 v[140:143], v[108:111], v[56:59], v[140:143]
ds_read_b128 v[68:71], v5 offset:8192
s_waitcnt lgkmcnt(8)
s_nop 0
v_mfma_f32_16x16x32_bf16 v[144:147], v[96:99], v[60:63], v[144:147]
ds_read2_b32 v[48:49], v19 offset0:192 offset1:192
v_mfma_f32_16x16x32_bf16 v[148:151], v[100:103], v[60:63], v[148:151]
ds_read2_b32 v[50:51], v19 offset0:224 offset1:224
v_mfma_f32_16x16x32_bf16 v[152:155], v[104:107], v[60:63], v[152:155]
ds_read_b32 v52, v19 offset:1024
v_mfma_f32_16x16x32_bf16 v[156:159], v[108:111], v[60:63], v[156:159]
ds_read_b128 v[56:59], v5 offset:10240
s_waitcnt lgkmcnt(8)
s_nop 0
v_mfma_f32_16x16x32_bf16 v[160:163], v[96:99], v[64:67], v[160:163]
ds_read_b32 v53, v19 offset:1024
v_mfma_f32_16x16x32_bf16 v[164:167], v[100:103], v[64:67], v[164:167]
ds_read_b32 v11, v9 offset:132
v_mfma_f32_16x16x32_bf16 v[168:171], v[104:107], v[64:67], v[168:171]
ds_read_b32 v12, v10 offset:4
v_mfma_f32_16x16x32_bf16 v[172:175], v[108:111], v[64:67], v[172:175]
ds_read_b128 v[60:63], v5 offset:12288
s_waitcnt lgkmcnt(8)
s_nop 0
v_mfma_f32_16x16x32_bf16 v[176:179], v[96:99], v[68:71], v[176:179]
ds_read_b32 v13, v10 offset:20
v_mfma_f32_16x16x32_bf16 v[180:183], v[100:103], v[68:71], v[180:183]
ds_read_b32 v14, v10 offset:36
v_mfma_f32_16x16x32_bf16 v[184:187], v[104:107], v[68:71], v[184:187]
ds_read_b32 v15, v10 offset:52
v_mfma_f32_16x16x32_bf16 v[188:191], v[108:111], v[68:71], v[188:191]
ds_read_b128 v[64:67], v5 offset:14336
s_waitcnt lgkmcnt(8)
s_nop 0
v_mfma_f32_16x16x32_bf16 v[192:195], v[96:99], v[56:59], v[192:195]
ds_read_b64 v[34:35], v1
v_mfma_f32_16x16x32_bf16 v[196:199], v[100:103], v[56:59], v[196:199]
ds_read_b128 v[68:71], v5 offset:16384
v_mfma_f32_16x16x32_bf16 v[200:203], v[104:107], v[56:59], v[200:203]
v_mfma_f32_16x16x32_bf16 v[204:207], v[108:111], v[56:59], v[204:207]
s_waitcnt lgkmcnt(0)
s_barrier
v_mfma_f32_16x16x32_bf16 v[208:211], v[96:99], v[60:63], v[208:211]
v_mfma_f32_16x16x32_bf16 v[212:215], v[100:103], v[60:63], v[212:215]
v_mfma_f32_16x16x32_bf16 v[216:219], v[104:107], v[60:63], v[216:219]
v_mfma_f32_16x16x32_bf16 v[220:223], v[108:111], v[60:63], v[220:223]
v_mfma_f32_16x16x32_bf16 v[224:227], v[96:99], v[64:67], v[224:227]
v_mfma_f32_16x16x32_bf16 v[228:231], v[100:103], v[64:67], v[228:231]
v_mfma_f32_16x16x32_bf16 v[232:235], v[104:107], v[64:67], v[232:235]
v_mfma_f32_16x16x32_bf16 v[236:239], v[108:111], v[64:67], v[236:239]
v_mfma_f32_16x16x32_bf16 v[240:243], v[96:99], v[68:71], v[240:243]
v_mfma_f32_16x16x32_bf16 v[244:247], v[100:103], v[68:71], v[244:247]
v_mfma_f32_16x16x32_bf16 v[248:251], v[104:107], v[68:71], v[248:251]
v_mfma_f32_16x16x32_bf16 v[252:255], v[108:111], v[68:71], v[252:255]
Q_FOLD:
v_mov_b32_dpp v80, v112 row_newbcast:0 row_mask:0xf bank_mask:0xf
v_mov_b32_dpp v81, v113 row_newbcast:0 row_mask:0xf bank_mask:0xf
v_mov_b32_dpp v82, v114 row_newbcast:0 row_mask:0xf bank_mask:0xf
v_mov_b32_dpp v83, v115 row_newbcast:0 row_mask:0xf bank_mask:0xf
v_mov_b32_dpp v84, v116 row_newbcast:0 row_mask:0xf bank_mask:0xf
v_mov_b32_dpp v85, v117 row_newbcast:0 row_mask:0xf bank_mask:0xf
v_mov_b32_dpp v86, v118 row_newbcast:0 row_mask:0xf bank_mask:0xf
v_mov_b32_dpp v87, v119 row_newbcast:0 row_mask:0xf bank_mask:0xf
v_mov_b32_dpp v88, v120 row_newbcast:0 row_mask:0xf bank_mask:0xf
v_mov_b32_dpp v89, v121 row_newbcast:0 row_mask:0xf bank_mask:0xf
v_mov_b32_dpp v90, v122 row_newbcast:0 row_mask:0xf bank_mask:0xf
v_mov_b32_dpp v91, v123 row_newbcast:0 row_mask:0xf bank_mask:0xf
v_mov_b32_dpp v92, v124 row_newbcast:0 row_mask:0xf bank_mask:0xf
v_mov_b32_dpp v93, v125 row_newbcast:0 row_mask:0xf bank_mask:0xf
v_mov_b32_dpp v94, v126 row_newbcast:0 row_mask:0xf bank_mask:0xf
v_mov_b32_dpp v95, v127 row_newbcast:0 row_mask:0xf bank_mask:0xf
s_waitcnt lgkmcnt(0)
s_nop 0
v_pk_fma_f32 v[112:113], v[36:37], v[80:81], v[112:113]
v_pk_fma_f32 v[114:115], v[36:37], v[82:83], v[114:115]
v_pk_fma_f32 v[116:117], v[36:37], v[84:85], v[116:117]
v_pk_fma_f32 v[118:119], v[36:37], v[86:87], v[118:119]
v_pk_fma_f32 v[120:121], v[36:37], v[88:89], v[120:121]
v_pk_fma_f32 v[122:123], v[36:37], v[90:91], v[122:123]
v_pk_fma_f32 v[124:125], v[36:37], v[92:93], v[124:125]
v_pk_fma_f32 v[126:127], v[36:37], v[94:95], v[126:127]
v_cvt_pk_bf16_f32 v112, v112, v113
v_cvt_pk_bf16_f32 v113, v114, v115
ds_write_b64 v17, v[112:113] offset:0
v_cvt_pk_bf16_f32 v116, v116, v117
v_cvt_pk_bf16_f32 v117, v118, v119
ds_write_b64 v17, v[116:117] offset:32
v_cvt_pk_bf16_f32 v120, v120, v121
v_cvt_pk_bf16_f32 v121, v122, v123
ds_write_b64 v17, v[120:121] offset:64
v_cvt_pk_bf16_f32 v124, v124, v125
v_cvt_pk_bf16_f32 v125, v126, v127
ds_write_b64 v17, v[124:125] offset:96
v_pk_fma_f32 v[128:129], v[38:39], v[80:81], v[128:129]
v_pk_fma_f32 v[130:131], v[38:39], v[82:83], v[130:131]
v_pk_fma_f32 v[132:133], v[38:39], v[84:85], v[132:133]
v_pk_fma_f32 v[134:135], v[38:39], v[86:87], v[134:135]
v_pk_fma_f32 v[136:137], v[38:39], v[88:89], v[136:137]
v_pk_fma_f32 v[138:139], v[38:39], v[90:91], v[138:139]
v_pk_fma_f32 v[140:141], v[38:39], v[92:93], v[140:141]
v_pk_fma_f32 v[142:143], v[38:39], v[94:95], v[142:143]
v_cvt_pk_bf16_f32 v128, v128, v129
v_cvt_pk_bf16_f32 v129, v130, v131
ds_write_b64 v17, v[128:129] offset:8320
v_cvt_pk_bf16_f32 v132, v132, v133
v_cvt_pk_bf16_f32 v133, v134, v135
ds_write_b64 v17, v[132:133] offset:8352
v_cvt_pk_bf16_f32 v136, v136, v137
v_cvt_pk_bf16_f32 v137, v138, v139
ds_write_b64 v17, v[136:137] offset:8384
v_cvt_pk_bf16_f32 v140, v140, v141
v_cvt_pk_bf16_f32 v141, v142, v143
ds_write_b64 v17, v[140:141] offset:8416
v_pk_fma_f32 v[144:145], v[40:41], v[80:81], v[144:145]
v_pk_fma_f32 v[146:147], v[40:41], v[82:83], v[146:147]
v_pk_fma_f32 v[148:149], v[40:41], v[84:85], v[148:149]
v_pk_fma_f32 v[150:151], v[40:41], v[86:87], v[150:151]
v_pk_fma_f32 v[152:153], v[40:41], v[88:89], v[152:153]
v_pk_fma_f32 v[154:155], v[40:41], v[90:91], v[154:155]
v_pk_fma_f32 v[156:157], v[40:41], v[92:93], v[156:157]
v_pk_fma_f32 v[158:159], v[40:41], v[94:95], v[158:159]
v_cvt_pk_bf16_f32 v144, v144, v145
v_cvt_pk_bf16_f32 v145, v146, v147
ds_write_b64 v17, v[144:145] offset:16640
v_cvt_pk_bf16_f32 v148, v148, v149
v_cvt_pk_bf16_f32 v149, v150, v151
ds_write_b64 v17, v[148:149] offset:16672
v_cvt_pk_bf16_f32 v152, v152, v153
v_cvt_pk_bf16_f32 v153, v154, v155
ds_write_b64 v17, v[152:153] offset:16704
v_cvt_pk_bf16_f32 v156, v156, v157
v_cvt_pk_bf16_f32 v157, v158, v159
ds_write_b64 v17, v[156:157] offset:16736
v_pk_fma_f32 v[160:161], v[42:43], v[80:81], v[160:161]
v_pk_fma_f32 v[162:163], v[42:43], v[82:83], v[162:163]
v_pk_fma_f32 v[164:165], v[42:43], v[84:85], v[164:165]
v_pk_fma_f32 v[166:167], v[42:43], v[86:87], v[166:167]
v_pk_fma_f32 v[168:169], v[42:43], v[88:89], v[168:169]
v_pk_fma_f32 v[170:171], v[42:43], v[90:91], v[170:171]
v_pk_fma_f32 v[172:173], v[42:43], v[92:93], v[172:173]
v_pk_fma_f32 v[174:175], v[42:43], v[94:95], v[174:175]
v_cvt_pk_bf16_f32 v160, v160, v161
v_cvt_pk_bf16_f32 v161, v162, v163
ds_write_b64 v17, v[160:161] offset:24960
v_cvt_pk_bf16_f32 v164, v164, v165
v_cvt_pk_bf16_f32 v165, v166, v167
ds_write_b64 v17, v[164:165] offset:24992
v_cvt_pk_bf16_f32 v168, v168, v169
v_cvt_pk_bf16_f32 v169, v170, v171
ds_write_b64 v17, v[168:169] offset:25024
v_cvt_pk_bf16_f32 v172, v172, v173
v_cvt_pk_bf16_f32 v173, v174, v175
ds_write_b64 v17, v[172:173] offset:25056
v_pk_fma_f32 v[176:177], v[44:45], v[80:81], v[176:177]
v_pk_fma_f32 v[178:179], v[44:45], v[82:83], v[178:179]
v_pk_fma_f32 v[180:181], v[44:45], v[84:85], v[180:181]
v_pk_fma_f32 v[182:183], v[44:45], v[86:87], v[182:183]
v_pk_fma_f32 v[184:185], v[44:45], v[88:89], v[184:185]
v_pk_fma_f32 v[186:187], v[44:45], v[90:91], v[186:187]
v_pk_fma_f32 v[188:189], v[44:45], v[92:93], v[188:189]
v_pk_fma_f32 v[190:191], v[44:45], v[94:95], v[190:191]
v_cvt_pk_bf16_f32 v176, v176, v177
v_cvt_pk_bf16_f32 v177, v178, v179
ds_write_b64 v17, v[176:177] offset:33280
v_cvt_pk_bf16_f32 v180, v180, v181
v_cvt_pk_bf16_f32 v181, v182, v183
ds_write_b64 v17, v[180:181] offset:33312
v_cvt_pk_bf16_f32 v184, v184, v185
v_cvt_pk_bf16_f32 v185, v186, v187
ds_write_b64 v17, v[184:185] offset:33344
v_cvt_pk_bf16_f32 v188, v188, v189
v_cvt_pk_bf16_f32 v189, v190, v191
ds_write_b64 v17, v[188:189] offset:33376
v_pk_fma_f32 v[192:193], v[46:47], v[80:81], v[192:193]
v_pk_fma_f32 v[194:195], v[46:47], v[82:83], v[194:195]
v_pk_fma_f32 v[196:197], v[46:47], v[84:85], v[196:197]
v_pk_fma_f32 v[198:199], v[46:47], v[86:87], v[198:199]
v_pk_fma_f32 v[200:201], v[46:47], v[88:89], v[200:201]
v_pk_fma_f32 v[202:203], v[46:47], v[90:91], v[202:203]
v_pk_fma_f32 v[204:205], v[46:47], v[92:93], v[204:205]
v_pk_fma_f32 v[206:207], v[46:47], v[94:95], v[206:207]
s_waitcnt lgkmcnt(0)
s_barrier
v_cvt_pk_bf16_f32 v192, v192, v193
v_cvt_pk_bf16_f32 v193, v194, v195
ds_write_b64 v17, v[192:193] offset:41600
v_cvt_pk_bf16_f32 v196, v196, v197
v_cvt_pk_bf16_f32 v197, v198, v199
ds_write_b64 v17, v[196:197] offset:41632
v_cvt_pk_bf16_f32 v200, v200, v201
v_cvt_pk_bf16_f32 v201, v202, v203
ds_write_b64 v17, v[200:201] offset:41664
v_cvt_pk_bf16_f32 v204, v204, v205
v_cvt_pk_bf16_f32 v205, v206, v207
ds_write_b64 v17, v[204:205] offset:41696
v_pk_fma_f32 v[208:209], v[48:49], v[80:81], v[208:209]
v_pk_fma_f32 v[210:211], v[48:49], v[82:83], v[210:211]
v_pk_fma_f32 v[212:213], v[48:49], v[84:85], v[212:213]
v_pk_fma_f32 v[214:215], v[48:49], v[86:87], v[214:215]
v_pk_fma_f32 v[216:217], v[48:49], v[88:89], v[216:217]
v_pk_fma_f32 v[218:219], v[48:49], v[90:91], v[218:219]
v_pk_fma_f32 v[220:221], v[48:49], v[92:93], v[220:221]
v_pk_fma_f32 v[222:223], v[48:49], v[94:95], v[222:223]
v_cvt_pk_bf16_f32 v208, v208, v209
v_cvt_pk_bf16_f32 v209, v210, v211
ds_write_b64 v17, v[208:209] offset:49920
v_cvt_pk_bf16_f32 v212, v212, v213
v_cvt_pk_bf16_f32 v213, v214, v215
ds_write_b64 v17, v[212:213] offset:49952
v_cvt_pk_bf16_f32 v216, v216, v217
v_cvt_pk_bf16_f32 v217, v218, v219
ds_write_b64 v17, v[216:217] offset:49984
v_cvt_pk_bf16_f32 v220, v220, v221
v_cvt_pk_bf16_f32 v221, v222, v223
ds_write_b64 v17, v[220:221] offset:50016
v_pk_fma_f32 v[224:225], v[50:51], v[80:81], v[224:225]
v_pk_fma_f32 v[226:227], v[50:51], v[82:83], v[226:227]
v_pk_fma_f32 v[228:229], v[50:51], v[84:85], v[228:229]
v_pk_fma_f32 v[230:231], v[50:51], v[86:87], v[230:231]
v_pk_fma_f32 v[232:233], v[50:51], v[88:89], v[232:233]
v_pk_fma_f32 v[234:235], v[50:51], v[90:91], v[234:235]
v_pk_fma_f32 v[236:237], v[50:51], v[92:93], v[236:237]
v_pk_fma_f32 v[238:239], v[50:51], v[94:95], v[238:239]
v_cvt_pk_bf16_f32 v224, v224, v225
v_cvt_pk_bf16_f32 v225, v226, v227
ds_write_b64 v17, v[224:225] offset:58240
v_cvt_pk_bf16_f32 v228, v228, v229
v_cvt_pk_bf16_f32 v229, v230, v231
ds_write_b64 v17, v[228:229] offset:58272
v_cvt_pk_bf16_f32 v232, v232, v233
v_cvt_pk_bf16_f32 v233, v234, v235
ds_write_b64 v17, v[232:233] offset:58304
v_cvt_pk_bf16_f32 v236, v236, v237
v_cvt_pk_bf16_f32 v237, v238, v239
ds_write_b64 v17, v[236:237] offset:58336
v_pk_fma_f32 v[240:241], v[52:53], v[80:81], v[240:241]
v_pk_fma_f32 v[242:243], v[52:53], v[82:83], v[242:243]
v_pk_fma_f32 v[244:245], v[52:53], v[84:85], v[244:245]
v_pk_fma_f32 v[246:247], v[52:53], v[86:87], v[246:247]
v_pk_fma_f32 v[248:249], v[52:53], v[88:89], v[248:249]
v_pk_fma_f32 v[250:251], v[52:53], v[90:91], v[250:251]
v_pk_fma_f32 v[252:253], v[52:53], v[92:93], v[252:253]
v_pk_fma_f32 v[254:255], v[52:53], v[94:95], v[254:255]
v_cvt_pk_bf16_f32 v240, v240, v241
v_cvt_pk_bf16_f32 v241, v242, v243
ds_write_b64 v18, v[240:241] offset:0
v_cvt_pk_bf16_f32 v244, v244, v245
v_cvt_pk_bf16_f32 v245, v246, v247
ds_write_b64 v18, v[244:245] offset:32
v_cvt_pk_bf16_f32 v248, v248, v249
v_cvt_pk_bf16_f32 v249, v250, v251
ds_write_b64 v18, v[248:249] offset:64
v_cvt_pk_bf16_f32 v252, v252, v253
v_cvt_pk_bf16_f32 v253, v254, v255
ds_write_b64 v18, v[252:253] offset:96
v_readfirstlane_b32 s0, v34
v_readfirstlane_b32 s1, v35
v_add_u32 v18, 4096, v2
s_branch Q_ATT
.p2align 12
Q_L:
s_setprio 2
s_lshl2_add_u32 s60, s45, s49
s_mul_i32 s61, s60, 43
s_lshr_b32 s61, s61, 8
s_mul_i32 s62, s61, 6
s_sub_u32 s62, s60, s62
s_mul_i32 s54, s61, 24576
s_mul_i32 s63, s44, 384
s_add_u32 s54, s54, s63
s_sub_u32 s63, s62, 3
s_cselect_b32 s63, s62, s63
s_lshl_b32 s63, s63, 7
s_add_u32 s54, s54, s63
v_lshrrev_b32 v4, 3, v0
v_mul_u32_u24 v4, 3072, v4
v_and_b32 v5, 7, v0
v_lshl_add_u32 v48, v5, 4, v4
s_cmp_lt_u32 s60, 60
s_cselect_b32 s42, 1966080, 0
s_mov_b32 s43, 0x20000
s_cmp_lt_u32 s62, 3
s_waitcnt lgkmcnt(0)
s_cselect_b64 s[40:41], s[12:13], s[14:15]
buffer_load_dwordx4 v[208:211], v48, s[40:43], s54 offen
s_add_u32 s54, s54, 245760
buffer_load_dwordx4 v[212:215], v48, s[40:43], s54 offen
s_add_u32 s54, s54, 245760
buffer_load_dwordx4 v[216:219], v48, s[40:43], s54 offen
s_add_u32 s54, s54, 245760
s_mul_i32 s76, s44, 10
s_add_u32 s76, s76, s61
s_mul_i32 s76, s76, 1536
s_lshl_b32 s62, s62, 8
s_add_u32 s76, s76, s62
s_add_u32 s76, s76, 22020096
s_cmp_lt_u32 s60, 60
s_cselect_b32 s76, s76, 2147483648
s_lshl3_add_u32 s46, s45, s44
s_lshl1_add_u32 s46, s46, 1
v_lshlrev_b32 v2, 4, v0
v_lshlrev_b32 v3, 2, v0
s_mov_b32 s26, 2621440
s_mov_b32 s27, 0x20000
s_lshl_b32 s61, s45, 7
s_lshl3_add_u32 s61, s49, s61
v_lshrrev_b32 v4, 3, v0
v_add_u32 v4, s61, v4
v_mul_u32_u24 v4, 1280, v4
s_lshl_b32 s62, s3, 2
v_lshrrev_b32 v5, 4, v0
v_add_u32 v5, s62, v5
v_xor_b32 v5, v5, v0
v_and_b32 v5, 7, v5
v_lshl_add_u32 v12, v5, 4, v4
v_subrev_u32 v11, 20480, v12
s_mov_b32 s51, 0
s_lshl_b32 s53, s49, 10
s_mov_b64 s[56:57], 0
s_cmp_eq_u32 s3, 5
s_cselect_b64 s[56:57], -1, s[56:57]
s_cmp_eq_u32 s3, 4
s_cselect_b32 s56, 0xffffff00, s56
s_cselect_b32 s57, -1, s57
s_waitcnt lgkmcnt(0)
s_mov_b64 s[24:25], s[4:5]
s_add_u32 m0, s53, 61440
s_nop 0
s_mov_b64 exec, s[56:57]
s_cbranch_execz L28
buffer_load_dwordx4 v11, s[24:27], 0 offen offset:0 lds
L28:
s_mov_b64 exec, -1
s_add_u32 m0, s53, 63488
s_nop 0
buffer_load_dwordx4 v12, s[24:27], s51 offen lds
s_add_u32 s51, s51, 40960
s_add_u32 m0, s53, 67584
s_nop 0
buffer_load_dwordx4 v12, s[24:27], s51 offen lds
s_add_u32 s51, s51, 40960
s_add_u32 m0, s53, 71680
s_nop 0
buffer_load_dwordx4 v12, s[24:27], s51 offen lds
s_add_u32 s51, s51, 40960
s_add_u32 m0, s53, 75776
s_nop 0
buffer_load_dwordx4 v12, s[24:27], s51 offen lds
s_add_u32 s51, s51, 4294844544
s_mov_b64 s[28:29], s[6:7]
s_mov_b32 s30, 2457600
s_mov_b32 s31, 0x20000
s_lshl_b32 s61, s49, 8
s_mul_i32 s62, s44, 160
v_add_u32 v5, s61, v0
v_mul_u32_u24 v4, 2185, v5
v_lshrrev_b32 v4, 16, v4
v_mul_u32_u24 v6, 30, v4
v_sub_u32 v5, v5, v6
v_cmp_gt_u32 vcc, 32, v4
v_and_b32 v6, 19, v4
v_bfe_u32 v7, v4, 2, 1
v_lshl_add_u32 v6, v7, 3, v6
v_bfe_u32 v7, v4, 3, 1
v_lshl_add_u32 v6, v7, 2, v6
v_mul_u32_u24 v6, 3840, v6
v_lshl_add_u32 v6, v5, 4, v6
v_mul_u32_u24 v7, 26, v5
v_lshrrev_b32 v7, 8, v7
v_mul_u32_u24 v7, 1120, v7
v_add3_u32 v6, v6, v7, s62
v_mov_b32 v7, 2147483648
v_cndmask_b32 v13, v7, v6, vcc
v_add_u32 v5, s61, v0
v_add_u32 v5, 64, v5
v_mul_u32_u24 v4, 2185, v5
v_lshrrev_b32 v4, 16, v4
v_mul_u32_u24 v6, 30, v4
v_sub_u32 v5, v5, v6
v_cmp_gt_u32 vcc, 32, v4
v_and_b32 v6, 19, v4
v_bfe_u32 v7, v4, 2, 1
v_lshl_add_u32 v6, v7, 3, v6
v_bfe_u32 v7, v4, 3, 1
v_lshl_add_u32 v6, v7, 2, v6
v_mul_u32_u24 v6, 3840, v6
v_lshl_add_u32 v6, v5, 4, v6
v_mul_u32_u24 v7, 26, v5
v_lshrrev_b32 v7, 8, v7
v_mul_u32_u24 v7, 1120, v7
v_add3_u32 v6, v6, v7, s62
v_mov_b32 v7, 2147483648
v_cndmask_b32 v14, v7, v6, vcc
v_add_u32 v5, s61, v0
v_add_u32 v5, 128, v5
v_mul_u32_u24 v4, 2185, v5
v_lshrrev_b32 v4, 16, v4
v_mul_u32_u24 v6, 30, v4
v_sub_u32 v5, v5, v6
v_cmp_gt_u32 vcc, 32, v4
v_and_b32 v6, 19, v4
v_bfe_u32 v7, v4, 2, 1
v_lshl_add_u32 v6, v7, 3, v6
v_bfe_u32 v7, v4, 3, 1
v_lshl_add_u32 v6, v7, 2, v6
v_mul_u32_u24 v6, 3840, v6
v_lshl_add_u32 v6, v5, 4, v6
v_mul_u32_u24 v7, 26, v5
v_lshrrev_b32 v7, 8, v7
v_mul_u32_u24 v7, 1120, v7
v_add3_u32 v6, v6, v7, s62
v_mov_b32 v7, 2147483648
v_cndmask_b32 v15, v7, v6, vcc
v_add_u32 v5, s61, v0
v_add_u32 v5, 192, v5
v_mul_u32_u24 v4, 2185, v5
v_lshrrev_b32 v4, 16, v4
v_mul_u32_u24 v6, 30, v4
v_sub_u32 v5, v5, v6
v_cmp_gt_u32 vcc, 32, v4
v_and_b32 v6, 19, v4
v_bfe_u32 v7, v4, 2, 1
v_lshl_add_u32 v6, v7, 3, v6
v_bfe_u32 v7, v4, 3, 1
v_lshl_add_u32 v6, v7, 2, v6
v_mul_u32_u24 v6, 3840, v6
v_lshl_add_u32 v6, v5, 4, v6
v_mul_u32_u24 v7, 26, v5
v_lshrrev_b32 v7, 8, v7
v_mul_u32_u24 v7, 1120, v7
v_add3_u32 v6, v6, v7, s62
v_mov_b32 v7, 2147483648
v_cndmask_b32 v17, v7, v6, vcc
s_mov_b32 s50, 0
s_lshl_b32 s52, s49, 12
s_cmp_eq_u32 s3, 7
s_cselect_b32 s12, 0x30000, s52
s_add_u32 m0, s52, 0
s_nop 0
buffer_load_dwordx4 v13, s[28:31], s50 offen lds
s_add_u32 m0, s52, 1024
s_nop 0
buffer_load_dwordx4 v14, s[28:31], s50 offen lds
s_add_u32 m0, s52, 2048
s_nop 0
buffer_load_dwordx4 v15, s[28:31], s50 offen lds
s_add_u32 m0, s12, 3072
s_nop 0
buffer_load_dwordx4 v17, s[28:31], s50 offen lds
s_add_u32 s50, s50, 122880
v_add_u32 v18, 4096, v2
s_mov_b64 s[32:33], s[22:23]
s_mov_b32 s34, 33554432
s_mov_b32 s35, 0x20000
s_mov_b64 s[36:37], s[20:21]
s_mov_b32 s38, 256
s_mov_b32 s39, 0x20000
s_bfe_u32 s47, s2, 0x30004
s_lshr_b32 s77, s2, 3
s_xor_b32 s77, s77, s47
s_and_b32 s77, s77, 1
s_lshr_b32 s48, s2, 7
s_lshl1_add_u32 s48, s48, s77
s_lshr_b32 s77, s44, 1
s_lshl_b32 s77, s77, 3
s_add_u32 s47, s77, s47
s_and_b32 s77, s44, 1
s_lshl_b32 s77, s77, 2
s_add_u32 s48, s77, s48
s_mul_i32 s10, s48, 348160
s_add_u32 s10, s10, 16777216
s_mul_i32 s59, s49, 5120
s_add_u32 s11, s10, s59
s_lshl_b32 s55, s3, 2
s_lshr_b32 s55, 0x32104576, s55
s_and_b32 s55, s55, 7
s_mul_i32 s55, s55, 20480
s_lshl_b32 s77, s45, 3
s_sub_u32 s77, s77, 1
v_min_u32 v4, 8, v0
v_add_u32 v4, s77, v4
v_max_i32 v4, 0, v4
v_lshl_add_u32 v4, v4, 1, 1
s_mul_i32 s77, s48, 5
s_lshr_b32 s77, s77, 2
s_sub_u32 s77, s77, 130
v_min_u32 v6, 49, v0
v_lshrrev_b32 v7, 1, v6
v_and_b32 v6, 1, v6
v_mad_u32_u24 v6, v7, 10, v6
v_add_lshl_u32 v6, v6, s77, 1
v_or_b32 v6, 1, v6
s_lshl1_add_u32 s77, s44, 4294967137
v_lshl_add_u32 v5, v0, 4, s77
v_cmp_gt_u32 vcc, 26, v0
s_nop 1
v_cndmask_b32 v6, v6, v5, vcc
v_cmp_gt_u32 vcc, 10, v0
s_nop 1
v_cndmask_b32 v6, v6, v4, vcc
v_lshlrev_b32 v62, 7, v6
s_mov_b32 s78, 23166976
s_xor_b32 s62, s3, 4
v_and_b32 v4, 15, v0
v_lshrrev_b32 v5, 4, v0
s_mul_i32 s61, s62, 8320
v_mul_u32_u24 v6, 520, v4
v_add_u32 v7, s61, v6
v_add_u32 v25, v7, v6
v_lshl_add_u32 v24, v5, 3, v25
v_lshl_add_u32 v6, v5, 3, v7
v_mov_b32 v1, 68480
s_mov_b32 vcc_lo, 0x55555555
s_mov_b32 vcc_hi, 0x55555555
v_cndmask_b32 v20, v1, v6, vcc
v_cndmask_b32 v22, v6, v1, vcc
s_mov_b64 vcc, 0x5555
v_cndmask_b32 v21, v1, v7, vcc
s_mov_b64 vcc, 0xaaaa
v_cndmask_b32 v23, v1, v7, vcc
v_lshrrev_b32 v6, 2, v0
v_and_b32 v7, 3, v0
v_mul_u32_u24 v6, 1040, v6
v_add_u32 v6, s61, v6
v_lshl_add_u32 v26, v7, 3, v6
v_mad_u32_u24 v27, v7, 40, v6
v_lshrrev_b32 v6, 5, v0
v_lshlrev_b32 v6, 8, v6
v_lshl_add_u32 v6, v4, 4, v6
v_and_b32 v7, 1, v5
v_lshl_add_u32 v16, v7, 26, v6
v_and_b32 v6, 1, v0
v_add_u32 v32, -1, v6
v_sub_u32 v33, 0, v6
s_lshl_b32 s64, s62, 7
s_add_u32 s64, s64, 79872
v_lshl_add_u32 v9, v4, 3, s64
v_lshl_add_u32 v10, v6, 3, s64
v_lshl_add_u32 v10, v5, 6, v10
s_or_b32 s64, s45, s62
s_cmp_eq_u32 s64, 0
s_cselect_b32 s64, 8, 0
v_bfe_u32 v6, v0, 1, 3
v_add_u32 v7, 1, v6
v_max_u32 v7, s64, v7
v_add_u32 v6, 8, v6
v_lshlrev_b32 v5, 2, v5
v_sub_u32 v6, v6, v7
v_sub_u32 v5, v5, v7
v_mov_b32 v4, 0xf149f2ca
v_add_u32 v7, 0, v5
v_cmp_ge_u32 vcc, v6, v7
s_nop 1
v_cndmask_b32_e64 v28, v4, 0, vcc
v_add_u32 v7, 1, v5
v_cmp_ge_u32 vcc, v6, v7
s_nop 1
v_cndmask_b32_e64 v29, v4, 0, vcc
v_add_u32 v7, 2, v5
v_cmp_ge_u32 vcc, v6, v7
s_nop 1
v_cndmask_b32_e64 v30, v4, 0, vcc
v_add_u32 v7, 3, v5
v_cmp_ge_u32 vcc, v6, v7
s_nop 1
v_cndmask_b32_e64 v31, v4, 0, vcc
s_lshl3_add_u32 s70, s45, s44
s_mul_i32 s68, s70, 6554
s_lshr_b32 s68, s68, 16
s_mul_i32 s69, s68, 10
s_sub_u32 s69, s70, s69
s_mul_i32 s71, s49, 12
s_add_u32 s68, s68, s71
s_cmp_ge_u32 s70, 120
s_cselect_b32 s68, 99, s68
s_cselect_b32 s6, 0, 1966080
s_mov_b64 s[4:5], s[16:17]
s_mov_b32 s7, 0x20000
s_cmp_ge_u32 s68, 20
s_cselect_b32 s22, 0, 819200
s_mov_b64 s[20:21], s[8:9]
s_mov_b32 s23, 0x20000
s_lshl_b32 s70, s69, 7
s_mul_i32 s65, s68, 40960
s_add_u32 s65, s65, s70
s_mul_i32 s66, s68, 40
s_mul_i32 s71, s68, 160
s_sub_u32 s71, s71, 2544
s_cmp_ge_u32 s68, 16
s_cselect_b32 s66, s71, s66
s_mov_b32 s71, 5120
s_cselect_b32 s67, 51200, s71
s_mul_i32 s66, s66, 1280
s_add_u32 s66, s66, s70
v_lshrrev_b32 v5, 5, v0
v_and_b32 v7, 7, v0
v_bfe_u32 v6, v0, 3, 2
v_lshl_add_u32 v4, v5, 4, v6
v_and_b32 v6, 2, v6
v_xor_b32 v7, v7, v6
v_mul_u32_u24 v4, 1280, v4
v_lshl_add_u32 v40, v7, 4, v4
v_xor_b32 v41, 64, v40
v_mul_u32_u24 v5, 5120, v5
v_add_u32 v42, v40, v5
v_add_u32 v43, v41, v5
s_lshl_b32 s71, s49, 12
s_add_u32 s71, s71, 122880
s_mov_b32 s58, s71
v_lshrrev_b32 v5, 4, v0
v_and_b32 v7, 3, v0
v_bfe_u32 v6, v0, 2, 2
v_lshl_add_u32 v4, v5, 3, v6
v_lshlrev_b32 v4, 7, v4
v_lshlrev_b32 v7, 3, v7
v_add3_u32 v4, v4, v7, s71
v_lshrrev_b32 v6, 1, v6
v_and_b32 v5, 1, v5
v_lshl_or_b32 v6, v5, 1, v6
v_lshl_add_u32 v44, v6, 5, v4
v_xor_b32 v45, 32, v44
v_xor_b32 v46, 64, v44
v_xor_b32 v47, 96, v44
v_and_b32 v4, 7, v0
v_lshrrev_b32 v5, 3, v0
v_lshlrev_b32 v4, 3, v4
v_add_lshl_u32 v49, v4, v5, 2
s_lshl_b32 s72, s49, 6
s_lshl_b32 s64, s45, 7
v_add_u32 v4, s72, v0
s_sub_u32 s64, s64, 16
v_min_u32 v4, 143, v4
v_add_u32 v5, s64, v4
v_max_i32 v5, 0, v5
v_lshlrev_b32 v64, 3, v5
v_lshlrev_b32 v4, 3, v4
v_add_u32 v19, 79872, v4
s_mov_b32 s64, 20971520
v_mov_b32 v65, 81408
v_lshlrev_b32 v66, 26, v0
v_mov_b32 v67, 0
v_add_u32 v68, 76800, v3
v_lshrrev_b32 v4, 3, v0
v_lshl_add_u32 v69, v4, 26, v2
s_add_u32 m0, s52, 15360
s_nop 0
buffer_load_dwordx4 v13, s[28:31], s50 offen lds
s_add_u32 m0, s52, 16384
s_nop 0
buffer_load_dwordx4 v14, s[28:31], s50 offen lds
s_add_u32 m0, s52, 17408
s_nop 0
buffer_load_dwordx4 v15, s[28:31], s50 offen lds
s_add_u32 m0, s12, 18432
s_nop 0
buffer_load_dwordx4 v17, s[28:31], s50 offen lds
s_add_u32 s50, s50, 122880
s_add_u32 m0, s53, 79744
s_nop 0
s_mov_b64 exec, s[56:57]
s_cbranch_execz L29
buffer_load_dwordx4 v11, s[24:27], 0 offen offset:128 lds
L29:
s_mov_b64 exec, -1
s_add_u32 m0, s53, 81920
s_nop 0
buffer_load_dwordx4 v12, s[24:27], s51 offen lds
s_add_u32 s51, s51, 40960
s_waitcnt vmcnt(5)
s_barrier
s_add_u32 m0, s53, 86016
s_nop 0
buffer_load_dwordx4 v12, s[24:27], s51 offen lds
s_add_u32 s51, s51, 40960
s_add_u32 m0, s53, 90112
s_nop 0
buffer_load_dwordx4 v12, s[24:27], s51 offen lds
s_add_u32 s51, s51, 40960
s_add_u32 m0, s53, 94208
s_nop 0
buffer_load_dwordx4 v12, s[24:27], s51 offen lds
s_add_u32 s51, s51, 4294844544
s_add_u32 m0, s52, 30720
s_nop 0
buffer_load_dwordx4 v13, s[28:31], s50 offen lds
s_add_u32 m0, s52, 31744
s_nop 0
buffer_load_dwordx4 v14, s[28:31], s50 offen lds
s_add_u32 m0, s52, 32768
s_nop 0
buffer_load_dwordx4 v15, s[28:31], s50 offen lds
s_add_u32 m0, s12, 33792
s_nop 0
buffer_load_dwordx4 v17, s[28:31], s50 offen lds
s_add_u32 s50, s50, 122880
s_add_u32 m0, s52, 46080
s_nop 0
buffer_load_dwordx4 v13, s[28:31], s50 offen lds
v_and_b32 v52, 7, v0
v_lshlrev_b32 v52, 4, v52
v_add_u32 v52, 163712, v52
ds_read_b128 v[36:39], v52
s_waitcnt vmcnt(9) lgkmcnt(0)
s_barrier
s_add_u32 m0, s52, 47104
s_nop 0
buffer_load_dwordx4 v14, s[28:31], s50 offen lds
s_add_u32 m0, s52, 48128
s_nop 0
buffer_load_dwordx4 v15, s[28:31], s50 offen lds
s_add_u32 m0, s12, 49152
s_nop 0
buffer_load_dwordx4 v17, s[28:31], s50 offen lds
s_add_u32 s50, s50, 122880
s_add_u32 m0, s53, 98048
s_nop 0
s_mov_b64 exec, s[56:57]
s_cbranch_execz L30
buffer_load_dwordx4 v11, s[24:27], 0 offen offset:256 lds
L30:
s_mov_b64 exec, -1
s_add_u32 m0, s53, 100352
s_nop 0
buffer_load_dwordx4 v12, s[24:27], s51 offen lds
s_add_u32 s51, s51, 40960
s_add_u32 m0, s53, 104448
s_nop 0
buffer_load_dwordx4 v12, s[24:27], s51 offen lds
s_add_u32 s51, s51, 40960
s_add_u32 m0, s53, 108544
s_nop 0
buffer_load_dwordx4 v12, s[24:27], s51 offen lds
s_add_u32 s51, s51, 40960
s_add_u32 m0, s53, 112640
s_nop 0
buffer_load_dwordx4 v12, s[24:27], s51 offen lds
s_add_u32 s51, s51, 4294844544
v_lshlrev_b32 v240, 16, v208
v_and_b32 v241, 0xffff0000, v208
v_lshlrev_b32 v242, 16, v209
v_and_b32 v243, 0xffff0000, v209
v_lshlrev_b32 v244, 16, v210
v_and_b32 v245, 0xffff0000, v210
v_lshlrev_b32 v246, 16, v211
v_and_b32 v247, 0xffff0000, v211
s_waitcnt vmcnt(8)
s_barrier
s_add_u32 m0, s52, 0
s_nop 0
buffer_load_dwordx4 v13, s[28:31], s50 offen lds
s_add_u32 m0, s52, 1024
s_nop 0
buffer_load_dwordx4 v14, s[28:31], s50 offen lds
s_add_u32 m0, s52, 2048
s_nop 0
buffer_load_dwordx4 v15, s[28:31], s50 offen lds
s_add_u32 m0, s12, 3072
s_nop 0
buffer_load_dwordx4 v17, s[28:31], s50 offen lds
s_add_u32 s50, s50, 122880
s_add_u32 m0, s52, 15360
s_nop 0
buffer_load_dwordx4 v13, s[28:31], s50 offen lds
s_add_u32 m0, s52, 16384
s_nop 0
buffer_load_dwordx4 v14, s[28:31], s50 offen lds
s_add_u32 m0, s52, 17408
s_nop 0
buffer_load_dwordx4 v15, s[28:31], s50 offen lds
s_add_u32 m0, s12, 18432
s_nop 0
buffer_load_dwordx4 v17, s[28:31], s50 offen lds
s_add_u32 s50, s50, 122880
v_lshlrev_b32 v248, 16, v212
v_and_b32 v212, 0xffff0000, v212
v_lshlrev_b32 v249, 16, v213
v_and_b32 v213, 0xffff0000, v213
v_lshlrev_b32 v250, 16, v214
v_and_b32 v214, 0xffff0000, v214
v_lshlrev_b32 v251, 16, v215
v_and_b32 v215, 0xffff0000, v215
v_add_f32 v240, v240, v248
v_add_f32 v241, v241, v212
v_add_f32 v242, v242, v249
v_add_f32 v243, v243, v213
v_add_f32 v244, v244, v250
v_add_f32 v245, v245, v214
v_add_f32 v246, v246, v251
v_add_f32 v247, v247, v215
s_waitcnt vmcnt(12)
s_barrier
s_add_u32 m0, s53, 61056
s_nop 0
s_mov_b64 exec, s[56:57]
s_cbranch_execz L31
buffer_load_dwordx4 v11, s[24:27], 0 offen offset:384 lds
L31:
s_mov_b64 exec, -1
s_add_u32 m0, s53, 63488
s_nop 0
buffer_load_dwordx4 v12, s[24:27], s51 offen lds
s_add_u32 s51, s51, 40960
s_add_u32 m0, s53, 67584
s_nop 0
buffer_load_dwordx4 v12, s[24:27], s51 offen lds
s_add_u32 s51, s51, 40960
s_add_u32 m0, s53, 71680
s_nop 0
buffer_load_dwordx4 v12, s[24:27], s51 offen lds
s_add_u32 s51, s51, 40960
s_add_u32 m0, s53, 75776
s_nop 0
buffer_load_dwordx4 v12, s[24:27], s51 offen lds
s_add_u32 s51, s51, 4294844544
s_add_u32 m0, s52, 30720
s_nop 0
buffer_load_dwordx4 v13, s[28:31], s50 offen lds
s_add_u32 m0, s52, 31744
s_nop 0
buffer_load_dwordx4 v14, s[28:31], s50 offen lds
s_add_u32 m0, s52, 32768
s_nop 0
buffer_load_dwordx4 v15, s[28:31], s50 offen lds
v_lshlrev_b32 v248, 16, v216
v_and_b32 v216, 0xffff0000, v216
v_lshlrev_b32 v249, 16, v217
v_and_b32 v217, 0xffff0000, v217
v_lshlrev_b32 v250, 16, v218
v_and_b32 v218, 0xffff0000, v218
v_lshlrev_b32 v251, 16, v219
v_and_b32 v219, 0xffff0000, v219
v_add_f32 v240, v240, v248
v_add_f32 v241, v241, v216
v_add_f32 v242, v242, v249
v_add_f32 v243, v243, v217
v_add_f32 v244, v244, v250
v_add_f32 v245, v245, v218
v_add_f32 v246, v246, v251
v_add_f32 v247, v247, v219
s_waitcnt vmcnt(11)
s_barrier
buffer_load_dwordx4 v[220:223], v48, s[40:43], s54 offen
s_add_u32 s54, s54, 245760
buffer_load_dwordx4 v[224:227], v48, s[40:43], s54 offen
s_add_u32 s54, s54, 245760
buffer_load_dwordx4 v[228:231], v48, s[40:43], s54 offen
s_add_u32 s54, s54, 245760
buffer_load_dwordx4 v[232:235], v48, s[40:43], s54 offen
s_add_u32 s54, s54, 245760
buffer_load_dwordx4 v[236:239], v48, s[40:43], s54 offen
s_add_u32 s54, s54, 245760
s_add_u32 m0, s12, 33792
s_nop 0
buffer_load_dwordx4 v17, s[28:31], s50 offen lds
s_add_u32 s50, s50, 122880
s_add_u32 m0, s52, 46080
s_nop 0
buffer_load_dwordx4 v13, s[28:31], s50 offen lds
s_add_u32 m0, s58, 16384
s_nop 0
buffer_load_dwordx4 v42, s[20:23], s66 offen nt lds
s_add_u32 s66, s66, s67
s_add_u32 m0, s58, 17408
s_nop 0
buffer_load_dwordx4 v43, s[20:23], s66 offen nt lds
s_add_u32 s66, s66, s67
s_add_u32 m0, s58, 18432
s_nop 0
buffer_load_dwordx4 v42, s[20:23], s66 offen nt lds
s_add_u32 s66, s66, s67
s_add_u32 m0, s58, 19456
s_nop 0
buffer_load_dwordx4 v43, s[20:23], s66 offen nt lds
s_add_u32 s66, s66, s67
s_add_u32 m0, s58, 0
s_nop 0
buffer_load_dwordx4 v40, s[4:7], s65 offen nt lds
s_add_u32 s65, s65, 5120
s_add_u32 m0, s58, 1024
s_nop 0
buffer_load_dwordx4 v41, s[4:7], s65 offen nt lds
s_add_u32 s65, s65, 5120
s_add_u32 m0, s58, 2048
s_nop 0
buffer_load_dwordx4 v40, s[4:7], s65 offen nt lds
s_add_u32 s65, s65, 5120
s_add_u32 m0, s58, 3072
s_nop 0
buffer_load_dwordx4 v41, s[4:7], s65 offen nt lds
s_add_u32 s65, s65, 5120
s_waitcnt vmcnt(22)
s_barrier
s_add_u32 m0, s52, 47104
s_nop 0
buffer_load_dwordx4 v14, s[28:31], s50 offen lds
s_add_u32 m0, s52, 48128
s_nop 0
buffer_load_dwordx4 v15, s[28:31], s50 offen lds
s_waitcnt vmcnt(11)
s_barrier
s_add_u32 m0, s12, 49152
s_nop 0
buffer_load_dwordx4 v17, s[28:31], s50 offen lds
s_add_u32 s50, s50, 122880
s_add_u32 m0, s53, 79360
s_nop 0
s_mov_b64 exec, s[56:57]
s_cbranch_execz L32
buffer_load_dwordx4 v11, s[24:27], 0 offen offset:512 lds
L32:
s_mov_b64 exec, -1
s_add_u32 m0, s53, 81920
s_nop 0
buffer_load_dwordx4 v12, s[24:27], s51 offen lds
s_add_u32 s51, s51, 40960
s_add_u32 m0, s53, 86016
s_nop 0
buffer_load_dwordx4 v12, s[24:27], s51 offen lds
s_add_u32 s51, s51, 40960
s_add_u32 m0, s53, 90112
s_nop 0
buffer_load_dwordx4 v12, s[24:27], s51 offen lds
s_add_u32 s51, s51, 40960
s_add_u32 m0, s53, 94208
s_nop 0
buffer_load_dwordx4 v12, s[24:27], s51 offen lds
s_add_u32 s51, s51, 4294844544
s_add_u32 m0, s52, 0
s_nop 0
buffer_load_dwordx4 v13, s[28:31], s50 offen lds
s_add_u32 m0, s52, 1024
s_nop 0
buffer_load_dwordx4 v14, s[28:31], s50 offen lds
v_lshlrev_b32 v248, 16, v220
v_and_b32 v220, 0xffff0000, v220
v_lshlrev_b32 v249, 16, v221
v_and_b32 v221, 0xffff0000, v221
v_lshlrev_b32 v250, 16, v222
v_and_b32 v222, 0xffff0000, v222
v_lshlrev_b32 v251, 16, v223
v_and_b32 v223, 0xffff0000, v223
v_add_f32 v240, v240, v248
v_add_f32 v241, v241, v220
v_add_f32 v242, v242, v249
v_add_f32 v243, v243, v221
v_add_f32 v244, v244, v250
v_add_f32 v245, v245, v222
v_add_f32 v246, v246, v251
v_add_f32 v247, v247, v223
v_lshlrev_b32 v248, 16, v224
v_and_b32 v224, 0xffff0000, v224
v_lshlrev_b32 v249, 16, v225
v_and_b32 v225, 0xffff0000, v225
v_lshlrev_b32 v250, 16, v226
v_and_b32 v226, 0xffff0000, v226
v_lshlrev_b32 v251, 16, v227
v_and_b32 v227, 0xffff0000, v227
v_add_f32 v240, v240, v248
v_add_f32 v241, v241, v224
v_add_f32 v242, v242, v249
v_add_f32 v243, v243, v225
v_add_f32 v244, v244, v250
v_add_f32 v245, v245, v226
v_add_f32 v246, v246, v251
v_add_f32 v247, v247, v227
v_lshlrev_b32 v248, 16, v228
v_and_b32 v228, 0xffff0000, v228
v_lshlrev_b32 v249, 16, v229
v_and_b32 v229, 0xffff0000, v229
v_lshlrev_b32 v250, 16, v230
v_and_b32 v230, 0xffff0000, v230
v_lshlrev_b32 v251, 16, v231
v_and_b32 v231, 0xffff0000, v231
v_add_f32 v240, v240, v248
v_add_f32 v241, v241, v228
v_add_f32 v242, v242, v249
v_add_f32 v243, v243, v229
v_add_f32 v244, v244, v250
v_add_f32 v245, v245, v230
v_add_f32 v246, v246, v251
v_add_f32 v247, v247, v231
v_lshlrev_b32 v248, 16, v232
v_and_b32 v232, 0xffff0000, v232
v_lshlrev_b32 v249, 16, v233
v_and_b32 v233, 0xffff0000, v233
v_lshlrev_b32 v250, 16, v234
v_and_b32 v234, 0xffff0000, v234
v_lshlrev_b32 v251, 16, v235
v_and_b32 v235, 0xffff0000, v235
v_add_f32 v240, v240, v248
v_add_f32 v241, v241, v232
v_add_f32 v242, v242, v249
v_add_f32 v243, v243, v233
v_add_f32 v244, v244, v250
v_add_f32 v245, v245, v234
v_add_f32 v246, v246, v251
v_add_f32 v247, v247, v235
s_waitcnt vmcnt(6)
s_barrier
s_add_u32 m0, s52, 2048
s_nop 0
buffer_load_dwordx4 v15, s[28:31], s50 offen lds
s_add_u32 m0, s12, 3072
s_nop 0
buffer_load_dwordx4 v17, s[28:31], s50 offen lds
s_add_u32 s50, s50, 122880
s_add_u32 m0, s52, 15360
s_nop 0
buffer_load_dwordx4 v13, s[28:31], s50 offen lds
s_add_u32 m0, s52, 16384
s_nop 0
buffer_load_dwordx4 v14, s[28:31], s50 offen lds
s_add_u32 m0, s52, 17408
s_nop 0
buffer_load_dwordx4 v15, s[28:31], s50 offen lds
s_add_u32 m0, s12, 18432
s_nop 0
buffer_load_dwordx4 v17, s[28:31], s50 offen lds
s_add_u32 s50, s50, 122880
s_add_u32 m0, s53, 97664
s_nop 0
s_mov_b64 exec, s[56:57]
s_cbranch_execz L33
buffer_load_dwordx4 v11, s[24:27], 0 offen offset:640 lds
L33:
s_mov_b64 exec, -1
s_add_u32 m0, s53, 100352
s_nop 0
buffer_load_dwordx4 v12, s[24:27], s51 offen lds
s_add_u32 s51, s51, 40960
ds_read_b64_tr_b16 v[176:177], v44 offset:0
ds_read_b64_tr_b16 v[178:179], v44 offset:512
ds_read_b64_tr_b16 v[180:181], v45 offset:0
ds_read_b64_tr_b16 v[182:183], v45 offset:512
ds_read_b64_tr_b16 v[184:185], v46 offset:0
ds_read_b64_tr_b16 v[186:187], v46 offset:512
ds_read_b64_tr_b16 v[188:189], v47 offset:0
ds_read_b64_tr_b16 v[190:191], v47 offset:512
s_cmp_ge_u32 s3, 6
s_cbranch_scc1 L38
ds_read_b64_tr_b16 v[192:193], v44 offset:16384
ds_read_b64_tr_b16 v[194:195], v44 offset:16896
ds_read_b64_tr_b16 v[196:197], v45 offset:16384
ds_read_b64_tr_b16 v[198:199], v45 offset:16896
ds_read_b64_tr_b16 v[200:201], v46 offset:16384
ds_read_b64_tr_b16 v[202:203], v46 offset:16896
ds_read_b64_tr_b16 v[204:205], v47 offset:16384
ds_read_b64_tr_b16 v[206:207], v47 offset:16896
L38:
v_lshlrev_b32 v248, 16, v236
v_and_b32 v236, 0xffff0000, v236
v_lshlrev_b32 v249, 16, v237
v_and_b32 v237, 0xffff0000, v237
v_lshlrev_b32 v250, 16, v238
v_and_b32 v238, 0xffff0000, v238
v_lshlrev_b32 v251, 16, v239
v_and_b32 v239, 0xffff0000, v239
v_add_f32 v240, v240, v248
v_add_f32 v241, v241, v236
v_add_f32 v242, v242, v249
v_add_f32 v243, v243, v237
v_add_f32 v244, v244, v250
v_add_f32 v245, v245, v238
v_add_f32 v246, v246, v251
v_add_f32 v247, v247, v239
s_nop 1
v_permlane32_swap_b32 v240, v244
v_permlane32_swap_b32 v241, v245
v_permlane32_swap_b32 v242, v246
v_permlane32_swap_b32 v243, v247
v_add_f32 v240, v240, v244
v_add_f32 v241, v241, v245
v_add_f32 v242, v242, v246
v_add_f32 v243, v243, v247
s_nop 1
v_permlane16_swap_b32 v240, v242
v_permlane16_swap_b32 v241, v243
s_nop 0
v_add_f32 v240, v240, v242
v_add_f32 v241, v241, v243
s_mov_b32 vcc_lo, 0xff00ff00
s_mov_b32 vcc_hi, 0xff00ff00
v_add_f32_dpp v240, v240, v240 row_ror:8 row_mask:0xf bank_mask:0xf
v_add_f32_dpp v241, v241, v241 row_ror:8 row_mask:0xf bank_mask:0xf
v_cndmask_b32 v240, v240, v241, vcc
s_waitcnt vmcnt(5) lgkmcnt(0)
s_barrier
s_mul_i32 s72, s68, 5120
s_add_u32 s72, s72, 16777216
s_add_u32 s73, s72, 245760
s_cmp_ge_u32 s68, 48
s_cselect_b32 s72, 2147483648, s72
s_cmp_ge_u32 s68, 20
s_cselect_b32 s73, 2147483648, s73
s_lshl2_add_u32 s70, s69, 0
s_mul_i32 s71, s70, 52
s_lshr_b32 s71, s71, 8
s_lshl_b32 s70, s70, 10
s_mul_i32 s71, s71, 343040
s_add_u32 s70, s70, s71
s_add_u32 s71, s70, s72
buffer_store_dwordx4 v[176:179], v2, s[32:35], s71 offen sc1
s_add_u32 s70, s70, s73
buffer_store_dwordx4 v[192:195], v2, s[32:35], s70 offen sc1
s_lshl2_add_u32 s70, s69, 1
s_mul_i32 s71, s70, 52
s_lshr_b32 s71, s71, 8
s_lshl_b32 s70, s70, 10
s_mul_i32 s71, s71, 343040
s_add_u32 s70, s70, s71
s_add_u32 s71, s70, s72
buffer_store_dwordx4 v[180:183], v2, s[32:35], s71 offen sc1
s_add_u32 s70, s70, s73
buffer_store_dwordx4 v[196:199], v2, s[32:35], s70 offen sc1
s_lshl2_add_u32 s70, s69, 2
s_mul_i32 s71, s70, 52
s_lshr_b32 s71, s71, 8
s_lshl_b32 s70, s70, 10
s_mul_i32 s71, s71, 343040
s_add_u32 s70, s70, s71
s_add_u32 s71, s70, s72
buffer_store_dwordx4 v[184:187], v2, s[32:35], s71 offen sc1
s_add_u32 s70, s70, s73
buffer_store_dwordx4 v[200:203], v2, s[32:35], s70 offen sc1
s_lshl2_add_u32 s70, s69, 3
s_mul_i32 s71, s70, 52
s_lshr_b32 s71, s71, 8
s_lshl_b32 s70, s70, 10
s_mul_i32 s71, s71, 343040
s_add_u32 s70, s70, s71
s_add_u32 s71, s70, s72
buffer_store_dwordx4 v[188:191], v2, s[32:35], s71 offen sc1
s_add_u32 s70, s70, s73
buffer_store_dwordx4 v[204:207], v2, s[32:35], s70 offen sc1
s_lshr_b32 s60, s46, 1
s_lshl_b32 s60, s60, 7
s_add_u32 s60, s60, 20971520
s_cmp_eq_u32 s3, 7
s_cselect_b32 s60, s60, 2147483648
buffer_store_dwordx4 v[36:39], v69, s[32:35], s60 offen sc1
buffer_store_dword v240, v49, s[32:35], s76 offen sc1
buffer_load_dwordx2 v[34:35], off, s[36:39], 0 sc1
s_add_u32 m0, s53, 104448
s_nop 0
buffer_load_dwordx4 v12, s[24:27], s51 offen lds
s_add_u32 s51, s51, 40960
s_add_u32 m0, s53, 108544
s_nop 0
buffer_load_dwordx4 v12, s[24:27], s51 offen lds
s_add_u32 s51, s51, 40960
s_waitcnt vmcnt(14)
s_barrier
s_add_u32 m0, s53, 112640
s_nop 0
buffer_load_dwordx4 v12, s[24:27], s51 offen lds
s_add_u32 s51, s51, 4294844544
s_add_u32 m0, s52, 30720
s_nop 0
buffer_load_dwordx4 v13, s[28:31], s50 offen lds
s_add_u32 m0, s52, 31744
s_nop 0
buffer_load_dwordx4 v14, s[28:31], s50 offen lds
s_add_u32 m0, s52, 32768
s_nop 0
buffer_load_dwordx4 v15, s[28:31], s50 offen lds
s_add_u32 m0, s12, 33792
s_nop 0
buffer_load_dwordx4 v17, s[28:31], s50 offen lds
s_add_u32 s50, s50, 122880
s_add_u32 m0, s52, 46080
s_nop 0
buffer_load_dwordx4 v13, s[28:31], s50 offen lds
s_add_u32 m0, s52, 47104
s_nop 0
buffer_load_dwordx4 v14, s[28:31], s50 offen lds
s_add_u32 m0, s52, 48128
s_nop 0
buffer_load_dwordx4 v15, s[28:31], s50 offen lds
s_waitcnt vmcnt(3)
s_mov_b32 s79, 0
L40:
v_cmp_eq_u64 vcc, 0, v[34:35]
s_nop 4
s_cbranch_vccz L41
s_addk_i32 s79, 1
s_cmp_ge_u32 s79, 200000
s_cbranch_scc1 L41
s_sleep 8
buffer_load_dwordx2 v[34:35], off, s[36:39], 0 sc1
s_waitcnt vmcnt(0)
s_branch L40
L41:
v_readfirstlane_b32 s0, v34
v_readfirstlane_b32 s1, v35
s_barrier
s_cmp_lg_u32 s3, 4
s_cbranch_scc1 L42
s_lshl_b32 s60, s46, 7
s_add_u32 s60, s60, 23166976
buffer_store_dwordx2 v[34:35], v66, s[32:35], s60 offen sc1
L42:
s_add_u32 m0, s12, 49152
s_nop 0
buffer_load_dwordx4 v17, s[28:31], s50 offen lds
s_add_u32 s50, s50, 122880
s_add_u32 m0, s53, 60672
s_nop 0
s_mov_b64 exec, s[56:57]
s_cbranch_execz L34
buffer_load_dwordx4 v11, s[24:27], 0 offen offset:768 lds
L34:
s_mov_b64 exec, -1
s_add_u32 m0, s53, 63488
s_nop 0
buffer_load_dwordx4 v12, s[24:27], s51 offen lds
s_add_u32 s51, s51, 40960
s_add_u32 m0, s53, 67584
s_nop 0
buffer_load_dwordx4 v12, s[24:27], s51 offen lds
s_add_u32 s51, s51, 40960
s_add_u32 m0, s53, 71680
s_nop 0
buffer_load_dwordx4 v12, s[24:27], s51 offen lds
s_add_u32 s51, s51, 40960
s_add_u32 m0, s53, 75776
s_nop 0
buffer_load_dwordx4 v12, s[24:27], s51 offen lds
s_add_u32 s51, s51, 4294844544
s_add_u32 m0, s52, 0
s_nop 0
buffer_load_dwordx4 v13, s[28:31], s50 offen lds
s_add_u32 m0, s52, 1024
s_nop 0
buffer_load_dwordx4 v14, s[28:31], s50 offen lds
s_waitcnt vmcnt(6)
s_barrier
s_add_u32 m0, s52, 2048
s_nop 0
buffer_load_dwordx4 v15, s[28:31], s50 offen lds
s_add_u32 m0, s12, 3072
s_nop 0
buffer_load_dwordx4 v17, s[28:31], s50 offen lds
s_add_u32 s50, s50, 122880
s_add_u32 m0, s52, 15360
s_nop 0
buffer_load_dwordx4 v13, s[28:31], s50 offen lds
s_add_u32 m0, s52, 16384
s_nop 0
buffer_load_dwordx4 v14, s[28:31], s50 offen lds
s_add_u32 m0, s52, 17408
s_nop 0
buffer_load_dwordx4 v15, s[28:31], s50 offen lds
s_add_u32 m0, s12, 18432
s_nop 0
buffer_load_dwordx4 v17, s[28:31], s50 offen lds
s_add_u32 s50, s50, 122880
s_add_u32 m0, s53, 78976
s_nop 0
s_mov_b64 exec, s[56:57]
s_cbranch_execz L35
buffer_load_dwordx4 v11, s[24:27], 0 offen offset:896 lds
L35:
s_mov_b64 exec, -1
s_add_u32 m0, s53, 81920
s_nop 0
buffer_load_dwordx4 v12, s[24:27], s51 offen lds
s_add_u32 s51, s51, 40960
s_waitcnt vmcnt(5)
s_barrier
s_add_u32 m0, s53, 86016
s_nop 0
buffer_load_dwordx4 v12, s[24:27], s51 offen lds
s_add_u32 s51, s51, 40960
s_add_u32 m0, s53, 90112
s_nop 0
buffer_load_dwordx4 v12, s[24:27], s51 offen lds
s_add_u32 s51, s51, 40960
s_add_u32 m0, s53, 94208
s_nop 0
buffer_load_dwordx4 v12, s[24:27], s51 offen lds
s_add_u32 s51, s51, 4294844544
s_add_u32 m0, s52, 30720
s_nop 0
buffer_load_dwordx4 v13, s[28:31], s50 offen lds
s_add_u32 m0, s52, 31744
s_nop 0
buffer_load_dwordx4 v14, s[28:31], s50 offen lds
s_add_u32 m0, s52, 32768
s_nop 0
buffer_load_dwordx4 v15, s[28:31], s50 offen lds
s_add_u32 m0, s12, 33792
s_nop 0
buffer_load_dwordx4 v17, s[28:31], s50 offen lds
s_add_u32 s50, s50, 122880
s_add_u32 m0, s52, 46080
s_nop 0
buffer_load_dwordx4 v13, s[28:31], s50 offen lds
s_waitcnt vmcnt(9)
s_barrier
s_add_u32 m0, s52, 47104
s_nop 0
buffer_load_dwordx4 v14, s[28:31], s50 offen lds
s_add_u32 m0, s52, 48128
s_nop 0
buffer_load_dwordx4 v15, s[28:31], s50 offen lds
s_add_u32 m0, s12, 49152
s_nop 0
buffer_load_dwordx4 v17, s[28:31], s50 offen lds
s_add_u32 s50, s50, 122880
s_add_u32 m0, s53, 97280
s_nop 0
s_mov_b64 exec, s[56:57]
s_cbranch_execz L36
buffer_load_dwordx4 v11, s[24:27], 0 offen offset:1024 lds
L36:
s_mov_b64 exec, -1
s_add_u32 m0, s53, 100352
s_nop 0
buffer_load_dwordx4 v12, s[24:27], s51 offen lds
s_add_u32 s51, s51, 40960
s_add_u32 m0, s53, 104448
s_nop 0
buffer_load_dwordx4 v12, s[24:27], s51 offen lds
s_add_u32 s51, s51, 40960
s_add_u32 m0, s53, 108544
s_nop 0
buffer_load_dwordx4 v12, s[24:27], s51 offen lds
s_add_u32 s51, s51, 40960
s_add_u32 m0, s53, 112640
s_nop 0
buffer_load_dwordx4 v12, s[24:27], s51 offen lds
s_add_u32 s51, s51, 4294844544
s_waitcnt vmcnt(8)
s_barrier
s_cmp_lg_u32 s3, 4
s_cbranch_scc1 L43
buffer_load_dwordx2 v[60:61], v62, s[32:35], s78 offen sc1
L43:
s_add_u32 m0, s52, 0
s_nop 0
buffer_load_dwordx4 v13, s[28:31], s50 offen lds
s_add_u32 m0, s52, 1024
s_nop 0
buffer_load_dwordx4 v14, s[28:31], s50 offen lds
s_add_u32 m0, s52, 2048
s_nop 0
buffer_load_dwordx4 v15, s[28:31], s50 offen lds
s_add_u32 m0, s12, 3072
s_nop 0
buffer_load_dwordx4 v17, s[28:31], s50 offen lds
s_add_u32 s50, s50, 122880
s_add_u32 m0, s52, 15360
s_nop 0
buffer_load_dwordx4 v13, s[28:31], s50 offen lds
s_add_u32 m0, s52, 16384
s_nop 0
buffer_load_dwordx4 v14, s[28:31], s50 offen lds
s_add_u32 m0, s52, 17408
s_nop 0
buffer_load_dwordx4 v15, s[28:31], s50 offen lds
s_add_u32 m0, s12, 18432
s_nop 0
buffer_load_dwordx4 v17, s[28:31], s50 offen lds
s_add_u32 s50, s50, 122880
s_waitcnt vmcnt(8)
s_cmp_lg_u32 s3, 4
s_cbranch_scc1 L45
s_mov_b32 s79, 0
L44:
v_cmp_ne_u64 vcc, s[0:1], v[60:61]
s_nop 4
s_cbranch_vccz L45
s_addk_i32 s79, 1
s_cmp_ge_u32 s79, 200000
s_cbranch_scc1 L45
s_sleep 8
buffer_load_dwordx2 v[60:61], v62, s[32:35], s78 offen sc1
s_waitcnt vmcnt(0)
s_branch L44
L45:
s_barrier
buffer_load_dwordx2 v[56:57], v64, s[32:35], s64 offen sc1
s_add_u32 m0, s53, 60288
s_nop 0
s_mov_b64 exec, s[56:57]
s_cbranch_execz L37
buffer_load_dwordx4 v11, s[24:27], 0 offen offset:1152 lds
L37:
s_mov_b64 exec, -1
s_add_u32 m0, s53, 63488
s_nop 0
buffer_load_dwordx4 v12, s[24:27], s51 offen lds
s_add_u32 s51, s51, 40960
s_add_u32 m0, s53, 67584
s_nop 0
buffer_load_dwordx4 v12, s[24:27], s51 offen lds
s_add_u32 s51, s51, 40960
s_add_u32 m0, s53, 71680
s_nop 0
buffer_load_dwordx4 v12, s[24:27], s51 offen lds
s_add_u32 s51, s51, 40960
s_add_u32 m0, s53, 75776
s_nop 0
buffer_load_dwordx4 v12, s[24:27], s51 offen lds
s_add_u32 s51, s51, 4294844544
s_add_u32 m0, s52, 30720
s_nop 0
buffer_load_dwordx4 v13, s[28:31], s50 offen lds
s_add_u32 m0, s52, 31744
s_nop 0
buffer_load_dwordx4 v14, s[28:31], s50 offen lds
s_add_u32 m0, s52, 32768
s_nop 0
buffer_load_dwordx4 v15, s[28:31], s50 offen lds
s_waitcnt vmcnt(12)
s_barrier
s_add_u32 m0, s12, 33792
s_nop 0
buffer_load_dwordx4 v17, s[28:31], s50 offen lds
s_add_u32 s50, s50, 122880
s_add_u32 m0, s52, 46080
s_nop 0
buffer_load_dwordx4 v13, s[28:31], s50 offen lds
s_add_u32 m0, s52, 47104
s_nop 0
buffer_load_dwordx4 v14, s[28:31], s50 offen lds
s_add_u32 m0, s52, 48128
s_nop 0
buffer_load_dwordx4 v15, s[28:31], s50 offen lds
s_add_u32 m0, s12, 49152
s_nop 0
buffer_load_dwordx4 v17, s[28:31], s50 offen lds
s_add_u32 s50, s50, 122880
s_waitcnt vmcnt(12)
s_barrier
s_add_u32 s74, s11, 0
s_add_u32 m0, s59, 122880
s_nop 0
buffer_load_dwordx4 v2, s[32:35], s74 offen offset:0 sc1 lds
s_add_u32 m0, s59, 122880
s_nop 0
buffer_load_dwordx4 v2, s[32:35], s74 offen offset:1024 sc1 lds
s_add_u32 m0, s59, 122880
s_nop 0
buffer_load_dwordx4 v2, s[32:35], s74 offen offset:2048 sc1 lds
s_add_u32 m0, s59, 122880
s_nop 0
buffer_load_dwordx4 v2, s[32:35], s74 offen offset:3072 sc1 lds
s_add_u32 m0, s59, 126976
s_nop 0
buffer_load_dwordx4 v18, s[32:35], s74 offen offset:0 sc1 lds
s_add_u32 s74, s11, 61440
s_add_u32 m0, s59, 143360
s_nop 0
buffer_load_dwordx4 v2, s[32:35], s74 offen offset:0 sc1 lds
s_add_u32 m0, s59, 143360
s_nop 0
buffer_load_dwordx4 v2, s[32:35], s74 offen offset:1024 sc1 lds
s_add_u32 m0, s59, 143360
s_nop 0
buffer_load_dwordx4 v2, s[32:35], s74 offen offset:2048 sc1 lds
ds_write_b64 v19, v[56:57]
ds_write_b64 v65, v[34:35]
s_waitcnt vmcnt(12) lgkmcnt(0)
s_barrier
s_add_u32 m0, s59, 143360
s_nop 0
buffer_load_dwordx4 v2, s[32:35], s74 offen offset:3072 sc1 lds
s_add_u32 m0, s59, 147456
s_nop 0
buffer_load_dwordx4 v18, s[32:35], s74 offen offset:0 sc1 lds
s_add_u32 s74, s11, 122880
s_add_u32 m0, s59, 102400
s_nop 0
buffer_load_dwordx4 v2, s[32:35], s74 offen offset:0 sc1 lds
s_add_u32 m0, s59, 102400
s_nop 0
buffer_load_dwordx4 v2, s[32:35], s74 offen offset:1024 sc1 lds
s_add_u32 m0, s59, 102400
s_nop 0
buffer_load_dwordx4 v2, s[32:35], s74 offen offset:2048 sc1 lds
s_add_u32 m0, s59, 102400
s_nop 0
buffer_load_dwordx4 v2, s[32:35], s74 offen offset:3072 sc1 lds
s_add_u32 m0, s59, 106496
s_nop 0
buffer_load_dwordx4 v18, s[32:35], s74 offen offset:0 sc1 lds
s_add_u32 s74, s11, 184320
s_add_u32 m0, s59, 81920
s_nop 0
buffer_load_dwordx4 v2, s[32:35], s74 offen offset:0 sc1 lds
s_mov_b32 s66, 0xffff0000
s_mov_b32 s67, 0
s_mov_b32 s68, 0
s_mov_b32 s69, 0xffff
s_mov_b32 s70, 0
s_mov_b32 s71, 0xffff0000
s_lshr_b32 s61, s3, 2
s_xor_b32 s61, s61, 1
s_lshl1_add_u32 s61, s45, s61
s_mul_i32 s61, s61, 278528
s_lshl_b32 s62, s49, 10
s_add_u32 s61, s61, s62
s_lshl_b32 s62, s44, 13
s_add_u32 s62, s62, s61
s_add_u32 s62, s62, 196608
s_add_u32 s63, s62, 4096
s_lshr_b32 s72, s44, 1
s_lshl_b32 s72, s72, 12
s_add_u32 s61, s61, s72
s_and_b32 s72, s44, 1
s_lshl_b32 s72, s72, 9
s_add_u32 s61, s61, s72
s_add_u32 s61, s61, 262144
s_lshr_b32 s54, s46, 1
s_lshl_b32 s54, s54, 7
s_add_u32 s54, s54, 23134208
s_waitcnt vmcnt(16)
s_barrier
s_add_u32 m0, s59, 81920
s_nop 0
buffer_load_dwordx4 v2, s[32:35], s74 offen offset:1024 sc1 lds
s_add_u32 m0, s59, 81920
s_nop 0
buffer_load_dwordx4 v2, s[32:35], s74 offen offset:2048 sc1 lds
s_add_u32 m0, s59, 81920
s_nop 0
buffer_load_dwordx4 v2, s[32:35], s74 offen offset:3072 sc1 lds
s_add_u32 m0, s59, 86016
s_nop 0
buffer_load_dwordx4 v18, s[32:35], s74 offen offset:0 sc1 lds
s_mul_i32 s75, s49, 5120
s_add_u32 s75, s75, s10
s_add_u32 s75, s75, 327680
buffer_load_dwordx4 v[76:79], v2, s[32:35], s75 offen offset:0 sc1
buffer_load_dwordx4 v[80:83], v2, s[32:35], s75 offen offset:1024 sc1
buffer_load_dwordx4 v[84:87], v2, s[32:35], s75 offen offset:2048 sc1
buffer_load_dwordx4 v[88:91], v2, s[32:35], s75 offen offset:3072 sc1
ds_read_b32 v11, v9 offset:132
ds_read_b32 v12, v10 offset:4
ds_read_b32 v13, v10 offset:20
ds_read_b32 v14, v10 offset:36
ds_read_b32 v15, v10 offset:52
s_waitcnt lgkmcnt(0)
s_barrier
buffer_load_dwordx4 v[92:95], v18, s[32:35], s75 offen offset:0 sc1
s_mul_i32 s75, s49, 20480
s_add_u32 s75, s75, s10
s_add_u32 s75, s75, 245760
buffer_load_dwordx4 v[96:99], v2, s[32:35], s75 offen offset:0 sc1
buffer_load_dwordx4 v[100:103], v2, s[32:35], s75 offen offset:1024 sc1
buffer_load_dwordx4 v[104:107], v2, s[32:35], s75 offen offset:2048 sc1
buffer_load_dwordx4 v[108:111], v2, s[32:35], s75 offen offset:3072 sc1
buffer_load_dwordx4 v[112:115], v18, s[32:35], s75 offen offset:0 sc1
s_mul_i32 s75, s49, 20480
s_add_u32 s75, s75, s10
s_add_u32 s75, s75, 250880
ds_write_b32 v68, v67
s_mov_b32 s81, 2
s_mov_b64 exec, 0
s_cmp_eq_u32 s49, 0
s_cbranch_scc1 W_A0
s_cmp_eq_u32 s49, 1
s_cbranch_scc1 W_A1
s_cmp_eq_u32 s49, 2
s_cbranch_scc1 W_A2
s_branch W_A3
W_RETA:
s_mov_b64 exec, -1
s_branch Q_ATT
.p2align 12
Q_ATT:
W_A0:
ISL_6677:
s_cbranch_execz W_RET
s_nop 0
s_setprio 0
s_waitcnt lgkmcnt(0)
v_mul_f32 v9, v11, v11
v_mul_f32 v11, 0x3ea52b5c, v11
v_mul_f32 v72, v11, v12
v_mul_f32 v73, v11, v13
v_mul_f32 v74, v11, v14
v_mul_f32 v75, v11, v15
s_barrier
ds_read_b64 v[176:177], v20 offset:8320
ds_read_b64 v[178:179], v21 offset:8352
ds_read_b64 v[208:209], v24 offset:160
ds_read_b64 v[210:211], v25 offset:192
ds_read_b64 v[180:181], v20 offset:8360
ds_read_b64 v[182:183], v21 offset:8392
ds_read_b64 v[212:213], v24 offset:200
ds_read_b64 v[214:215], v25 offset:232
ds_read_b64 v[184:185], v20 offset:8400
ds_read_b64 v[186:187], v21 offset:8432
ds_read_b64 v[216:217], v24 offset:240
ds_read_b64 v[218:219], v25 offset:272
ds_read_b64 v[188:189], v20 offset:8440
ds_read_b64 v[190:191], v21 offset:8472
ds_read_b64 v[220:221], v24 offset:280
ds_read_b64 v[222:223], v25 offset:312
ds_read_b64 v[192:193], v22 offset:8320
ds_read_b64 v[194:195], v23 offset:8352
ds_read_b64 v[224:225], v24 offset:680
ds_read_b64 v[226:227], v25 offset:712
ds_read_b64 v[196:197], v22 offset:8360
ds_read_b64 v[198:199], v23 offset:8392
ds_read_b64 v[228:229], v24 offset:720
ds_read_b64 v[230:231], v25 offset:752
ds_read_b64 v[200:201], v22 offset:8400
ds_read_b64 v[202:203], v23 offset:8432
ds_read_b64 v[232:233], v24 offset:760
ds_read_b64 v[234:235], v25 offset:792
ds_read_b64 v[204:205], v22 offset:8440
ds_read_b64 v[206:207], v23 offset:8472
ds_read_b64 v[236:237], v24 offset:800
ds_read_b64 v[238:239], v25 offset:832
s_cmp_lt_u32 s3, 4
s_cbranch_scc1 L46
s_barrier
s_branch L47
L46:
s_mul_i32 s75, s49, 61440
s_add_u32 s75, s75, s10
s_add_u32 s75, s75, 20480
buffer_load_dwordx4 v[76:79], v2, s[32:35], s75 offen offset:0 sc1
buffer_load_dwordx4 v[80:83], v2, s[32:35], s75 offen offset:1024 sc1
buffer_load_dwordx4 v[84:87], v2, s[32:35], s75 offen offset:2048 sc1
buffer_load_dwordx4 v[88:91], v2, s[32:35], s75 offen offset:3072 sc1
L47:
s_waitcnt lgkmcnt(15)
.p2align 3
v_mfma_f32_16x16x32_bf16 v[240:243], v[208:211], v[176:179], v[28:31]
v_mfma_f32_16x16x32_bf16 v[244:247], v[212:215], v[180:183], v[28:31]
v_mfma_f32_16x16x32_bf16 v[248:251], v[216:219], v[184:187], v[28:31]
v_mfma_f32_16x16x32_bf16 v[252:255], v[220:223], v[188:191], v[28:31]
s_waitcnt lgkmcnt(0)
s_nop 0
v_mfma_f32_16x16x32_bf16 v[240:243], v[224:227], v[192:195], v[240:243]
v_mfma_f32_16x16x32_bf16 v[244:247], v[228:231], v[196:199], v[244:247]
v_mfma_f32_16x16x32_bf16 v[248:251], v[232:235], v[200:203], v[248:251]
v_mfma_f32_16x16x32_bf16 v[252:255], v[236:239], v[204:207], v[252:255]
ds_read_b64_tr_b16 v[36:37], v26 offset:320
ds_read_b64_tr_b16 v[38:39], v26 offset:840
ds_read_b64_tr_b16 v[40:41], v26 offset:360
ds_read_b64_tr_b16 v[42:43], v26 offset:880
ds_read_b64_tr_b16 v[44:45], v26 offset:400
ds_read_b64_tr_b16 v[46:47], v26 offset:920
ds_read_b64_tr_b16 v[48:49], v26 offset:440
ds_read_b64_tr_b16 v[50:51], v26 offset:960
ds_read_b64_tr_b16 v[52:53], v27 offset:352
ds_read_b64_tr_b16 v[54:55], v27 offset:872
s_cmp_lt_u32 s3, 4
s_cbranch_scc1 L48
buffer_load_dwordx4 v[116:119], v2, s[32:35], s75 offen offset:0 sc1
buffer_load_dwordx4 v[120:123], v2, s[32:35], s75 offen offset:1024 sc1
buffer_load_dwordx4 v[124:127], v2, s[32:35], s75 offen offset:2048 sc1
buffer_load_dwordx4 v[128:131], v2, s[32:35], s75 offen offset:3072 sc1
buffer_load_dwordx4 v[132:135], v18, s[32:35], s75 offen offset:0 sc1
s_mul_i32 s75, s49, 20480
s_add_u32 s75, s75, s10
s_add_u32 s75, s75, 256000
buffer_load_dwordx4 v[136:139], v2, s[32:35], s75 offen offset:0 sc1
s_branch L49
L48:
L49:
v_pk_mul_f32 v[240:241], v[240:241], v[72:73]
v_pk_mul_f32 v[242:243], v[242:243], v[74:75]
v_pk_mul_f32 v[244:245], v[244:245], v[72:73]
v_pk_mul_f32 v[246:247], v[246:247], v[74:75]
v_pk_mul_f32 v[248:249], v[248:249], v[72:73]
v_pk_mul_f32 v[250:251], v[250:251], v[74:75]
v_pk_mul_f32 v[252:253], v[252:253], v[72:73]
v_pk_mul_f32 v[254:255], v[254:255], v[74:75]
v_max3_f32 v4, v240, v241, v242
v_max3_f32 v5, v244, v245, v246
v_max3_f32 v6, v248, v249, v250
v_max3_f32 v7, v252, v253, v254
v_max_f32 v4, v4, v243
v_max_f32 v5, v5, v247
v_max_f32 v6, v6, v251
v_max_f32 v7, v7, v255
s_nop 1
v_permlane16_swap_b32 v4, v5
v_permlane16_swap_b32 v6, v7
s_nop 0
v_max_f32 v4, v4, v5
v_max_f32 v6, v6, v7
s_nop 1
v_permlane32_swap_b32 v4, v6
s_nop 0
v_max_f32 v4, v4, v6
v_mov_b32 v6, v4
s_nop 1
v_permlane32_swap_b32 v4, v6
s_nop 0
v_mov_b32 v5, v4
v_mov_b32 v7, v6
s_nop 1
v_permlane16_swap_b32 v4, v5
v_permlane16_swap_b32 v6, v7
s_nop 0
s_cmp_lt_u32 s3, 4
s_cbranch_scc1 L50
buffer_load_dwordx4 v[140:143], v2, s[32:35], s75 offen offset:1024 sc1
buffer_load_dwordx4 v[144:147], v2, s[32:35], s75 offen offset:2048 sc1
s_branch L51
L50:
L51:
v_sub_f32 v240, v240, v4
v_sub_f32 v241, v241, v4
v_sub_f32 v242, v242, v4
v_sub_f32 v243, v243, v4
v_sub_f32 v244, v244, v5
v_sub_f32 v245, v245, v5
v_sub_f32 v246, v246, v5
v_sub_f32 v247, v247, v5
v_sub_f32 v248, v248, v6
v_sub_f32 v249, v249, v6
v_sub_f32 v250, v250, v6
v_sub_f32 v251, v251, v6
v_sub_f32 v252, v252, v7
v_sub_f32 v253, v253, v7
v_sub_f32 v254, v254, v7
v_sub_f32 v255, v255, v7
v_exp_f32 v240, v240
v_exp_f32 v241, v241
v_exp_f32 v242, v242
v_exp_f32 v243, v243
v_exp_f32 v244, v244
v_exp_f32 v245, v245
v_exp_f32 v246, v246
v_exp_f32 v247, v247
v_exp_f32 v248, v248
v_exp_f32 v249, v249
v_exp_f32 v250, v250
v_exp_f32 v251, v251
v_exp_f32 v252, v252
v_exp_f32 v253, v253
v_exp_f32 v254, v254
v_exp_f32 v255, v255
s_nop 0
W_A1:
ISL_6843:
s_cbranch_execz W_RET
s_nop 0
v_add_f32 v4, v240, v241
v_add_f32 v8, v242, v243
v_add_f32 v4, v4, v8
v_add_f32 v5, v244, v245
v_add_f32 v8, v246, v247
v_add_f32 v5, v5, v8
v_add_f32 v6, v248, v249
v_add_f32 v8, v250, v251
v_add_f32 v6, v6, v8
v_add_f32 v7, v252, v253
v_add_f32 v8, v254, v255
v_add_f32 v7, v7, v8
.p2align 3
v_pk_mul_f32 v[240:241], v[240:241], v[12:13]
v_pk_mul_f32 v[242:243], v[242:243], v[14:15]
v_pk_mul_f32 v[244:245], v[244:245], v[12:13]
v_pk_mul_f32 v[246:247], v[246:247], v[14:15]
v_pk_mul_f32 v[248:249], v[248:249], v[12:13]
v_pk_mul_f32 v[250:251], v[250:251], v[14:15]
v_pk_mul_f32 v[252:253], v[252:253], v[12:13]
v_pk_mul_f32 v[254:255], v[254:255], v[14:15]
s_nop 1
v_permlane16_swap_b32 v4, v5
v_permlane16_swap_b32 v6, v7
s_nop 0
v_add_f32 v4, v4, v5
v_add_f32 v6, v6, v7
s_nop 1
v_permlane32_swap_b32 v4, v6
s_nop 0
v_add_f32 v4, v4, v6
v_mul_f32 v4, v4, v9
v_rcp_f32 v4, v4
s_nop 0
v_mov_b32 v6, v4
s_nop 1
v_permlane32_swap_b32 v4, v6
s_nop 0
v_mov_b32 v5, v4
v_mov_b32 v7, v6
s_nop 1
v_permlane16_swap_b32 v4, v5
v_permlane16_swap_b32 v6, v7
s_nop 0
v_mul_f32 v240, v240, v4
v_mul_f32 v241, v241, v4
v_mul_f32 v242, v242, v4
v_mul_f32 v243, v243, v4
v_cvt_pk_bf16_f32 v240, v240, v241
v_cvt_pk_bf16_f32 v241, v242, v243
v_and_b32 v56, v240, v32
v_and_b32 v57, v241, v32
v_and_b32 v58, v240, v33
v_and_b32 v59, v241, v33
v_mul_f32 v244, v244, v5
v_mul_f32 v245, v245, v5
v_mul_f32 v246, v246, v5
v_mul_f32 v247, v247, v5
v_cvt_pk_bf16_f32 v244, v244, v245
v_cvt_pk_bf16_f32 v245, v246, v247
v_and_b32 v60, v244, v32
v_and_b32 v61, v245, v32
v_and_b32 v62, v244, v33
v_and_b32 v63, v245, v33
v_mul_f32 v248, v248, v6
v_mul_f32 v249, v249, v6
v_mul_f32 v250, v250, v6
v_mul_f32 v251, v251, v6
v_cvt_pk_bf16_f32 v248, v248, v249
v_cvt_pk_bf16_f32 v249, v250, v251
v_and_b32 v64, v248, v32
v_and_b32 v65, v249, v32
v_and_b32 v66, v248, v33
v_and_b32 v67, v249, v33
v_mul_f32 v252, v252, v7
v_mul_f32 v253, v253, v7
v_mul_f32 v254, v254, v7
v_mul_f32 v255, v255, v7
v_cvt_pk_bf16_f32 v252, v252, v253
v_cvt_pk_bf16_f32 v253, v254, v255
v_and_b32 v68, v252, v32
v_and_b32 v69, v253, v32
v_and_b32 v70, v252, v33
v_and_b32 v71, v253, v33
s_waitcnt lgkmcnt(0)
s_nop 0
v_mfma_f32_16x16x32_bf16 v[176:179], v[36:39], v[56:59], 0
v_mfma_f32_16x16x32_bf16 v[180:183], v[40:43], v[60:63], 0
v_mfma_f32_16x16x32_bf16 v[184:187], v[44:47], v[64:67], 0
v_mfma_f32_16x16x32_bf16 v[188:191], v[48:51], v[68:71], 0
v_mfma_f32_16x16x32_bf16 v[192:195], v[52:55], v[56:59], 0
v_mfma_f32_16x16x32_bf16 v[196:199], v[52:55], v[60:63], 0
v_mfma_f32_16x16x32_bf16 v[200:203], v[52:55], v[64:67], 0
v_mfma_f32_16x16x32_bf16 v[204:207], v[52:55], v[68:71], 0
s_nop 3
v_cvt_pk_bf16_f32 v208, v176, v177
v_cvt_pk_bf16_f32 v209, v178, v179
v_cvt_pk_bf16_f32 v210, v180, v181
v_cvt_pk_bf16_f32 v211, v182, v183
buffer_store_dwordx4 v[208:211], v2, s[32:35], s62 offen sc1
v_cvt_pk_bf16_f32 v212, v184, v185
v_cvt_pk_bf16_f32 v213, v186, v187
v_cvt_pk_bf16_f32 v214, v188, v189
v_cvt_pk_bf16_f32 v215, v190, v191
buffer_store_dwordx4 v[212:215], v2, s[32:35], s63 offen sc1
v_cndmask_b32_e64 v192, v192, v196, s[66:67]
v_cndmask_b32_e64 v193, v193, v197, s[66:67]
v_cndmask_b32_e64 v194, v194, v198, s[66:67]
v_cndmask_b32_e64 v195, v195, v199, s[66:67]
v_cndmask_b32_e64 v192, v192, v200, s[68:69]
v_cndmask_b32_e64 v193, v193, v201, s[68:69]
v_cndmask_b32_e64 v194, v194, v202, s[68:69]
v_cndmask_b32_e64 v195, v195, v203, s[68:69]
v_cndmask_b32_e64 v192, v192, v204, s[70:71]
v_cndmask_b32_e64 v193, v193, v205, s[70:71]
v_cndmask_b32_e64 v194, v194, v206, s[70:71]
v_cndmask_b32_e64 v195, v195, v207, s[70:71]
v_cvt_pk_bf16_f32 v216, v192, v193
v_cvt_pk_bf16_f32 v217, v194, v195
v_mov_b32 v218, v216
v_mov_b32 v219, v217
s_nop 1
v_permlane16_swap_b32 v216, v218
v_permlane16_swap_b32 v217, v219
s_nop 0
buffer_store_dwordx4 v[216:219], v16, s[32:35], s61 offen sc1
v_add_lshl_u32 v6, v0, s3, 25
s_waitcnt vmcnt(0)
s_barrier
buffer_store_dwordx2 v[34:35], v6, s[32:35], s54 offen sc1
s_cmp_ge_u32 s3, 4
s_cbranch_scc1 L52
buffer_load_dwordx4 v[92:95], v18, s[32:35], s75 offen offset:0 sc1
s_mul_i32 s75, s49, 61440
s_add_u32 s75, s75, s10
s_add_u32 s75, s75, 25600
buffer_load_dwordx4 v[96:99], v2, s[32:35], s75 offen offset:0 sc1
buffer_load_dwordx4 v[100:103], v2, s[32:35], s75 offen offset:1024 sc1
buffer_load_dwordx4 v[104:107], v2, s[32:35], s75 offen offset:2048 sc1
buffer_load_dwordx4 v[108:111], v2, s[32:35], s75 offen offset:3072 sc1
buffer_load_dwordx4 v[112:115], v18, s[32:35], s75 offen offset:0 sc1
s_mul_i32 s75, s49, 61440
s_add_u32 s75, s75, s10
s_add_u32 s75, s75, 30720
buffer_load_dwordx4 v[116:119], v2, s[32:35], s75 offen offset:0 sc1
buffer_load_dwordx4 v[120:123], v2, s[32:35], s75 offen offset:1024 sc1
buffer_load_dwordx4 v[124:127], v2, s[32:35], s75 offen offset:2048 sc1
buffer_load_dwordx4 v[128:131], v2, s[32:35], s75 offen offset:3072 sc1
buffer_load_dwordx4 v[132:135], v18, s[32:35], s75 offen offset:0 sc1
s_branch P2_CQ
L52:
buffer_load_dwordx4 v[148:151], v2, s[32:35], s75 offen offset:3072 sc1
buffer_load_dwordx4 v[152:155], v18, s[32:35], s75 offen offset:0 sc1
s_mul_i32 s75, s49, 20480
s_add_u32 s75, s75, s10
s_add_u32 s75, s75, 261120
buffer_load_dwordx4 v[156:159], v2, s[32:35], s75 offen offset:0 sc1
buffer_load_dwordx4 v[160:163], v2, s[32:35], s75 offen offset:1024 sc1
buffer_load_dwordx4 v[164:167], v2, s[32:35], s75 offen offset:2048 sc1
buffer_load_dwordx4 v[168:171], v2, s[32:35], s75 offen offset:3072 sc1
buffer_load_dwordx4 v[172:175], v18, s[32:35], s75 offen offset:0 sc1
v_mov_b32 v14, 0
v_mov_b32 v15, 0
s_lshr_b32 s73, s47, 1
s_lshl2_add_u32 s73, s73, s49
W_A2:
W_A3:
ISL_7008:
s_cbranch_execz W_RET
s_nop 0
s_lshl_b32 s73, s73, 8
s_add_u32 s73, s73, 23134208
v_and_b32 v13, 1, v0
v_lshlrev_b32 v13, 7, v13
v_add_u32 v11, s55, v2
s_mov_b64 s[40:41], s[18:19]
s_mov_b32 s42, 2621440
s_mov_b32 s43, 0x20000
s_lshl_b32 s72, s47, 6
s_lshl3_add_u32 s72, s3, s72
s_lshl3_add_u32 s60, s72, 20971524
s_mul_i32 s72, s72, 1280
s_mul_i32 s70, s48, 160
s_add_u32 s70, s70, s72
v_add_u32 v16, 0, v0
v_mul_u32_u24 v17, 3277, v16
v_lshrrev_b32 v17, 16, v17
v_mul_u32_u24 v19, 20, v17
v_sub_u32 v16, v16, v19
v_lshlrev_b32 v1, 3, v17
v_bfe_u32 v19, v17, 1, 2
v_xor_b32 v16, v16, v19
v_mul_u32_u24 v17, 1280, v17
v_lshl_add_u32 v4, v16, 3, v17
v_add_u32 v16, 64, v0
v_mul_u32_u24 v17, 3277, v16
v_lshrrev_b32 v17, 16, v17
v_mul_u32_u24 v19, 20, v17
v_sub_u32 v16, v16, v19
v_lshlrev_b32 v3, 3, v17
v_bfe_u32 v19, v17, 1, 2
v_xor_b32 v16, v16, v19
v_mul_u32_u24 v17, 1280, v17
v_lshl_add_u32 v5, v16, 3, v17
v_add_u32 v16, 128, v0
v_mul_u32_u24 v17, 3277, v16
v_lshrrev_b32 v17, 16, v17
v_mul_u32_u24 v19, 20, v17
v_sub_u32 v16, v16, v19
v_lshlrev_b32 v75, 3, v17
v_bfe_u32 v19, v17, 1, 2
v_xor_b32 v16, v16, v19
v_mul_u32_u24 v17, 1280, v17
v_lshl_add_u32 v6, v16, 3, v17
v_lshrrev_b32 v16, 5, v0
v_lshl_add_u32 v6, v16, 26, v6
v_and_b32 v16, 15, v0
v_lshrrev_b32 v17, 4, v0
v_bfe_u32 v19, v0, 1, 2
v_xor_b32 v17, v17, v19
v_mul_u32_u24 v16, 320, v16
v_lshl_add_u32 v16, v17, 4, v16
v_add_u32 v7, s55, v16
s_mul_i32 s72, s3, 2560
v_add_u32 v8, s72, v2
v_add_u32 v9, 61440, v8
v_add_u32 v10, 122880, v8
s_lshl2_add_u32 s71, s47, s49
s_lshl_b32 s71, s71, 9
s_add_u32 s71, s71, 23068672
v_and_b32 v12, 3, v0
v_lshlrev_b32 v12, 7, v12
s_mul_i32 s72, s47, 278528
s_mul_i32 s61, s49, 4096
s_add_u32 s61, s61, s72
s_add_u32 s61, s61, 262144
s_mul_i32 s62, s49, 16384
s_add_u32 s62, s62, s72
s_add_u32 s62, s62, 196608
s_mul_i32 s63, s49, 16384
s_add_u32 s63, s63, s72
s_add_u32 s63, s63, 200704
s_mul_i32 s64, s49, 16384
s_add_u32 s64, s64, s72
s_add_u32 s64, s64, 204800
s_mul_i32 s65, s49, 16384
s_add_u32 s65, s65, s72
s_add_u32 s65, s65, 208896
s_mul_i32 s66, s49, 49152
s_add_u32 s66, s66, s72
s_add_u32 s66, s66, 36864
s_mul_i32 s67, s49, 49152
s_add_u32 s67, s67, s72
s_add_u32 s67, s67, 40960
s_mul_i32 s68, s49, 49152
s_add_u32 s68, s68, s72
s_add_u32 s68, s68, 45056
P2_LQ:
s_setprio 0
s_mov_b32 s79, 0
L53:
v_cmp_ne_u64 vcc, s[0:1], v[14:15]
s_nop 4
s_cbranch_vccz L54
s_addk_i32 s79, 1
s_cmp_ge_u32 s79, 200000
s_cbranch_scc1 L54
s_sleep 2
buffer_load_dwordx2 v[14:15], v13, s[32:35], s73 offen sc1
s_waitcnt vmcnt(0)
s_branch L53
L54:
buffer_load_dwordx4 v[20:23], v2, s[32:35], s61 offen offset:0 sc1
buffer_load_dwordx4 v[24:27], v2, s[32:35], s61 offen offset:1024 sc1
buffer_load_dwordx4 v[28:31], v2, s[32:35], s61 offen offset:2048 sc1
buffer_load_dwordx4 v[32:35], v2, s[32:35], s61 offen offset:3072 sc1
.p2align 3
s_waitcnt vmcnt(3) lgkmcnt(0)
s_nop 0
v_mfma_f32_16x16x32_bf16 v[176:179], v[76:79], v[20:23], 0
buffer_load_dwordx4 v[36:39], v2, s[32:35], s62 offen offset:0 sc1
v_mfma_f32_16x16x32_bf16 v[180:183], v[80:83], v[20:23], 0
buffer_load_dwordx4 v[40:43], v2, s[32:35], s62 offen offset:1024 sc1
v_mfma_f32_16x16x32_bf16 v[184:187], v[84:87], v[20:23], 0
s_mul_i32 s74, s49, 61440
s_add_u32 s74, s74, s10
s_add_u32 s74, s74, 46080
.p2align 3
v_mfma_f32_16x16x32_bf16 v[188:191], v[88:91], v[20:23], 0
s_bitcmp0_b32 s2, 3
s_cbranch_scc1 L55
s_add_u32 m0, s55, 0
s_nop 0
.p2align 3
buffer_load_dwordx4 v2, s[32:35], s74 offen offset:0 sc1 lds
L55:
v_mfma_f32_16x16x32_bf16 v[192:195], v[92:95], v[20:23], 0
s_bitcmp0_b32 s2, 3
s_cbranch_scc1 L56
s_add_u32 m0, s55, 0
s_nop 0
.p2align 3
buffer_load_dwordx4 v2, s[32:35], s74 offen offset:1024 sc1 lds
L56:
s_waitcnt vmcnt(4)
s_nop 0
v_mfma_f32_16x16x32_bf16 v[196:199], v[76:79], v[24:27], 0
buffer_load_dwordx4 v[44:47], v2, s[32:35], s62 offen offset:2048 sc1
v_mfma_f32_16x16x32_bf16 v[200:203], v[80:83], v[24:27], 0
buffer_load_dwordx4 v[48:51], v2, s[32:35], s62 offen offset:3072 sc1
v_mfma_f32_16x16x32_bf16 v[204:207], v[84:87], v[24:27], 0
v_mfma_f32_16x16x32_bf16 v[208:211], v[88:91], v[24:27], 0
s_bitcmp0_b32 s2, 3
s_cbranch_scc1 L57
s_add_u32 m0, s55, 0
s_nop 0
.p2align 3
buffer_load_dwordx4 v2, s[32:35], s74 offen offset:2048 sc1 lds
L57:
v_mfma_f32_16x16x32_bf16 v[212:215], v[92:95], v[24:27], 0
s_bitcmp0_b32 s2, 3
s_cbranch_scc1 L58
s_add_u32 m0, s55, 0
s_nop 0
.p2align 3
buffer_load_dwordx4 v2, s[32:35], s74 offen offset:3072 sc1 lds
L58:
s_waitcnt vmcnt(5)
s_nop 0
v_mfma_f32_16x16x32_bf16 v[216:219], v[76:79], v[28:31], 0
buffer_load_dwordx4 v[52:55], v2, s[32:35], s63 offen offset:0 sc1
v_mfma_f32_16x16x32_bf16 v[220:223], v[80:83], v[28:31], 0
v_mfma_f32_16x16x32_bf16 v[224:227], v[84:87], v[28:31], 0
buffer_load_dwordx4 v[56:59], v2, s[32:35], s63 offen offset:1024 sc1
v_mfma_f32_16x16x32_bf16 v[228:231], v[88:91], v[28:31], 0
v_mfma_f32_16x16x32_bf16 v[232:235], v[92:95], v[28:31], 0
s_bitcmp0_b32 s2, 3
s_cbranch_scc1 L59
s_add_u32 m0, s55, 4096
s_nop 0
.p2align 3
buffer_load_dwordx4 v18, s[32:35], s74 offen offset:0 sc1 lds
L59:
s_waitcnt vmcnt(6)
s_nop 0
v_mfma_f32_16x16x32_bf16 v[236:239], v[76:79], v[32:35], 0
buffer_load_dwordx4 v[60:63], v2, s[32:35], s63 offen offset:2048 sc1
v_mfma_f32_16x16x32_bf16 v[240:243], v[80:83], v[32:35], 0
v_mfma_f32_16x16x32_bf16 v[244:247], v[84:87], v[32:35], 0
v_mfma_f32_16x16x32_bf16 v[248:251], v[88:91], v[32:35], 0
v_mfma_f32_16x16x32_bf16 v[252:255], v[92:95], v[32:35], 0
s_waitcnt vmcnt(6)
s_nop 0
v_mfma_f32_16x16x32_bf16 v[176:179], v[96:99], v[36:39], v[176:179]
buffer_load_dwordx4 v[64:67], v2, s[32:35], s63 offen offset:3072 sc1
v_mfma_f32_16x16x32_bf16 v[180:183], v[100:103], v[36:39], v[180:183]
s_mul_i32 s74, s49, 61440
s_add_u32 s74, s74, s10
s_add_u32 s74, s74, 51200
.p2align 3
v_mfma_f32_16x16x32_bf16 v[184:187], v[104:107], v[36:39], v[184:187]
v_mfma_f32_16x16x32_bf16 v[188:191], v[108:111], v[36:39], v[188:191]
s_bitcmp0_b32 s2, 3
s_cbranch_scc1 L60
s_add_u32 m0, s55, 5120
s_nop 0
.p2align 3
buffer_load_dwordx4 v2, s[32:35], s74 offen offset:0 sc1 lds
L60:
v_mfma_f32_16x16x32_bf16 v[192:195], v[112:115], v[36:39], v[192:195]
s_bitcmp0_b32 s2, 3
s_cbranch_scc1 L61
s_add_u32 m0, s55, 5120
s_nop 0
.p2align 3
buffer_load_dwordx4 v2, s[32:35], s74 offen offset:1024 sc1 lds
L61:
s_waitcnt vmcnt(6)
s_nop 0
v_mfma_f32_16x16x32_bf16 v[196:199], v[96:99], v[40:43], v[196:199]
buffer_load_dwordx4 v[20:23], v2, s[32:35], s64 offen offset:0 sc1
v_mfma_f32_16x16x32_bf16 v[200:203], v[100:103], v[40:43], v[200:203]
v_mfma_f32_16x16x32_bf16 v[204:207], v[104:107], v[40:43], v[204:207]
s_bitcmp0_b32 s2, 3
s_cbranch_scc1 L62
s_add_u32 m0, s55, 5120
s_nop 0
.p2align 3
buffer_load_dwordx4 v2, s[32:35], s74 offen offset:2048 sc1 lds
L62:
v_mfma_f32_16x16x32_bf16 v[208:211], v[108:111], v[40:43], v[208:211]
v_mfma_f32_16x16x32_bf16 v[212:215], v[112:115], v[40:43], v[212:215]
s_bitcmp0_b32 s2, 3
s_cbranch_scc1 L63
s_add_u32 m0, s55, 5120
s_nop 0
.p2align 3
buffer_load_dwordx4 v2, s[32:35], s74 offen offset:3072 sc1 lds
L63:
s_waitcnt vmcnt(6)
s_nop 0
v_mfma_f32_16x16x32_bf16 v[216:219], v[96:99], v[44:47], v[216:219]
v_mfma_f32_16x16x32_bf16 v[220:223], v[100:103], v[44:47], v[220:223]
buffer_load_dwordx4 v[24:27], v2, s[32:35], s64 offen offset:1024 sc1
v_mfma_f32_16x16x32_bf16 v[224:227], v[104:107], v[44:47], v[224:227]
v_mfma_f32_16x16x32_bf16 v[228:231], v[108:111], v[44:47], v[228:231]
s_bitcmp0_b32 s2, 3
s_cbranch_scc1 L64
s_add_u32 m0, s55, 9216
s_nop 0
.p2align 3
buffer_load_dwordx4 v18, s[32:35], s74 offen offset:0 sc1 lds
L64:
v_mfma_f32_16x16x32_bf16 v[232:235], v[112:115], v[44:47], v[232:235]
s_waitcnt vmcnt(6)
s_nop 0
v_mfma_f32_16x16x32_bf16 v[236:239], v[96:99], v[48:51], v[236:239]
buffer_load_dwordx4 v[28:31], v2, s[32:35], s64 offen offset:2048 sc1
v_mfma_f32_16x16x32_bf16 v[240:243], v[100:103], v[48:51], v[240:243]
v_mfma_f32_16x16x32_bf16 v[244:247], v[104:107], v[48:51], v[244:247]
v_mfma_f32_16x16x32_bf16 v[248:251], v[108:111], v[48:51], v[248:251]
v_mfma_f32_16x16x32_bf16 v[252:255], v[112:115], v[48:51], v[252:255]
s_waitcnt vmcnt(6)
s_nop 0
v_mfma_f32_16x16x32_bf16 v[176:179], v[116:119], v[52:55], v[176:179]
buffer_load_dwordx4 v[32:35], v2, s[32:35], s64 offen offset:3072 sc1
v_mfma_f32_16x16x32_bf16 v[180:183], v[120:123], v[52:55], v[180:183]
buffer_load_dwordx2 v[14:15], v12, s[32:35], s71 offen sc1
v_mfma_f32_16x16x32_bf16 v[184:187], v[124:127], v[52:55], v[184:187]
v_mfma_f32_16x16x32_bf16 v[188:191], v[128:131], v[52:55], v[188:191]
s_mul_i32 s74, s49, 61440
s_add_u32 s74, s74, s10
s_add_u32 s74, s74, 56320
.p2align 3
v_mfma_f32_16x16x32_bf16 v[192:195], v[132:135], v[52:55], v[192:195]
s_add_u32 m0, s55, 10240
s_nop 0
.p2align 3
buffer_load_dwordx4 v2, s[32:35], s74 offen offset:0 sc1 lds
s_waitcnt vmcnt(8)
s_nop 0
v_mfma_f32_16x16x32_bf16 v[196:199], v[116:119], v[56:59], v[196:199]
buffer_load_dwordx4 v[36:39], v2, s[32:35], s65 offen offset:0 sc1
v_mfma_f32_16x16x32_bf16 v[200:203], v[120:123], v[56:59], v[200:203]
v_mfma_f32_16x16x32_bf16 v[204:207], v[124:127], v[56:59], v[204:207]
s_add_u32 m0, s55, 10240
s_nop 0
.p2align 3
buffer_load_dwordx4 v2, s[32:35], s74 offen offset:1024 sc1 lds
v_mfma_f32_16x16x32_bf16 v[208:211], v[128:131], v[56:59], v[208:211]
v_mfma_f32_16x16x32_bf16 v[212:215], v[132:135], v[56:59], v[212:215]
s_add_u32 m0, s55, 10240
s_nop 0
.p2align 3
buffer_load_dwordx4 v2, s[32:35], s74 offen offset:2048 sc1 lds
s_waitcnt vmcnt(10)
s_nop 0
v_mfma_f32_16x16x32_bf16 v[216:219], v[116:119], v[60:63], v[216:219]
buffer_load_dwordx4 v[40:43], v2, s[32:35], s65 offen offset:1024 sc1
v_mfma_f32_16x16x32_bf16 v[220:223], v[120:123], v[60:63], v[220:223]
v_mfma_f32_16x16x32_bf16 v[224:227], v[124:127], v[60:63], v[224:227]
s_add_u32 m0, s55, 10240
s_nop 0
.p2align 3
buffer_load_dwordx4 v2, s[32:35], s74 offen offset:3072 sc1 lds
v_mfma_f32_16x16x32_bf16 v[228:231], v[128:131], v[60:63], v[228:231]
v_mfma_f32_16x16x32_bf16 v[232:235], v[132:135], v[60:63], v[232:235]
s_add_u32 m0, s55, 14336
s_nop 0
.p2align 3
buffer_load_dwordx4 v18, s[32:35], s74 offen offset:0 sc1 lds
s_waitcnt vmcnt(12)
s_nop 0
v_mfma_f32_16x16x32_bf16 v[236:239], v[116:119], v[64:67], v[236:239]
buffer_load_dwordx4 v[44:47], v2, s[32:35], s65 offen offset:2048 sc1
v_mfma_f32_16x16x32_bf16 v[240:243], v[120:123], v[64:67], v[240:243]
v_mfma_f32_16x16x32_bf16 v[244:247], v[124:127], v[64:67], v[244:247]
v_mfma_f32_16x16x32_bf16 v[248:251], v[128:131], v[64:67], v[248:251]
v_mfma_f32_16x16x32_bf16 v[252:255], v[132:135], v[64:67], v[252:255]
s_waitcnt vmcnt(12)
s_nop 0
v_mfma_f32_16x16x32_bf16 v[176:179], v[136:139], v[20:23], v[176:179]
buffer_load_dwordx4 v[48:51], v2, s[32:35], s65 offen offset:3072 sc1
v_mfma_f32_16x16x32_bf16 v[180:183], v[140:143], v[20:23], v[180:183]
ds_read_b128 v[76:79], v11 offset:0
v_mfma_f32_16x16x32_bf16 v[184:187], v[144:147], v[20:23], v[184:187]
ds_read_b128 v[80:83], v11 offset:1024
ds_read_b128 v[84:87], v11 offset:2048
v_mfma_f32_16x16x32_bf16 v[188:191], v[148:151], v[20:23], v[188:191]
ds_read_b128 v[88:91], v11 offset:3072
v_mfma_f32_16x16x32_bf16 v[192:195], v[152:155], v[20:23], v[192:195]
ds_read_b128 v[92:95], v11 offset:4096
s_waitcnt vmcnt(9)
s_mov_b32 s79, 0
L65:
v_cmp_ne_u64 vcc, s[0:1], v[14:15]
s_nop 4
s_cbranch_vccz L66
s_addk_i32 s79, 1
s_cmp_ge_u32 s79, 200000
s_cbranch_scc1 L66
s_sleep 2
buffer_load_dwordx2 v[14:15], v12, s[32:35], s71 offen sc1
s_waitcnt vmcnt(0)
s_branch L65
L66:
.p2align 3
s_waitcnt vmcnt(12)
s_nop 0
v_mfma_f32_16x16x32_bf16 v[196:199], v[136:139], v[24:27], v[196:199]
buffer_load_dwordx4 v[52:55], v2, s[32:35], s66 offen offset:0 sc1
v_mfma_f32_16x16x32_bf16 v[200:203], v[140:143], v[24:27], v[200:203]
v_mfma_f32_16x16x32_bf16 v[204:207], v[144:147], v[24:27], v[204:207]
v_mfma_f32_16x16x32_bf16 v[208:211], v[148:151], v[24:27], v[208:211]
v_mfma_f32_16x16x32_bf16 v[212:215], v[152:155], v[24:27], v[212:215]

v_mfma_f32_16x16x32_bf16 v[216:219], v[136:139], v[28:31], v[216:219]
buffer_load_dwordx4 v[56:59], v2, s[32:35], s67 offen offset:0 sc1
v_mfma_f32_16x16x32_bf16 v[220:223], v[140:143], v[28:31], v[220:223]
v_mfma_f32_16x16x32_bf16 v[224:227], v[144:147], v[28:31], v[224:227]
v_mfma_f32_16x16x32_bf16 v[228:231], v[148:151], v[28:31], v[228:231]
v_mfma_f32_16x16x32_bf16 v[232:235], v[152:155], v[28:31], v[232:235]

v_mfma_f32_16x16x32_bf16 v[236:239], v[136:139], v[32:35], v[236:239]
buffer_load_dwordx4 v[60:63], v2, s[32:35], s68 offen offset:0 sc1
v_mfma_f32_16x16x32_bf16 v[240:243], v[140:143], v[32:35], v[240:243]
v_mfma_f32_16x16x32_bf16 v[244:247], v[144:147], v[32:35], v[244:247]
v_mfma_f32_16x16x32_bf16 v[248:251], v[148:151], v[32:35], v[248:251]
v_mfma_f32_16x16x32_bf16 v[252:255], v[152:155], v[32:35], v[252:255]
s_waitcnt vmcnt(5) lgkmcnt(0)
s_nop 0
v_mfma_f32_16x16x32_bf16 v[176:179], v[156:159], v[36:39], v[176:179]
buffer_load_dwordx4 v[64:67], v2, s[32:35], s66 offen offset:1024 sc1
ds_read_b128 v[96:99], v11 offset:5120
ds_read_b128 v[100:103], v11 offset:6144
v_mfma_f32_16x16x32_bf16 v[180:183], v[160:163], v[36:39], v[180:183]
ds_read_b128 v[104:107], v11 offset:7168
ds_read_b128 v[108:111], v11 offset:8192
v_mfma_f32_16x16x32_bf16 v[184:187], v[164:167], v[36:39], v[184:187]
ds_read_b128 v[112:115], v11 offset:9216
ds_read_b128 v[116:119], v11 offset:10240
ds_read_b128 v[120:123], v11 offset:11264
v_mfma_f32_16x16x32_bf16 v[188:191], v[168:171], v[36:39], v[188:191]
ds_read_b128 v[124:127], v11 offset:12288
ds_read_b128 v[128:131], v11 offset:13312
v_mfma_f32_16x16x32_bf16 v[192:195], v[172:175], v[36:39], v[192:195]
ds_read_b128 v[132:135], v11 offset:14336
buffer_load_dwordx2 v[68:69], v4, s[24:27], s70 offen
buffer_load_dwordx2 v[70:71], v5, s[24:27], s70 offen

v_mfma_f32_16x16x32_bf16 v[196:199], v[156:159], v[40:43], v[196:199]
buffer_load_dwordx4 v[20:23], v2, s[32:35], s67 offen offset:1024 sc1
v_mfma_f32_16x16x32_bf16 v[200:203], v[160:163], v[40:43], v[200:203]
v_mfma_f32_16x16x32_bf16 v[204:207], v[164:167], v[40:43], v[204:207]
buffer_load_dwordx2 v[72:73], v6, s[24:27], s70 offen
v_mfma_f32_16x16x32_bf16 v[208:211], v[168:171], v[40:43], v[208:211]
v_mfma_f32_16x16x32_bf16 v[212:215], v[172:175], v[40:43], v[212:215]
buffer_load_dword v1, v1, s[32:35], s60 offen sc1
s_waitcnt vmcnt(10)
s_nop 0
v_mfma_f32_16x16x32_bf16 v[216:219], v[156:159], v[44:47], v[216:219]
buffer_load_dwordx4 v[24:27], v2, s[32:35], s68 offen offset:1024 sc1
v_mfma_f32_16x16x32_bf16 v[220:223], v[160:163], v[44:47], v[220:223]
v_mfma_f32_16x16x32_bf16 v[224:227], v[164:167], v[44:47], v[224:227]
buffer_load_dword v3, v3, s[32:35], s60 offen sc1
v_mfma_f32_16x16x32_bf16 v[228:231], v[168:171], v[44:47], v[228:231]
v_mfma_f32_16x16x32_bf16 v[232:235], v[172:175], v[44:47], v[232:235]
buffer_load_dword v75, v75, s[32:35], s60 offen sc1
s_waitcnt vmcnt(12)
s_nop 0
v_mfma_f32_16x16x32_bf16 v[236:239], v[156:159], v[48:51], v[236:239]
buffer_load_dwordx4 v[28:31], v2, s[32:35], s66 offen offset:2048 sc1
v_mfma_f32_16x16x32_bf16 v[240:243], v[160:163], v[48:51], v[240:243]
v_mfma_f32_16x16x32_bf16 v[244:247], v[164:167], v[48:51], v[244:247]
v_mfma_f32_16x16x32_bf16 v[248:251], v[168:171], v[48:51], v[248:251]
v_mfma_f32_16x16x32_bf16 v[252:255], v[172:175], v[48:51], v[252:255]
s_waitcnt vmcnt(12) lgkmcnt(0)
s_nop 0
v_mfma_f32_16x16x32_bf16 v[176:179], v[76:79], v[52:55], v[176:179]
buffer_load_dwordx4 v[32:35], v2, s[32:35], s67 offen offset:2048 sc1
v_mfma_f32_16x16x32_bf16 v[180:183], v[80:83], v[52:55], v[180:183]
v_mfma_f32_16x16x32_bf16 v[184:187], v[84:87], v[52:55], v[184:187]
v_mfma_f32_16x16x32_bf16 v[188:191], v[88:91], v[52:55], v[188:191]
v_mfma_f32_16x16x32_bf16 v[192:195], v[92:95], v[52:55], v[192:195]
s_waitcnt vmcnt(12)
s_nop 0
v_mfma_f32_16x16x32_bf16 v[176:179], v[96:99], v[56:59], v[176:179]
buffer_load_dwordx4 v[36:39], v2, s[32:35], s68 offen offset:2048 sc1
v_mfma_f32_16x16x32_bf16 v[180:183], v[100:103], v[56:59], v[180:183]
v_mfma_f32_16x16x32_bf16 v[184:187], v[104:107], v[56:59], v[184:187]
v_mfma_f32_16x16x32_bf16 v[188:191], v[108:111], v[56:59], v[188:191]
v_mfma_f32_16x16x32_bf16 v[192:195], v[112:115], v[56:59], v[192:195]
s_waitcnt vmcnt(12)
s_nop 0
v_mfma_f32_16x16x32_bf16 v[176:179], v[116:119], v[60:63], v[176:179]
buffer_load_dwordx4 v[40:43], v2, s[32:35], s66 offen offset:3072 sc1
v_mfma_f32_16x16x32_bf16 v[180:183], v[120:123], v[60:63], v[180:183]
v_mfma_f32_16x16x32_bf16 v[184:187], v[124:127], v[60:63], v[184:187]
v_mfma_f32_16x16x32_bf16 v[188:191], v[128:131], v[60:63], v[188:191]
v_mfma_f32_16x16x32_bf16 v[192:195], v[132:135], v[60:63], v[192:195]
s_waitcnt vmcnt(12)
s_nop 0
v_mfma_f32_16x16x32_bf16 v[196:199], v[76:79], v[64:67], v[196:199]
buffer_load_dwordx4 v[44:47], v2, s[32:35], s67 offen offset:3072 sc1
v_mfma_f32_16x16x32_bf16 v[200:203], v[80:83], v[64:67], v[200:203]
v_mfma_f32_16x16x32_bf16 v[204:207], v[84:87], v[64:67], v[204:207]
v_mfma_f32_16x16x32_bf16 v[208:211], v[88:91], v[64:67], v[208:211]
v_mfma_f32_16x16x32_bf16 v[212:215], v[92:95], v[64:67], v[212:215]
s_waitcnt vmcnt(10)
s_nop 0
v_mfma_f32_16x16x32_bf16 v[196:199], v[96:99], v[20:23], v[196:199]
buffer_load_dwordx4 v[48:51], v2, s[32:35], s68 offen offset:3072 sc1
v_mfma_f32_16x16x32_bf16 v[200:203], v[100:103], v[20:23], v[200:203]
ds_write_b128 v7, v[176:179] offset:0
v_mfma_f32_16x16x32_bf16 v[204:207], v[104:107], v[20:23], v[204:207]
v_mfma_f32_16x16x32_bf16 v[208:211], v[108:111], v[20:23], v[208:211]
ds_write_b128 v7, v[180:183] offset:64
v_mfma_f32_16x16x32_bf16 v[212:215], v[112:115], v[20:23], v[212:215]
s_waitcnt vmcnt(8)
s_nop 0
v_mfma_f32_16x16x32_bf16 v[196:199], v[116:119], v[24:27], v[196:199]
v_mfma_f32_16x16x32_bf16 v[200:203], v[120:123], v[24:27], v[200:203]
ds_write_b128 v7, v[184:187] offset:128
v_mfma_f32_16x16x32_bf16 v[204:207], v[124:127], v[24:27], v[204:207]
v_mfma_f32_16x16x32_bf16 v[208:211], v[128:131], v[24:27], v[208:211]
ds_write_b128 v7, v[188:191] offset:192
v_mfma_f32_16x16x32_bf16 v[212:215], v[132:135], v[24:27], v[212:215]
s_waitcnt vmcnt(5)
s_nop 0
v_mfma_f32_16x16x32_bf16 v[216:219], v[76:79], v[28:31], v[216:219]
v_mfma_f32_16x16x32_bf16 v[220:223], v[80:83], v[28:31], v[220:223]
v_mfma_f32_16x16x32_bf16 v[224:227], v[84:87], v[28:31], v[224:227]
ds_write_b128 v7, v[192:195] offset:256
v_mfma_f32_16x16x32_bf16 v[228:231], v[88:91], v[28:31], v[228:231]
v_mfma_f32_16x16x32_bf16 v[232:235], v[92:95], v[28:31], v[232:235]
s_waitcnt vmcnt(4)
s_nop 0
v_mfma_f32_16x16x32_bf16 v[216:219], v[96:99], v[32:35], v[216:219]
v_mfma_f32_16x16x32_bf16 v[220:223], v[100:103], v[32:35], v[220:223]
ds_write_b128 v7, v[196:199] offset:5120
v_mfma_f32_16x16x32_bf16 v[224:227], v[104:107], v[32:35], v[224:227]
v_mfma_f32_16x16x32_bf16 v[228:231], v[108:111], v[32:35], v[228:231]
ds_write_b128 v7, v[200:203] offset:5184
v_mfma_f32_16x16x32_bf16 v[232:235], v[112:115], v[32:35], v[232:235]
s_waitcnt vmcnt(3)
s_nop 0
v_mfma_f32_16x16x32_bf16 v[216:219], v[116:119], v[36:39], v[216:219]
v_mfma_f32_16x16x32_bf16 v[220:223], v[120:123], v[36:39], v[220:223]
ds_write_b128 v7, v[204:207] offset:5248
v_mfma_f32_16x16x32_bf16 v[224:227], v[124:127], v[36:39], v[224:227]
v_mfma_f32_16x16x32_bf16 v[228:231], v[128:131], v[36:39], v[228:231]
ds_write_b128 v7, v[208:211] offset:5312
v_mfma_f32_16x16x32_bf16 v[232:235], v[132:135], v[36:39], v[232:235]
s_waitcnt vmcnt(2)
s_nop 0
v_mfma_f32_16x16x32_bf16 v[236:239], v[76:79], v[40:43], v[236:239]
v_mfma_f32_16x16x32_bf16 v[240:243], v[80:83], v[40:43], v[240:243]
v_mfma_f32_16x16x32_bf16 v[244:247], v[84:87], v[40:43], v[244:247]
ds_write_b128 v7, v[212:215] offset:5376
v_mfma_f32_16x16x32_bf16 v[248:251], v[88:91], v[40:43], v[248:251]
v_mfma_f32_16x16x32_bf16 v[252:255], v[92:95], v[40:43], v[252:255]
s_waitcnt vmcnt(1)
s_nop 0
v_mfma_f32_16x16x32_bf16 v[236:239], v[96:99], v[44:47], v[236:239]
v_mfma_f32_16x16x32_bf16 v[240:243], v[100:103], v[44:47], v[240:243]
ds_write_b128 v7, v[216:219] offset:10240
v_mfma_f32_16x16x32_bf16 v[244:247], v[104:107], v[44:47], v[244:247]
v_mfma_f32_16x16x32_bf16 v[248:251], v[108:111], v[44:47], v[248:251]
ds_write_b128 v7, v[220:223] offset:10304
v_mfma_f32_16x16x32_bf16 v[252:255], v[112:115], v[44:47], v[252:255]
s_waitcnt vmcnt(0)
s_nop 0
v_mfma_f32_16x16x32_bf16 v[236:239], v[116:119], v[48:51], v[236:239]
v_mfma_f32_16x16x32_bf16 v[240:243], v[120:123], v[48:51], v[240:243]
ds_write_b128 v7, v[224:227] offset:10368
v_mfma_f32_16x16x32_bf16 v[244:247], v[124:127], v[48:51], v[244:247]
v_mfma_f32_16x16x32_bf16 v[248:251], v[128:131], v[48:51], v[248:251]
ds_write_b128 v7, v[228:231] offset:10432
v_mfma_f32_16x16x32_bf16 v[252:255], v[132:135], v[48:51], v[252:255]
ds_write_b128 v7, v[232:235] offset:10496
s_nop 6
ds_write_b128 v7, v[236:239] offset:15360
ds_write_b128 v7, v[240:243] offset:15424
ds_write_b128 v7, v[244:247] offset:15488
ds_write_b128 v7, v[248:251] offset:15552
ds_write_b128 v7, v[252:255] offset:15616
s_branch P2_RED
P2_CQ:
s_setprio 0
v_add_u32 v11, s55, v2
s_mov_b64 s[40:41], s[18:19]
s_mov_b32 s42, 2621440
s_mov_b32 s43, 0x20000
s_lshl_b32 s72, s47, 6
s_lshl3_add_u32 s72, s3, s72
s_lshl3_add_u32 s60, s72, 20971524
s_mul_i32 s72, s72, 1280
s_mul_i32 s70, s48, 160
s_add_u32 s70, s70, s72
v_add_u32 v16, 0, v0
v_mul_u32_u24 v17, 3277, v16
v_lshrrev_b32 v17, 16, v17
v_mul_u32_u24 v19, 20, v17
v_sub_u32 v16, v16, v19
v_lshlrev_b32 v1, 3, v17
v_bfe_u32 v19, v17, 1, 2
v_xor_b32 v16, v16, v19
v_mul_u32_u24 v17, 1280, v17
v_lshl_add_u32 v4, v16, 3, v17
v_add_u32 v16, 64, v0
v_mul_u32_u24 v17, 3277, v16
v_lshrrev_b32 v17, 16, v17
v_mul_u32_u24 v19, 20, v17
v_sub_u32 v16, v16, v19
v_lshlrev_b32 v3, 3, v17
v_bfe_u32 v19, v17, 1, 2
v_xor_b32 v16, v16, v19
v_mul_u32_u24 v17, 1280, v17
v_lshl_add_u32 v5, v16, 3, v17
v_add_u32 v16, 128, v0
v_mul_u32_u24 v17, 3277, v16
v_lshrrev_b32 v17, 16, v17
v_mul_u32_u24 v19, 20, v17
v_sub_u32 v16, v16, v19
v_lshlrev_b32 v75, 3, v17
v_bfe_u32 v19, v17, 1, 2
v_xor_b32 v16, v16, v19
v_mul_u32_u24 v17, 1280, v17
v_lshl_add_u32 v6, v16, 3, v17
v_lshrrev_b32 v16, 5, v0
v_lshl_add_u32 v6, v16, 26, v6
v_and_b32 v16, 15, v0
v_lshrrev_b32 v17, 4, v0
v_bfe_u32 v19, v0, 1, 2
v_xor_b32 v17, v17, v19
v_mul_u32_u24 v16, 320, v16
v_lshl_add_u32 v16, v17, 4, v16
v_add_u32 v7, s55, v16
s_mul_i32 s72, s3, 2560
v_add_u32 v8, s72, v2
v_add_u32 v9, 61440, v8
v_add_u32 v10, 122880, v8
s_lshl2_add_u32 s71, s47, s49
s_lshl_b32 s71, s71, 9
s_add_u32 s71, s71, 23068672
v_and_b32 v12, 3, v0
v_lshlrev_b32 v12, 7, v12
buffer_load_dwordx2 v[14:15], v12, s[32:35], s71 offen sc1
s_mul_i32 s75, s49, 61440
s_add_u32 s75, s75, s10
s_add_u32 s75, s75, 35840
.p2align 3
buffer_load_dwordx4 v[136:139], v2, s[32:35], s75 offen offset:0 sc1
buffer_load_dwordx4 v[140:143], v2, s[32:35], s75 offen offset:1024 sc1
buffer_load_dwordx4 v[144:147], v2, s[32:35], s75 offen offset:2048 sc1
buffer_load_dwordx4 v[148:151], v2, s[32:35], s75 offen offset:3072 sc1
buffer_load_dwordx4 v[152:155], v18, s[32:35], s75 offen offset:0 sc1
s_mul_i32 s72, s47, 278528
s_mul_i32 s66, s49, 49152
s_add_u32 s66, s66, s72
s_add_u32 s61, s66, 16384
s_add_u32 s62, s66, 20480
s_add_u32 s63, s66, 24576
s_add_u32 s64, s66, 28672
s_add_u32 s65, s66, 32768
s_add_u32 s67, s66, 4096
s_add_u32 s68, s66, 8192
s_add_u32 s69, s66, 12288
s_waitcnt vmcnt(5)
s_mov_b32 s79, 0
L67:
v_cmp_ne_u64 vcc, s[0:1], v[14:15]
s_nop 4
s_cbranch_vccz L68
s_addk_i32 s79, 1
s_cmp_ge_u32 s79, 200000
s_cbranch_scc1 L68
s_sleep 2
buffer_load_dwordx2 v[14:15], v12, s[32:35], s71 offen sc1
s_waitcnt vmcnt(0)
s_branch L67
L68:
buffer_load_dwordx4 v[20:23], v2, s[32:35], s61 offen offset:0 sc1
buffer_load_dwordx4 v[24:27], v2, s[32:35], s61 offen offset:1024 sc1
buffer_load_dwordx4 v[28:31], v2, s[32:35], s61 offen offset:2048 sc1
buffer_load_dwordx4 v[32:35], v2, s[32:35], s61 offen offset:3072 sc1
.p2align 3
s_waitcnt vmcnt(3) lgkmcnt(0)
s_nop 0
v_mfma_f32_16x16x32_bf16 v[176:179], v[76:79], v[20:23], 0
buffer_load_dwordx4 v[36:39], v2, s[32:35], s62 offen offset:0 sc1
v_mfma_f32_16x16x32_bf16 v[180:183], v[80:83], v[20:23], 0
buffer_load_dwordx4 v[40:43], v2, s[32:35], s62 offen offset:1024 sc1
v_mfma_f32_16x16x32_bf16 v[184:187], v[84:87], v[20:23], 0
s_mul_i32 s75, s49, 61440
s_add_u32 s75, s75, s10
s_add_u32 s75, s75, 40960
.p2align 3
v_mfma_f32_16x16x32_bf16 v[188:191], v[88:91], v[20:23], 0
buffer_load_dwordx4 v[156:159], v2, s[32:35], s75 offen offset:0 sc1
v_mfma_f32_16x16x32_bf16 v[192:195], v[92:95], v[20:23], 0
buffer_load_dwordx4 v[160:163], v2, s[32:35], s75 offen offset:1024 sc1
s_waitcnt vmcnt(6)
s_nop 0
v_mfma_f32_16x16x32_bf16 v[196:199], v[76:79], v[24:27], 0
buffer_load_dwordx4 v[44:47], v2, s[32:35], s62 offen offset:2048 sc1
v_mfma_f32_16x16x32_bf16 v[200:203], v[80:83], v[24:27], 0
buffer_load_dwordx4 v[48:51], v2, s[32:35], s62 offen offset:3072 sc1
v_mfma_f32_16x16x32_bf16 v[204:207], v[84:87], v[24:27], 0
v_mfma_f32_16x16x32_bf16 v[208:211], v[88:91], v[24:27], 0
buffer_load_dwordx4 v[164:167], v2, s[32:35], s75 offen offset:2048 sc1
v_mfma_f32_16x16x32_bf16 v[212:215], v[92:95], v[24:27], 0
buffer_load_dwordx4 v[168:171], v2, s[32:35], s75 offen offset:3072 sc1
s_waitcnt vmcnt(9)
s_nop 0
v_mfma_f32_16x16x32_bf16 v[216:219], v[76:79], v[28:31], 0
buffer_load_dwordx4 v[52:55], v2, s[32:35], s63 offen offset:0 sc1
v_mfma_f32_16x16x32_bf16 v[220:223], v[80:83], v[28:31], 0
v_mfma_f32_16x16x32_bf16 v[224:227], v[84:87], v[28:31], 0
buffer_load_dwordx4 v[56:59], v2, s[32:35], s63 offen offset:1024 sc1
v_mfma_f32_16x16x32_bf16 v[228:231], v[88:91], v[28:31], 0
v_mfma_f32_16x16x32_bf16 v[232:235], v[92:95], v[28:31], 0
buffer_load_dwordx4 v[172:175], v18, s[32:35], s75 offen offset:0 sc1
s_waitcnt vmcnt(11)
s_nop 0
v_mfma_f32_16x16x32_bf16 v[236:239], v[76:79], v[32:35], 0
buffer_load_dwordx4 v[60:63], v2, s[32:35], s63 offen offset:2048 sc1
v_mfma_f32_16x16x32_bf16 v[240:243], v[80:83], v[32:35], 0
v_mfma_f32_16x16x32_bf16 v[244:247], v[84:87], v[32:35], 0
v_mfma_f32_16x16x32_bf16 v[248:251], v[88:91], v[32:35], 0
v_mfma_f32_16x16x32_bf16 v[252:255], v[92:95], v[32:35], 0
s_waitcnt vmcnt(11)
s_nop 0
v_mfma_f32_16x16x32_bf16 v[176:179], v[96:99], v[36:39], v[176:179]
buffer_load_dwordx4 v[64:67], v2, s[32:35], s63 offen offset:3072 sc1
v_mfma_f32_16x16x32_bf16 v[180:183], v[100:103], v[36:39], v[180:183]
ds_read_b128 v[76:79], v11 offset:0
v_mfma_f32_16x16x32_bf16 v[184:187], v[104:107], v[36:39], v[184:187]
ds_read_b128 v[80:83], v11 offset:1024
ds_read_b128 v[84:87], v11 offset:2048
v_mfma_f32_16x16x32_bf16 v[188:191], v[108:111], v[36:39], v[188:191]
ds_read_b128 v[88:91], v11 offset:3072
v_mfma_f32_16x16x32_bf16 v[192:195], v[112:115], v[36:39], v[192:195]
ds_read_b128 v[92:95], v11 offset:4096
s_waitcnt vmcnt(11)
s_nop 0
v_mfma_f32_16x16x32_bf16 v[196:199], v[96:99], v[40:43], v[196:199]
buffer_load_dwordx4 v[20:23], v2, s[32:35], s64 offen offset:0 sc1
v_mfma_f32_16x16x32_bf16 v[200:203], v[100:103], v[40:43], v[200:203]
v_mfma_f32_16x16x32_bf16 v[204:207], v[104:107], v[40:43], v[204:207]
v_mfma_f32_16x16x32_bf16 v[208:211], v[108:111], v[40:43], v[208:211]
v_mfma_f32_16x16x32_bf16 v[212:215], v[112:115], v[40:43], v[212:215]
s_waitcnt vmcnt(9)
s_nop 0
v_mfma_f32_16x16x32_bf16 v[216:219], v[96:99], v[44:47], v[216:219]
buffer_load_dwordx4 v[24:27], v2, s[32:35], s64 offen offset:1024 sc1
v_mfma_f32_16x16x32_bf16 v[220:223], v[100:103], v[44:47], v[220:223]
v_mfma_f32_16x16x32_bf16 v[224:227], v[104:107], v[44:47], v[224:227]
v_mfma_f32_16x16x32_bf16 v[228:231], v[108:111], v[44:47], v[228:231]
v_mfma_f32_16x16x32_bf16 v[232:235], v[112:115], v[44:47], v[232:235]
s_waitcnt vmcnt(9)
s_nop 0
v_mfma_f32_16x16x32_bf16 v[236:239], v[96:99], v[48:51], v[236:239]
buffer_load_dwordx4 v[28:31], v2, s[32:35], s64 offen offset:2048 sc1
v_mfma_f32_16x16x32_bf16 v[240:243], v[100:103], v[48:51], v[240:243]
v_mfma_f32_16x16x32_bf16 v[244:247], v[104:107], v[48:51], v[244:247]
v_mfma_f32_16x16x32_bf16 v[248:251], v[108:111], v[48:51], v[248:251]
v_mfma_f32_16x16x32_bf16 v[252:255], v[112:115], v[48:51], v[252:255]
s_waitcnt vmcnt(7) lgkmcnt(0)
s_nop 0
v_mfma_f32_16x16x32_bf16 v[176:179], v[116:119], v[52:55], v[176:179]
buffer_load_dwordx4 v[32:35], v2, s[32:35], s64 offen offset:3072 sc1
v_mfma_f32_16x16x32_bf16 v[180:183], v[120:123], v[52:55], v[180:183]
ds_read_b128 v[96:99], v11 offset:5120
v_mfma_f32_16x16x32_bf16 v[184:187], v[124:127], v[52:55], v[184:187]
ds_read_b128 v[100:103], v11 offset:6144
ds_read_b128 v[104:107], v11 offset:7168
v_mfma_f32_16x16x32_bf16 v[188:191], v[128:131], v[52:55], v[188:191]
ds_read_b128 v[108:111], v11 offset:8192
v_mfma_f32_16x16x32_bf16 v[192:195], v[132:135], v[52:55], v[192:195]
ds_read_b128 v[112:115], v11 offset:9216
s_waitcnt vmcnt(7)
s_nop 0
v_mfma_f32_16x16x32_bf16 v[196:199], v[116:119], v[56:59], v[196:199]
buffer_load_dwordx4 v[36:39], v2, s[32:35], s65 offen offset:0 sc1
v_mfma_f32_16x16x32_bf16 v[200:203], v[120:123], v[56:59], v[200:203]
v_mfma_f32_16x16x32_bf16 v[204:207], v[124:127], v[56:59], v[204:207]
v_mfma_f32_16x16x32_bf16 v[208:211], v[128:131], v[56:59], v[208:211]
v_mfma_f32_16x16x32_bf16 v[212:215], v[132:135], v[56:59], v[212:215]
s_waitcnt vmcnt(6)
s_nop 0
v_mfma_f32_16x16x32_bf16 v[216:219], v[116:119], v[60:63], v[216:219]
buffer_load_dwordx4 v[40:43], v2, s[32:35], s65 offen offset:1024 sc1
v_mfma_f32_16x16x32_bf16 v[220:223], v[120:123], v[60:63], v[220:223]
v_mfma_f32_16x16x32_bf16 v[224:227], v[124:127], v[60:63], v[224:227]
v_mfma_f32_16x16x32_bf16 v[228:231], v[128:131], v[60:63], v[228:231]
v_mfma_f32_16x16x32_bf16 v[232:235], v[132:135], v[60:63], v[232:235]
s_waitcnt vmcnt(6)
s_nop 0
v_mfma_f32_16x16x32_bf16 v[236:239], v[116:119], v[64:67], v[236:239]
buffer_load_dwordx4 v[44:47], v2, s[32:35], s65 offen offset:2048 sc1
v_mfma_f32_16x16x32_bf16 v[240:243], v[120:123], v[64:67], v[240:243]
v_mfma_f32_16x16x32_bf16 v[244:247], v[124:127], v[64:67], v[244:247]
v_mfma_f32_16x16x32_bf16 v[248:251], v[128:131], v[64:67], v[248:251]
v_mfma_f32_16x16x32_bf16 v[252:255], v[132:135], v[64:67], v[252:255]
s_waitcnt vmcnt(6) lgkmcnt(0)
s_nop 0
v_mfma_f32_16x16x32_bf16 v[176:179], v[136:139], v[20:23], v[176:179]
buffer_load_dwordx4 v[48:51], v2, s[32:35], s65 offen offset:3072 sc1
v_mfma_f32_16x16x32_bf16 v[180:183], v[140:143], v[20:23], v[180:183]
ds_read_b128 v[116:119], v11 offset:10240
v_mfma_f32_16x16x32_bf16 v[184:187], v[144:147], v[20:23], v[184:187]
ds_read_b128 v[120:123], v11 offset:11264
ds_read_b128 v[124:127], v11 offset:12288
v_mfma_f32_16x16x32_bf16 v[188:191], v[148:151], v[20:23], v[188:191]
ds_read_b128 v[128:131], v11 offset:13312
v_mfma_f32_16x16x32_bf16 v[192:195], v[152:155], v[20:23], v[192:195]
ds_read_b128 v[132:135], v11 offset:14336
s_waitcnt vmcnt(6)
s_nop 0
v_mfma_f32_16x16x32_bf16 v[196:199], v[136:139], v[24:27], v[196:199]
buffer_load_dwordx4 v[52:55], v2, s[32:35], s66 offen offset:0 sc1
v_mfma_f32_16x16x32_bf16 v[200:203], v[140:143], v[24:27], v[200:203]
v_mfma_f32_16x16x32_bf16 v[204:207], v[144:147], v[24:27], v[204:207]
v_mfma_f32_16x16x32_bf16 v[208:211], v[148:151], v[24:27], v[208:211]
v_mfma_f32_16x16x32_bf16 v[212:215], v[152:155], v[24:27], v[212:215]
s_waitcnt vmcnt(6)
s_nop 0
v_mfma_f32_16x16x32_bf16 v[216:219], v[136:139], v[28:31], v[216:219]
buffer_load_dwordx4 v[56:59], v2, s[32:35], s66 offen offset:1024 sc1
v_mfma_f32_16x16x32_bf16 v[220:223], v[140:143], v[28:31], v[220:223]
v_mfma_f32_16x16x32_bf16 v[224:227], v[144:147], v[28:31], v[224:227]
v_mfma_f32_16x16x32_bf16 v[228:231], v[148:151], v[28:31], v[228:231]
v_mfma_f32_16x16x32_bf16 v[232:235], v[152:155], v[28:31], v[232:235]
s_waitcnt vmcnt(6)
s_nop 0
v_mfma_f32_16x16x32_bf16 v[236:239], v[136:139], v[32:35], v[236:239]
buffer_load_dwordx4 v[60:63], v2, s[32:35], s66 offen offset:2048 sc1
v_mfma_f32_16x16x32_bf16 v[240:243], v[140:143], v[32:35], v[240:243]
v_mfma_f32_16x16x32_bf16 v[244:247], v[144:147], v[32:35], v[244:247]
v_mfma_f32_16x16x32_bf16 v[248:251], v[148:151], v[32:35], v[248:251]
v_mfma_f32_16x16x32_bf16 v[252:255], v[152:155], v[32:35], v[252:255]
s_waitcnt vmcnt(6) lgkmcnt(0)
s_nop 0
v_mfma_f32_16x16x32_bf16 v[176:179], v[156:159], v[36:39], v[176:179]
buffer_load_dwordx4 v[64:67], v2, s[32:35], s66 offen offset:3072 sc1
v_mfma_f32_16x16x32_bf16 v[180:183], v[160:163], v[36:39], v[180:183]
ds_read_b128 v[136:139], v11 offset:15360
v_mfma_f32_16x16x32_bf16 v[184:187], v[164:167], v[36:39], v[184:187]
ds_read_b128 v[140:143], v11 offset:16384
ds_read_b128 v[144:147], v11 offset:17408
v_mfma_f32_16x16x32_bf16 v[188:191], v[168:171], v[36:39], v[188:191]
ds_read_b128 v[148:151], v11 offset:18432
v_mfma_f32_16x16x32_bf16 v[192:195], v[172:175], v[36:39], v[192:195]
ds_read_b128 v[152:155], v11 offset:19456
s_waitcnt vmcnt(6)
s_nop 0
v_mfma_f32_16x16x32_bf16 v[196:199], v[156:159], v[40:43], v[196:199]
buffer_load_dwordx4 v[20:23], v2, s[32:35], s67 offen offset:0 sc1
v_mfma_f32_16x16x32_bf16 v[200:203], v[160:163], v[40:43], v[200:203]
v_mfma_f32_16x16x32_bf16 v[204:207], v[164:167], v[40:43], v[204:207]
v_mfma_f32_16x16x32_bf16 v[208:211], v[168:171], v[40:43], v[208:211]
v_mfma_f32_16x16x32_bf16 v[212:215], v[172:175], v[40:43], v[212:215]
s_waitcnt vmcnt(6)
s_nop 0
v_mfma_f32_16x16x32_bf16 v[216:219], v[156:159], v[44:47], v[216:219]
buffer_load_dwordx4 v[24:27], v2, s[32:35], s68 offen offset:0 sc1
v_mfma_f32_16x16x32_bf16 v[220:223], v[160:163], v[44:47], v[220:223]
v_mfma_f32_16x16x32_bf16 v[224:227], v[164:167], v[44:47], v[224:227]
v_mfma_f32_16x16x32_bf16 v[228:231], v[168:171], v[44:47], v[228:231]
v_mfma_f32_16x16x32_bf16 v[232:235], v[172:175], v[44:47], v[232:235]
s_waitcnt vmcnt(6)
s_nop 0
v_mfma_f32_16x16x32_bf16 v[236:239], v[156:159], v[48:51], v[236:239]
buffer_load_dwordx4 v[28:31], v2, s[32:35], s69 offen offset:0 sc1
v_mfma_f32_16x16x32_bf16 v[240:243], v[160:163], v[48:51], v[240:243]
v_mfma_f32_16x16x32_bf16 v[244:247], v[164:167], v[48:51], v[244:247]
v_mfma_f32_16x16x32_bf16 v[248:251], v[168:171], v[48:51], v[248:251]
v_mfma_f32_16x16x32_bf16 v[252:255], v[172:175], v[48:51], v[252:255]
s_waitcnt vmcnt(6) lgkmcnt(0)
s_nop 0
v_mfma_f32_16x16x32_bf16 v[176:179], v[76:79], v[52:55], v[176:179]
buffer_load_dwordx4 v[32:35], v2, s[32:35], s67 offen offset:1024 sc1
v_mfma_f32_16x16x32_bf16 v[180:183], v[80:83], v[52:55], v[180:183]
v_mfma_f32_16x16x32_bf16 v[184:187], v[84:87], v[52:55], v[184:187]
buffer_load_dwordx2 v[68:69], v4, s[24:27], s70 offen
v_mfma_f32_16x16x32_bf16 v[188:191], v[88:91], v[52:55], v[188:191]
v_mfma_f32_16x16x32_bf16 v[192:195], v[92:95], v[52:55], v[192:195]
buffer_load_dwordx2 v[70:71], v5, s[24:27], s70 offen
s_waitcnt vmcnt(8)
s_nop 0
v_mfma_f32_16x16x32_bf16 v[196:199], v[76:79], v[56:59], v[196:199]
buffer_load_dwordx4 v[36:39], v2, s[32:35], s68 offen offset:1024 sc1
v_mfma_f32_16x16x32_bf16 v[200:203], v[80:83], v[56:59], v[200:203]
v_mfma_f32_16x16x32_bf16 v[204:207], v[84:87], v[56:59], v[204:207]
buffer_load_dwordx2 v[72:73], v6, s[24:27], s70 offen
v_mfma_f32_16x16x32_bf16 v[208:211], v[88:91], v[56:59], v[208:211]
v_mfma_f32_16x16x32_bf16 v[212:215], v[92:95], v[56:59], v[212:215]
buffer_load_dword v1, v1, s[32:35], s60 offen sc1
s_waitcnt vmcnt(10)
s_nop 0
v_mfma_f32_16x16x32_bf16 v[216:219], v[76:79], v[60:63], v[216:219]
buffer_load_dwordx4 v[40:43], v2, s[32:35], s69 offen offset:1024 sc1
v_mfma_f32_16x16x32_bf16 v[220:223], v[80:83], v[60:63], v[220:223]
v_mfma_f32_16x16x32_bf16 v[224:227], v[84:87], v[60:63], v[224:227]
buffer_load_dword v3, v3, s[32:35], s60 offen sc1
v_mfma_f32_16x16x32_bf16 v[228:231], v[88:91], v[60:63], v[228:231]
v_mfma_f32_16x16x32_bf16 v[232:235], v[92:95], v[60:63], v[232:235]
buffer_load_dword v75, v75, s[32:35], s60 offen sc1
s_waitcnt vmcnt(12)
s_nop 0
v_mfma_f32_16x16x32_bf16 v[236:239], v[76:79], v[64:67], v[236:239]
buffer_load_dwordx4 v[44:47], v2, s[32:35], s67 offen offset:2048 sc1
v_mfma_f32_16x16x32_bf16 v[240:243], v[80:83], v[64:67], v[240:243]
v_mfma_f32_16x16x32_bf16 v[244:247], v[84:87], v[64:67], v[244:247]
v_mfma_f32_16x16x32_bf16 v[248:251], v[88:91], v[64:67], v[248:251]
v_mfma_f32_16x16x32_bf16 v[252:255], v[92:95], v[64:67], v[252:255]
s_waitcnt vmcnt(12)
s_nop 0
v_mfma_f32_16x16x32_bf16 v[176:179], v[96:99], v[20:23], v[176:179]
buffer_load_dwordx4 v[48:51], v2, s[32:35], s68 offen offset:2048 sc1
v_mfma_f32_16x16x32_bf16 v[180:183], v[100:103], v[20:23], v[180:183]
v_mfma_f32_16x16x32_bf16 v[184:187], v[104:107], v[20:23], v[184:187]
v_mfma_f32_16x16x32_bf16 v[188:191], v[108:111], v[20:23], v[188:191]
v_mfma_f32_16x16x32_bf16 v[192:195], v[112:115], v[20:23], v[192:195]
s_waitcnt vmcnt(12)
s_nop 0
v_mfma_f32_16x16x32_bf16 v[176:179], v[116:119], v[24:27], v[176:179]
buffer_load_dwordx4 v[52:55], v2, s[32:35], s69 offen offset:2048 sc1
v_mfma_f32_16x16x32_bf16 v[180:183], v[120:123], v[24:27], v[180:183]
v_mfma_f32_16x16x32_bf16 v[184:187], v[124:127], v[24:27], v[184:187]
v_mfma_f32_16x16x32_bf16 v[188:191], v[128:131], v[24:27], v[188:191]
v_mfma_f32_16x16x32_bf16 v[192:195], v[132:135], v[24:27], v[192:195]
s_waitcnt vmcnt(12)
s_nop 0
v_mfma_f32_16x16x32_bf16 v[176:179], v[136:139], v[28:31], v[176:179]
buffer_load_dwordx4 v[56:59], v2, s[32:35], s67 offen offset:3072 sc1
v_mfma_f32_16x16x32_bf16 v[180:183], v[140:143], v[28:31], v[180:183]
v_mfma_f32_16x16x32_bf16 v[184:187], v[144:147], v[28:31], v[184:187]
v_mfma_f32_16x16x32_bf16 v[188:191], v[148:151], v[28:31], v[188:191]
v_mfma_f32_16x16x32_bf16 v[192:195], v[152:155], v[28:31], v[192:195]
s_waitcnt vmcnt(12)
s_nop 0
v_mfma_f32_16x16x32_bf16 v[196:199], v[96:99], v[32:35], v[196:199]
buffer_load_dwordx4 v[60:63], v2, s[32:35], s68 offen offset:3072 sc1
v_mfma_f32_16x16x32_bf16 v[200:203], v[100:103], v[32:35], v[200:203]
v_mfma_f32_16x16x32_bf16 v[204:207], v[104:107], v[32:35], v[204:207]
v_mfma_f32_16x16x32_bf16 v[208:211], v[108:111], v[32:35], v[208:211]
v_mfma_f32_16x16x32_bf16 v[212:215], v[112:115], v[32:35], v[212:215]
s_waitcnt vmcnt(10)
s_nop 0
v_mfma_f32_16x16x32_bf16 v[196:199], v[116:119], v[36:39], v[196:199]
buffer_load_dwordx4 v[64:67], v2, s[32:35], s69 offen offset:3072 sc1
v_mfma_f32_16x16x32_bf16 v[200:203], v[120:123], v[36:39], v[200:203]
ds_write_b128 v7, v[176:179] offset:0
v_mfma_f32_16x16x32_bf16 v[204:207], v[124:127], v[36:39], v[204:207]
v_mfma_f32_16x16x32_bf16 v[208:211], v[128:131], v[36:39], v[208:211]
ds_write_b128 v7, v[180:183] offset:64
v_mfma_f32_16x16x32_bf16 v[212:215], v[132:135], v[36:39], v[212:215]
s_waitcnt vmcnt(8)
s_nop 0
v_mfma_f32_16x16x32_bf16 v[196:199], v[136:139], v[40:43], v[196:199]
v_mfma_f32_16x16x32_bf16 v[200:203], v[140:143], v[40:43], v[200:203]
ds_write_b128 v7, v[184:187] offset:128
v_mfma_f32_16x16x32_bf16 v[204:207], v[144:147], v[40:43], v[204:207]
v_mfma_f32_16x16x32_bf16 v[208:211], v[148:151], v[40:43], v[208:211]
ds_write_b128 v7, v[188:191] offset:192
v_mfma_f32_16x16x32_bf16 v[212:215], v[152:155], v[40:43], v[212:215]
s_waitcnt vmcnt(5)
s_nop 0
v_mfma_f32_16x16x32_bf16 v[216:219], v[96:99], v[44:47], v[216:219]
v_mfma_f32_16x16x32_bf16 v[220:223], v[100:103], v[44:47], v[220:223]
v_mfma_f32_16x16x32_bf16 v[224:227], v[104:107], v[44:47], v[224:227]
ds_write_b128 v7, v[192:195] offset:256
v_mfma_f32_16x16x32_bf16 v[228:231], v[108:111], v[44:47], v[228:231]
v_mfma_f32_16x16x32_bf16 v[232:235], v[112:115], v[44:47], v[232:235]
s_waitcnt vmcnt(4)
s_nop 0
v_mfma_f32_16x16x32_bf16 v[216:219], v[116:119], v[48:51], v[216:219]
v_mfma_f32_16x16x32_bf16 v[220:223], v[120:123], v[48:51], v[220:223]
ds_write_b128 v7, v[196:199] offset:5120
v_mfma_f32_16x16x32_bf16 v[224:227], v[124:127], v[48:51], v[224:227]
v_mfma_f32_16x16x32_bf16 v[228:231], v[128:131], v[48:51], v[228:231]
ds_write_b128 v7, v[200:203] offset:5184
v_mfma_f32_16x16x32_bf16 v[232:235], v[132:135], v[48:51], v[232:235]
s_waitcnt vmcnt(3)
s_nop 0
v_mfma_f32_16x16x32_bf16 v[216:219], v[136:139], v[52:55], v[216:219]
v_mfma_f32_16x16x32_bf16 v[220:223], v[140:143], v[52:55], v[220:223]
ds_write_b128 v7, v[204:207] offset:5248
v_mfma_f32_16x16x32_bf16 v[224:227], v[144:147], v[52:55], v[224:227]
v_mfma_f32_16x16x32_bf16 v[228:231], v[148:151], v[52:55], v[228:231]
ds_write_b128 v7, v[208:211] offset:5312
v_mfma_f32_16x16x32_bf16 v[232:235], v[152:155], v[52:55], v[232:235]
s_waitcnt vmcnt(2)
s_nop 0
v_mfma_f32_16x16x32_bf16 v[236:239], v[96:99], v[56:59], v[236:239]
v_mfma_f32_16x16x32_bf16 v[240:243], v[100:103], v[56:59], v[240:243]
v_mfma_f32_16x16x32_bf16 v[244:247], v[104:107], v[56:59], v[244:247]
ds_write_b128 v7, v[212:215] offset:5376
v_mfma_f32_16x16x32_bf16 v[248:251], v[108:111], v[56:59], v[248:251]
v_mfma_f32_16x16x32_bf16 v[252:255], v[112:115], v[56:59], v[252:255]
s_waitcnt vmcnt(1)
s_nop 0
v_mfma_f32_16x16x32_bf16 v[236:239], v[116:119], v[60:63], v[236:239]
v_mfma_f32_16x16x32_bf16 v[240:243], v[120:123], v[60:63], v[240:243]
ds_write_b128 v7, v[216:219] offset:10240
v_mfma_f32_16x16x32_bf16 v[244:247], v[124:127], v[60:63], v[244:247]
v_mfma_f32_16x16x32_bf16 v[248:251], v[128:131], v[60:63], v[248:251]
ds_write_b128 v7, v[220:223] offset:10304
v_mfma_f32_16x16x32_bf16 v[252:255], v[132:135], v[60:63], v[252:255]
s_waitcnt vmcnt(0)
s_nop 0
v_mfma_f32_16x16x32_bf16 v[236:239], v[136:139], v[64:67], v[236:239]
v_mfma_f32_16x16x32_bf16 v[240:243], v[140:143], v[64:67], v[240:243]
ds_write_b128 v7, v[224:227] offset:10368
v_mfma_f32_16x16x32_bf16 v[244:247], v[144:147], v[64:67], v[244:247]
v_mfma_f32_16x16x32_bf16 v[248:251], v[148:151], v[64:67], v[248:251]
ds_write_b128 v7, v[228:231] offset:10432
v_mfma_f32_16x16x32_bf16 v[252:255], v[152:155], v[64:67], v[252:255]
ds_write_b128 v7, v[232:235] offset:10496
s_nop 6
ds_write_b128 v7, v[236:239] offset:15360
ds_write_b128 v7, v[240:243] offset:15424
ds_write_b128 v7, v[244:247] offset:15488
ds_write_b128 v7, v[248:251] offset:15552
ds_write_b128 v7, v[252:255] offset:15616
P2_RED:
s_waitcnt lgkmcnt(0)
s_barrier
ds_read_b128 v[20:23], v8 offset:0
ds_read_b128 v[24:27], v8 offset:20480
ds_read_b128 v[28:31], v8 offset:40960
ds_read_b128 v[32:35], v9 offset:0
ds_read_b128 v[36:39], v9 offset:20480
ds_read_b128 v[40:43], v9 offset:40960
ds_read_b128 v[44:47], v10 offset:0
ds_read_b128 v[48:51], v10 offset:20480
ds_read_b128 v[80:83], v8 offset:1024
ds_read_b128 v[84:87], v8 offset:21504
ds_read_b128 v[88:91], v8 offset:41984
ds_read_b128 v[92:95], v9 offset:1024
ds_read_b128 v[96:99], v9 offset:21504
ds_read_b128 v[100:103], v9 offset:41984
ds_read_b128 v[104:107], v10 offset:1024
ds_read_b128 v[108:111], v10 offset:21504
ds_read_b128 v[176:179], v8 offset:2048
ds_read_b128 v[180:183], v8 offset:22528
ds_read_b128 v[184:187], v8 offset:43008
ds_read_b128 v[188:191], v9 offset:2048
ds_read_b128 v[192:195], v9 offset:22528
ds_read_b128 v[196:199], v9 offset:43008
ds_read_b128 v[200:203], v10 offset:2048
ds_read_b128 v[204:207], v10 offset:22528
v_mul_f32 v1, v1, v1
v_mul_f32 v3, v3, v3
v_mul_f32 v75, v75, v75
s_nop 0
v_lshlrev_b32 v60, 16, v68
v_lshlrev_b32 v62, 16, v69
v_and_b32 v61, 0xffff0000, v68
v_and_b32 v63, 0xffff0000, v69
s_waitcnt lgkmcnt(15)
s_nop 0
v_pk_add_f32 v[20:21], v[20:21], v[24:25]
v_pk_add_f32 v[22:23], v[22:23], v[26:27]
v_pk_add_f32 v[28:29], v[28:29], v[32:33]
v_pk_add_f32 v[30:31], v[30:31], v[34:35]
v_pk_add_f32 v[36:37], v[36:37], v[40:41]
v_pk_add_f32 v[38:39], v[38:39], v[42:43]
v_pk_add_f32 v[44:45], v[44:45], v[48:49]
v_pk_add_f32 v[46:47], v[46:47], v[50:51]
v_pk_add_f32 v[20:21], v[20:21], v[28:29]
v_pk_add_f32 v[22:23], v[22:23], v[30:31]
v_pk_add_f32 v[36:37], v[36:37], v[44:45]
v_pk_add_f32 v[38:39], v[38:39], v[46:47]
v_pk_add_f32 v[20:21], v[20:21], v[36:37]
v_pk_add_f32 v[22:23], v[22:23], v[38:39]
v_fma_f32 v20, v20, v1, v60
v_fma_f32 v21, v21, v1, v61
v_fma_f32 v22, v22, v1, v62
v_fma_f32 v23, v23, v1, v63
v_cvt_pk_bf16_f32 v20, v20, v21
v_cvt_pk_bf16_f32 v21, v22, v23
buffer_store_dwordx2 v[20:21], v4, s[40:43], s70 offen
v_lshlrev_b32 v60, 16, v70
v_lshlrev_b32 v62, 16, v71
v_and_b32 v61, 0xffff0000, v70
v_and_b32 v63, 0xffff0000, v71
s_waitcnt lgkmcnt(8)
s_nop 0
v_pk_add_f32 v[80:81], v[80:81], v[84:85]
v_pk_add_f32 v[82:83], v[82:83], v[86:87]
v_pk_add_f32 v[88:89], v[88:89], v[92:93]
v_pk_add_f32 v[90:91], v[90:91], v[94:95]
v_pk_add_f32 v[96:97], v[96:97], v[100:101]
v_pk_add_f32 v[98:99], v[98:99], v[102:103]
v_pk_add_f32 v[104:105], v[104:105], v[108:109]
v_pk_add_f32 v[106:107], v[106:107], v[110:111]
v_pk_add_f32 v[80:81], v[80:81], v[88:89]
v_pk_add_f32 v[82:83], v[82:83], v[90:91]
v_pk_add_f32 v[96:97], v[96:97], v[104:105]
v_pk_add_f32 v[98:99], v[98:99], v[106:107]
v_pk_add_f32 v[80:81], v[80:81], v[96:97]
v_pk_add_f32 v[82:83], v[82:83], v[98:99]
v_fma_f32 v80, v80, v3, v60
v_fma_f32 v81, v81, v3, v61
v_fma_f32 v82, v82, v3, v62
v_fma_f32 v83, v83, v3, v63
v_cvt_pk_bf16_f32 v80, v80, v81
v_cvt_pk_bf16_f32 v81, v82, v83
buffer_store_dwordx2 v[80:81], v5, s[40:43], s70 offen
v_lshlrev_b32 v60, 16, v72
v_lshlrev_b32 v62, 16, v73
v_and_b32 v61, 0xffff0000, v72
v_and_b32 v63, 0xffff0000, v73
s_waitcnt lgkmcnt(0)
s_nop 0
v_pk_add_f32 v[176:177], v[176:177], v[180:181]
v_pk_add_f32 v[178:179], v[178:179], v[182:183]
v_pk_add_f32 v[184:185], v[184:185], v[188:189]
v_pk_add_f32 v[186:187], v[186:187], v[190:191]
v_pk_add_f32 v[192:193], v[192:193], v[196:197]
v_pk_add_f32 v[194:195], v[194:195], v[198:199]
v_pk_add_f32 v[200:201], v[200:201], v[204:205]
v_pk_add_f32 v[202:203], v[202:203], v[206:207]
v_pk_add_f32 v[176:177], v[176:177], v[184:185]
v_pk_add_f32 v[178:179], v[178:179], v[186:187]
v_pk_add_f32 v[192:193], v[192:193], v[200:201]
v_pk_add_f32 v[194:195], v[194:195], v[202:203]
v_pk_add_f32 v[176:177], v[176:177], v[192:193]
v_pk_add_f32 v[178:179], v[178:179], v[194:195]
v_fma_f32 v176, v176, v75, v60
v_fma_f32 v177, v177, v75, v61
v_fma_f32 v178, v178, v75, v62
v_fma_f32 v179, v179, v75, v63
v_cvt_pk_bf16_f32 v176, v176, v177
v_cvt_pk_bf16_f32 v177, v178, v179
buffer_store_dwordx2 v[176:177], v6, s[40:43], s70 offen
K_END:
s_endpgm
W_RET:
s_branch W_RETA
K_LAST:
.set CODE_SPAN, K_LAST - parallel_sum__sliding_local_dilated__glu_gated_bilinear__prompt_kernel - 4
.section .rodata,"a"
.p2align 6
.amdhsa_kernel parallel_sum__sliding_local_dilated__glu_gated_bilinear__prompt_kernel
  .amdhsa_next_free_vgpr 256
  .amdhsa_next_free_sgpr 102
  .amdhsa_accum_offset 256
  .amdhsa_group_segment_fixed_size 0
  .amdhsa_kernarg_size 80
  .amdhsa_user_sgpr_count 2
  .amdhsa_user_sgpr_kernarg_segment_ptr 1
  .amdhsa_system_sgpr_workgroup_id_x 1
.end_amdhsa_kernel
.text
```
